```python
import torch

def _softmax(x, axis=-1):
    return torch.softmax(x, dim=axis)

def _gelu(x):
    return torch.nn.functional.gelu(x, approximate='tanh')

def _silu(x):
    return torch.nn.functional.silu(x)

def _sigmoid(x):
    return torch.sigmoid(x)

def _layernorm(x, axis=-1, eps=1e-05):
    m = x.mean(dim=axis, keepdim=True)
    v = x.var(dim=axis, keepdim=True, unbiased=False)
    return (x - m) / torch.sqrt(v + eps)

def _scatter_add(tgt, idx, src, axis=0):
    return tgt.clone().index_add_(axis, idx, src)

def _segment_sum(src, seg, n):
    out = torch.zeros((n,) + src.shape[1:], dtype=src.dtype)
    return out.index_add_(0, seg, src)

def _pad(x, pw):
    flat = tuple((v for pair in reversed(pw) for v in pair))
    return torch.nn.functional.pad(x, flat)
kernel_name = 'adaLN_cond__sliding_local_dilated__mixer_channel_mlp__prompt'

def setup_inputs():

    _w = lambda a: (lambda t: t.to(torch.bfloat16) if t.is_floating_point() else t)(torch.as_tensor(a))

    def _A_setup():
        B, S, D = (1, 2048, 640)
        return {'x': _w((lambda *s: torch.randn(*s, dtype=torch.bfloat16) * 0.05)(B, S, D)), 'wqkv': _w((lambda *s: torch.randn(*s, dtype=torch.bfloat16) * 0.05)(D, 3 * D)), 'wo': _w((lambda *s: torch.randn(*s, dtype=torch.bfloat16) * 0.05)(D, D))}
    _A_in = _A_setup()

    def _B_setup():
        B, S, D, F = (1, 2048, 640, 1728)
        return {'x': _w((lambda *s: torch.randn(*s, dtype=torch.bfloat16) * 0.05)(B, S, D)), 'w1': _w((lambda *s: torch.randn(*s, dtype=torch.bfloat16) * 3.2)(D, F) * D ** (-0.5)), 'b1': _w((lambda *s: torch.randn(*s, dtype=torch.bfloat16) * 1.6)(F)), 'w2': _w((lambda *s: torch.randn(*s, dtype=torch.bfloat16) * 0.4)(F, D) * F ** (-0.5)), 'b2': _w((lambda *s: torch.randn(*s, dtype=torch.bfloat16) * 0.8)(D))}
    _B_in = _B_setup()
    return {'A_x': _A_in['x'], 'A_wqkv': _A_in['wqkv'], 'A_wo': _A_in['wo'], 'B_x': _B_in['x'], 'B_w1': _B_in['w1'], 'B_b1': _B_in['b1'], 'B_w2': _B_in['w2'], 'B_b2': _B_in['b2'], 'c': _w((lambda *s: torch.randn(*s, dtype=torch.bfloat16) * 0.1)(1, 640) * 8.0), 'w_mod': _w((lambda *s: torch.randn(*s, dtype=torch.bfloat16) * 0.1)(640, 6 * 640) * 640 ** (-0.5) * 8.0)}

def reference(A_x, A_wqkv, A_wo, B_x, B_w1, B_b1, B_w2, B_b2, c, w_mod):

    def _A_ref(x, wqkv, wo):
        B, S, D = x.shape
        H = 32
        Dh = D // H
        W, dil = (8, 2)
        qkv = (lambda x, *d: x.permute(*d))((x @ wqkv).reshape(B, S, 3, H, Dh), 2, 0, 3, 1, 4)
        q, k, v = (qkv[0], qkv[1], qkv[2])
        scale = Dh ** (-0.5)
        pos = torch.arange(S)
        off = torch.arange(W) * dil
        idx = pos[:, None] - off[None, :]
        mask = idx >= 0
        idx_c = torch.where(mask, idx, 0).reshape(-1)
        kg = k[:, :, idx_c, :].reshape(B, H, S, W, Dh)
        vg = v[:, :, idx_c, :].reshape(B, H, S, W, Dh)
        logits = torch.einsum('bhsd,bhswd->bhsw', q, kg) * scale
        logits = torch.where(mask[None, None, :, :], logits, -1000000000.0)
        attn = _softmax(logits, axis=-1)
        o = torch.einsum('bhsw,bhswd->bhsd', attn, vg)
        return (lambda x, *d: x.permute(*d))(o, 0, 2, 1, 3).reshape(B, S, D) @ wo

    def _B_ref(x, w1, b1, w2, b2):
        y = _layernorm(x, axis=-1)
        h = _gelu(torch.einsum('bsd,df->bsf', y, w1) + b1)
        return torch.einsum('bsf,fd->bsd', h, w2) + b2
    x = A_x
    mod = (_silu(c) @ w_mod).reshape(c.shape[0], 6, 1, -1)
    sa, ca, ga, sb, cb, gb = (mod[:, 0].clone(), mod[:, 1].clone(), mod[:, 2].clone(), mod[:, 3].clone(), mod[:, 4].clone(), mod[:, 5].clone())
    h = _layernorm(x, axis=-1) * (1 + ca) + sa
    x = x + ga * _A_ref(h, A_wqkv, A_wo)
    h = _layernorm(x, axis=-1) * (1 + cb) + sb
    x = x + gb * _B_ref(h, B_w1, B_b1, B_w2, B_b2)
    return x
```

```asm
; @launch grid=(256,1,1) block=(256,1,1) lds=163840
.amdgcn_target "amdgcn-amd-amdhsa--gfx950"
.text
.globl adaLN_cond__sliding_local_dilated__mixer_channel_mlp__prompt_kernel
.p2align 8
.type adaLN_cond__sliding_local_dilated__mixer_channel_mlp__prompt_kernel,@function
adaLN_cond__sliding_local_dilated__mixer_channel_mlp__prompt_kernel:
    s_cmp_ge_u32 s2, 256
    s_cbranch_scc1 L_end
    s_load_dwordx8 s[40:47], s[0:1], 64
    s_load_dwordx16 s[24:39], s[0:1], 0
    s_load_dwordx2 s[48:49], s[0:1], 96
    s_getpc_b64 s[54:55]
L_pc:
    s_bfe_u32 s56, s2, 0x30003
    v_lshrrev_b32 v3, 2, v0
    s_lshl_b32 s56, s56, 7
    v_lshl_add_u32 v3, v3, 10, s56
    v_min_u32 v3, L_code_end-L_pc-4, v3
    global_load_dword v6, v3, s[54:55]
    v_lshrrev_b32 v3, 6, v0
    v_and_b32 v1, 63, v0
    v_readfirstlane_b32 s3, v3
    v_and_b32 v18, 7, v1
    v_lshrrev_b32 v19, 3, v1
    s_and_b32 s50, s2, 7
    s_lshr_b32 s51, s2, 3
    s_lshr_b32 s54, s2, 6
    s_lshl_b32 s55, s50, 2
    s_add_u32 s54, s54, s55
    s_lshl_b32 s54, s54, 2
    s_add_u32 s62, s54, s3
    s_lshr_b32 s54, s62, 1
    s_lshl_b32 s54, s54, 5
    s_and_b32 s55, s3, 1
    s_add_u32 s54, s54, s55
    s_mul_i32 s54, s54, 1280
    s_and_b32 s63, s51, 7
    s_mul_i32 s55, s63, 160
    s_add_u32 s61, s54, s55
    s_and_b32 s57, s61, 0xffffff80
    v_mul_u32_u24 v25, 2560, v19
    s_mul_i32 m0, s3, 22528
    v_lshl_add_u32 v25, v18, 4, v25
    s_and_b32 s60, s2, 3
    v_min_u32 v26, 39, v1
    s_mul_i32 s54, s60, 320
    v_lshl_add_u32 v27, v26, 3, s54
    v_mov_b32 v7, 0
    s_mov_b32 s6, 0x280000
    s_mov_b32 s7, 0x20000
    s_waitcnt lgkmcnt(0)
    s_mov_b64 s[4:5], s[24:25]
    global_load_dwordx2 v[20:21], v27, s[40:41]
    global_load_dword v23, v7, s[48:49] sc1
    buffer_load_dwordx4 v25, s[4:7], s57 offen offset:0 nt lds
    s_add_u32 m0, m0, 896
    s_nop 0
    buffer_load_dwordx4 v25, s[4:7], s57 offen offset:128 nt lds
    s_add_u32 m0, m0, 1152
    s_add_u32 s57, s57, 20480
    buffer_load_dwordx4 v25, s[4:7], s57 offen offset:0 nt lds
    s_add_u32 m0, m0, 896
    s_nop 0
    buffer_load_dwordx4 v25, s[4:7], s57 offen offset:128 nt lds
    v_mov_b32 v24, v19
    s_movk_i32 s58, 128
    v_lshrrev_b32 v26, 2, v19
    s_mov_b32 s22, 0x58500800
    s_movk_i32 s23, 16
    s_cmp_lt_u32 s2, 120
    s_cbranch_scc1 L1
    s_sub_u32 s54, s2, 200
    s_cmp_ge_u32 s54, 40
    s_cbranch_scc1 L2
    s_lshr_b32 s20, s54, 1
    s_and_b32 s21, s54, 1
    s_mul_i32 s54, s20, 40
    s_lshl_b32 s55, s54, 2
    s_sub_u32 s55, s55, 2544
    s_cmp_lt_u32 s20, 16
    s_cselect_b32 s54, s54, s55
    s_cselect_b32 s55, 4, 40
    s_movk_i32 s59, 1280
    v_lshl_add_u32 v24, v26, 4, v19
    s_mul_i32 s57, s21, 640
    s_mov_b64 s[16:17], s[28:29]
    s_branch L3
L2:
    s_mul_i32 s54, s60, 160
    s_movk_i32 s55, 40
    s_sub_u32 s21, s2, 120
    s_lshr_b32 s21, s21, 2
    s_cmp_ge_u32 s2, 240
    s_cselect_b32 s21, 59, s21
    s_lshl_b32 s57, s21, 7
    s_movk_i32 s59, 7680
    s_mov_b32 s58, 61440
    s_mov_b64 s[16:17], s[42:43]
    s_branch L3
L1:
    s_mul_i32 s20, s2, 171
    s_lshr_b32 s20, s20, 10
    s_mul_i32 s54, s20, 6
    s_sub_u32 s21, s2, s54
    s_mul_i32 s54, s20, 205
    s_lshr_b32 s54, s54, 10
    s_mul_i32 s55, s54, 5
    s_sub_u32 s55, s20, s55
    s_mul_i32 s54, s54, 160
    s_lshl_b32 s55, s55, 3
    s_lshr_b64 s[56:57], s[22:23], s55
    s_and_b32 s56, s56, 0xff
    s_add_u32 s54, s54, s56
    s_cmp_eq_u32 s55, 32
    s_cselect_b32 s56, 16, 0
    s_cselect_b32 s55, 40, 20
    v_mad_u32_u24 v24, v26, s56, v19
    s_movk_i32 s59, 3840
    s_mul_i32 s57, s21, 640
    s_mov_b64 s[16:17], s[26:27]
L3:
    s_mul_i32 s55, s55, s3
    v_mul_u32_u24 v24, s59, v24
    s_add_u32 s54, s54, s55
    s_mul_i32 s18, s59, 640
    s_mul_i32 s54, s54, s59
    v_lshl_add_u32 v24, v18, 4, v24
    s_mov_b32 s19, 0x20000
    s_add_u32 s57, s57, s54
    s_mul_i32 s54, s3, 5120
    s_add_u32 m0, s54, 112640
    s_nop 0
    buffer_load_dwordx4 v24, s[16:19], s57 offen nt lds
    s_add_u32 m0, m0, 1024
    s_add_u32 s57, s57, s58
    buffer_load_dwordx4 v24, s[16:19], s57 offen nt lds
    s_add_u32 m0, m0, 1024
    s_add_u32 s57, s57, s58
    buffer_load_dwordx4 v24, s[16:19], s57 offen nt lds
    s_add_u32 m0, m0, 1024
    s_add_u32 s57, s57, s58
    buffer_load_dwordx4 v24, s[16:19], s57 offen nt lds
    s_add_u32 m0, m0, 1024
    s_add_u32 s57, s57, s58
    buffer_load_dwordx4 v24, s[16:19], s57 offen nt lds
L_issued:
    s_mov_b32 s8, s48
    s_mov_b32 s9, s49
    s_mov_b32 s10, 0x1d00000
    s_mov_b32 s11, 0x20000
    v_mov_b32 v13, 0x7ffffff0
    v_cmp_eq_u32 vcc, 0, v1
    v_lshlrev_b32 v2, 4, v1
    v_and_b32 v4, 15, v1
    v_cndmask_b32 v15, v13, 0, vcc
    v_lshrrev_b32 v5, 4, v1
    s_lshl_b32 s1, s2, 8
    s_lshl_b32 s54, s3, 7
    s_add_u32 s54, s54, s1
    s_add_u32 s54, s54, 0x10000
    s_cmp_lt_u32 s3, 2
    s_cselect_b32 s54, s54, 0x7ffffff0
    buffer_load_dword v29, v15, s[8:11], s54 offen sc1
    s_mov_b32 s12, s34
    s_mov_b32 s13, s35
    s_mov_b32 s14, 0xd80
    s_mov_b32 s15, 0x20000
    s_lshl_b32 s54, s3, 10
    s_add_u32 m0, s54, 158848
    v_lshlrev_b32 v22, 2, v1
    buffer_load_dwordx4 v2, s[12:15], s54 offen lds
    s_mov_b32 s12, s38
    s_mov_b32 s13, s39
    s_mov_b32 s14, 0x500
    s_mov_b32 s15, 0x20000
    s_mov_b32 m0, 162944
    s_mul_i32 s55, s63, 160
    buffer_load_dword v22, s[12:15], s55 offen lds
    v_mul_u32_u24 v3, 2560, v4
    v_mad_u32_u24 v3, v5, 40, v3
    v_add_u32 v3, s61, v3
    s_and_b32 s54, s61, 127
    s_mul_i32 s59, s3, 22528
    v_mov_b32 v26, s54
    v_mad_u32_u24 v26, v5, 40, v26
    v_and_b32 v27, 8, v1
    v_add_u32 v27, v27, v4
    v_lshl_add_u32 v27, v27, 7, s59
    s_movk_i32 s54, 896
    v_lshrrev_b32 v120, 7, v26
    v_mad_u32_u24 v120, v120, s54, v26
    v_add_u32 v26, 8, v26
    v_add_u32 v120, v120, v27
    v_lshrrev_b32 v121, 7, v26
    v_mad_u32_u24 v121, v121, s54, v26
    v_add_u32 v26, 8, v26
    v_add_u32 v121, v121, v27
    v_lshrrev_b32 v122, 7, v26
    v_mad_u32_u24 v122, v122, s54, v26
    v_add_u32 v26, 8, v26
    v_add_u32 v122, v122, v27
    v_lshrrev_b32 v123, 7, v26
    v_mad_u32_u24 v123, v123, s54, v26
    v_add_u32 v26, 8, v26
    v_add_u32 v123, v123, v27
    v_lshrrev_b32 v124, 7, v26
    v_mad_u32_u24 v124, v124, s54, v26
    v_add_u32 v124, v124, v27
    v_mov_b32 v40, 157696
    s_waitcnt vmcnt(13)
    v_lshlrev_b32 v220, 16, v20
    v_and_b32 v221, 0xffff0000, v20
    v_lshlrev_b32 v222, 16, v21
    v_and_b32 v223, 0xffff0000, v21
    v_mul_f32 v224, 0xbfb8aa3b, v220
    v_mul_f32 v225, 0xbfb8aa3b, v221
    v_mul_f32 v226, 0xbfb8aa3b, v222
    v_mul_f32 v227, 0xbfb8aa3b, v223
    v_exp_f32 v224, v224
    v_exp_f32 v225, v225
    v_exp_f32 v226, v226
    v_exp_f32 v227, v227
    v_add_f32 v224, 1.0, v224
    v_add_f32 v225, 1.0, v225
    v_add_f32 v226, 1.0, v226
    v_add_f32 v227, 1.0, v227
    v_rcp_f32 v224, v224
    v_rcp_f32 v225, v225
    v_rcp_f32 v226, v226
    v_rcp_f32 v227, v227
    v_min_u32 v228, 39, v1
    v_mul_f32 v220, v220, v224
    v_mul_f32 v221, v221, v225
    v_mul_f32 v222, v222, v226
    v_mul_f32 v223, v223, v227
    v_cvt_pk_bf16_f32 v224, v220, v221
    v_cvt_pk_bf16_f32 v225, v222, v223
    v_lshl_add_u32 v228, v228, 3, v40
    v_lshl_add_u32 v229, v5, 4, v40
    ds_write_b64 v228, v[224:225] offset:5696
    s_waitcnt vmcnt(12)
    v_readfirstlane_b32 s52, v23
    s_nop 0
    s_mul_i32 s52, s52, 1664525
    s_add_u32 s52, s52, 1013904223
    v_mov_b32 v14, s52
    s_waitcnt vmcnt(8)
    ds_read_b64 v[248:249], v120
    ds_read_b64 v[250:251], v121
    ds_read_b64 v[252:253], v122
    ds_read_b64 v[254:255], v123
    ds_read_b64 v[232:233], v124
    v_mov_b32 v96, 0
    v_mov_b32 v97, 0
    v_mov_b32 v98, v14
    v_mov_b32 v99, v14
    v_mov_b32 v100, 0x3f803f80
    v_cmp_gt_u32 vcc, 16, v1
    s_lshl_b32 s23, s62, 11
    s_add_u32 s23, s23, 0xa0000
    v_cndmask_b32 v101, v13, v2, vcc
    s_lshl_b32 s54, s63, 8
    s_add_u32 s54, s54, s23
    s_waitcnt lgkmcnt(0)
    v_dot2c_f32_bf16 v96, v248, v100
    v_dot2c_f32_bf16 v97, v248, v248
    v_dot2c_f32_bf16 v96, v249, v100
    v_dot2c_f32_bf16 v97, v249, v249
    v_dot2c_f32_bf16 v96, v250, v100
    v_dot2c_f32_bf16 v97, v250, v250
    v_dot2c_f32_bf16 v96, v251, v100
    v_dot2c_f32_bf16 v97, v251, v251
    v_dot2c_f32_bf16 v96, v252, v100
    v_dot2c_f32_bf16 v97, v252, v252
    v_dot2c_f32_bf16 v96, v253, v100
    v_dot2c_f32_bf16 v97, v253, v253
    v_dot2c_f32_bf16 v96, v254, v100
    v_dot2c_f32_bf16 v97, v254, v254
    v_dot2c_f32_bf16 v96, v255, v100
    v_dot2c_f32_bf16 v97, v255, v255
    v_dot2c_f32_bf16 v96, v232, v100
    v_dot2c_f32_bf16 v97, v232, v232
    v_dot2c_f32_bf16 v96, v233, v100
    v_dot2c_f32_bf16 v97, v233, v233
    v_lshlrev_b32 v200, 16, v248
    v_and_b32 v201, 0xffff0000, v248
    v_lshlrev_b32 v202, 16, v249
    v_mov_b32 v94, v96
    v_mov_b32 v95, v97
    v_and_b32 v203, 0xffff0000, v249
    v_permlane16_swap_b32 v96, v94
    v_permlane16_swap_b32 v97, v95
    v_add_f32 v96, v96, v94
    v_add_f32 v97, v97, v95
    v_mov_b32 v94, v96
    v_mov_b32 v95, v97
    v_lshlrev_b32 v204, 16, v250
    v_permlane32_swap_b32 v96, v94
    v_permlane32_swap_b32 v97, v95
    v_add_f32 v96, v96, v94
    v_add_f32 v97, v97, v95
    buffer_store_dwordx4 v[96:99], v101, s[8:11], s54 offen sc1
    s_sub_u32 s54, s2, 200
    s_cmp_lt_u32 s54, 40
    s_cselect_b32 s54, 0, s2
    s_cmp_ge_u32 s54, 120
    s_cbranch_scc0 L4
    ds_read_b128 v[44:47], v229 offset:5696
    ds_read_b128 v[48:51], v229 offset:5760
    ds_read_b128 v[52:55], v229 offset:5824
    ds_read_b128 v[56:59], v229 offset:5888
    ds_read_b128 v[60:63], v229 offset:5952
    v_bfe_u32 v25, v1, 2, 2
    v_lshl_add_u32 v25, v5, 3, v25
    v_and_b32 v26, 3, v1
    v_lshlrev_b32 v25, 7, v25
    v_lshl_add_u32 v25, v26, 3, v25
    s_lshl_b32 s54, s3, 5
    s_add_u32 s54, s54, 112640
    v_add_u32 v25, s54, v25
    v_add_u32 v26, 0x07060500, v26
    v_mul_u32_u24 v27, 61440, v5
    v_lshl_add_u32 v27, v4, 2, v27
    s_and_b32 s54, s2, 3
    s_mul_i32 s54, s54, 15360
    s_lshl_b32 s55, s21, 8
    s_add_u32 s54, s54, s55
    s_lshl_b32 s55, s3, 6
    s_add_u32 s54, s54, s55
    s_add_u32 s54, s54, 0x20000
    s_add_u32 s55, s54, 245760
    s_waitcnt vmcnt(4) lgkmcnt(0)
    s_barrier
    ds_read_b64_tr_b16 v[128:129], v25 offset:0
    ds_read_b64_tr_b16 v[130:131], v25 offset:512
    ds_read_b64_tr_b16 v[132:133], v25 offset:4096
    ds_read_b64_tr_b16 v[134:135], v25 offset:4608
    ds_read_b64_tr_b16 v[136:137], v25 offset:8192
    ds_read_b64_tr_b16 v[138:139], v25 offset:8704
    ds_read_b64_tr_b16 v[140:141], v25 offset:12288
    ds_read_b64_tr_b16 v[142:143], v25 offset:12800
    ds_read_b64_tr_b16 v[144:145], v25 offset:16384
    ds_read_b64_tr_b16 v[146:147], v25 offset:16896
    s_waitcnt lgkmcnt(8)
    v_mfma_f32_16x16x32_bf16 v[64:67], v[44:47], v[128:131], 0
    s_waitcnt lgkmcnt(6)
    v_mfma_f32_16x16x32_bf16 v[64:67], v[48:51], v[132:135], v[64:67]
    s_waitcnt lgkmcnt(4)
    v_mfma_f32_16x16x32_bf16 v[64:67], v[52:55], v[136:139], v[64:67]
    s_waitcnt lgkmcnt(2)
    v_mfma_f32_16x16x32_bf16 v[64:67], v[56:59], v[140:143], v[64:67]
    s_waitcnt lgkmcnt(0)
    v_mfma_f32_16x16x32_bf16 v[64:67], v[60:63], v[144:147], v[64:67]
    s_nop 7
    v_perm_b32 v64, v64, v14, v26
    buffer_store_dword v64, v27, s[8:11], s54 offen sc1
    buffer_store_dword v64, v27, s[8:11], s55 offen sc1
    s_branch L_joinS
L4:
    v_bfe_u32 v25, v1, 2, 2
    v_lshlrev_b32 v25, 7, v25
    s_movk_i32 s54, 5120
    v_mad_u32_u24 v25, v5, s54, v25
    v_add_u32 v25, 112640, v25
    s_movk_i32 s0, 896
    s_mul_i32 s61, s3, 160
    v_and_b32 v27, 3, v1
    s_cmp_lt_u32 s2, 120
    s_cbranch_scc0 L5
    v_lshl_add_u32 v26, v27, 3, s61
    v_lshrrev_b32 v68, 7, v26
    v_mad_u32_u24 v68, v68, s0, v26
    v_add_u32 v68, v68, v25
    v_add_u32 v26, 40, v26
    v_lshrrev_b32 v69, 7, v26
    v_mad_u32_u24 v69, v69, s0, v26
    v_add_u32 v69, v69, v25
    v_add_u32 v26, 40, v26
    v_lshrrev_b32 v70, 7, v26
    v_mad_u32_u24 v70, v70, s0, v26
    v_add_u32 v70, v70, v25
    v_add_u32 v26, 40, v26
    v_lshrrev_b32 v71, 7, v26
    v_mad_u32_u24 v71, v71, s0, v26
    v_add_u32 v71, v71, v25
    s_add_u32 s61, s61, 32
    v_mov_b32 v26, s61
    v_mad_u32_u24 v26, v27, 40, v26
    v_lshrrev_b32 v72, 7, v26
    v_mad_u32_u24 v72, v72, s0, v26
    v_add_u32 v72, v72, v25
    v_lshl_add_u32 v28, v5, 3, v18
    v_lshlrev_b32 v28, 4, v28
    v_and_b32 v27, 1, v19
    s_mov_b32 s54, 153600
    v_mad_u32_u24 v28, v27, s54, v28
    s_and_b32 s54, s21, 1
    s_lshl_b32 s54, s54, 2
    s_add_u32 s54, s54, s3
    s_mul_i32 s54, s54, 307200
    s_add_u32 s54, s54, 0xf80000
    s_lshr_b32 s21, s21, 1
    s_mul_i32 s55, s20, 5632
    s_add_u32 s55, s55, s54
    s_lshl_b32 s22, s21, 9
    s_add_u32 s22, s22, s55
    s_add_u32 s22, s22, 4096
    s_lshl_b32 s61, s21, 11
    s_add_u32 s55, s55, s61
    s_sub_u32 s55, s55, 2048
    s_lshl_b32 s20, s20, 11
    s_add_u32 s54, s54, s20
    s_add_u32 s54, s54, 112640
    s_cmp_eq_u32 s21, 0
    s_cselect_b32 s54, s54, s55
    s_add_u32 s55, s54, 153600
    s_branch L_joinQ
L5:
    v_mov_b32 v26, s61
    v_mad_u32_u24 v26, v27, 40, v26
    v_lshrrev_b32 v68, 7, v26
    v_mad_u32_u24 v68, v68, s0, v26
    v_add_u32 v68, v68, v25
    v_add_u32 v26, 8, v26
    v_lshrrev_b32 v69, 7, v26
    v_mad_u32_u24 v69, v69, s0, v26
    v_add_u32 v69, v69, v25
    v_add_u32 v26, 8, v26
    v_lshrrev_b32 v70, 7, v26
    v_mad_u32_u24 v70, v70, s0, v26
    v_add_u32 v70, v70, v25
    v_add_u32 v26, 8, v26
    v_lshrrev_b32 v71, 7, v26
    v_mad_u32_u24 v71, v71, s0, v26
    v_add_u32 v71, v71, v25
    v_add_u32 v26, 8, v26
    v_lshrrev_b32 v72, 7, v26
    v_mad_u32_u24 v72, v72, s0, v26
    v_add_u32 v72, v72, v25
    v_mov_b32 v28, v2
    s_lshl_b32 s54, s21, 2
    s_add_u32 s54, s54, s3
    s_mul_i32 s54, s54, 20
    s_add_u32 s54, s54, s20
    s_mul_i32 s54, s54, 5120
    s_add_u32 s54, s54, 0x1200000
    s_add_u32 s55, s54, 2048
    s_add_u32 s22, s54, 4096
L_joinQ:
    s_waitcnt vmcnt(4)
    s_barrier
    ds_read_b64_tr_b16 v[128:129], v68
    ds_read_b64_tr_b16 v[130:131], v68 offset:512
    ds_read_b64_tr_b16 v[132:133], v69
    ds_read_b64_tr_b16 v[134:135], v69 offset:512
    ds_read_b64_tr_b16 v[136:137], v70
    ds_read_b64_tr_b16 v[138:139], v70 offset:512
    ds_read_b64_tr_b16 v[140:141], v71
    ds_read_b64_tr_b16 v[142:143], v71 offset:512
    ds_read_b64_tr_b16 v[144:145], v72
    ds_read_b64_tr_b16 v[146:147], v72 offset:512
    s_waitcnt lgkmcnt(8)
    buffer_store_dwordx4 v[128:131], v2, s[8:11], s54 offen offset:0 sc1
    s_waitcnt lgkmcnt(6)
    buffer_store_dwordx4 v[132:135], v2, s[8:11], s54 offen offset:1024 sc1
    s_waitcnt lgkmcnt(4)
    buffer_store_dwordx4 v[136:139], v2, s[8:11], s55 offen offset:0 sc1
    s_waitcnt lgkmcnt(2)
    buffer_store_dwordx4 v[140:143], v2, s[8:11], s55 offen offset:1024 sc1
    s_waitcnt lgkmcnt(0)
    buffer_store_dwordx4 v[144:147], v28, s[8:11], s22 offen sc1
L_joinS:
    s_mov_b32 s47, 1280
    s_mov_b32 s100, 128
    s_mov_b32 s101, 640
    s_mov_b32 s97, 1024
    s_mov_b32 s96, 40
    s_mov_b32 s95, 8
    s_mov_b32 s31, 4
    s_and_b32 s54, s2, 1
    s_mul_i32 s99, s54, 640
    s_lshl_b32 s54, s54, 2
    s_cmp_ge_u32 s2, 108
    s_cbranch_scc1 L7
    s_mov_b32 s16, s36
    s_mov_b32 s17, s37
    s_mov_b32 s18, 0x21c000
    s_mov_b32 s19, 0x20000
    s_mov_b32 s94, 282624
    s_lshr_b32 s55, s2, 1
    s_lshl_b32 s30, s55, 5
    s_cmp_ge_u32 s55, 45
    s_addc_u32 s0, s55, 0
    s_cmp_ge_u32 s55, 51
    s_addc_u32 s0, s0, 0
    s_mul_i32 s98, s54, 56
    s_add_u32 s98, s98, s0
    s_mul_i32 s98, s98, 5120
    s_add_u32 s98, s98, 0x1540000
    s_mul_i32 s55, s0, 37
    s_lshr_b32 s55, s55, 8
    s_mul_i32 s55, s55, 7
    s_sub_u32 s55, s0, s55
    s_cmp_eq_u32 s55, 3
    s_cselect_b32 s31, 8, 4
    s_cselect_b32 s46, 4, 16
    s_branch L9
L7:
    s_mov_b32 s16, s32
    s_mov_b32 s17, s33
    s_mov_b32 s18, 0x21c000
    s_mov_b32 s19, 0x20000
    s_mov_b32 s94, 20480
    s_mov_b32 s100, 32
    s_mov_b32 s47, 3456
    s_mov_b32 s97, 20480
    s_mov_b32 s96, 8
    s_mov_b32 s95, 32
    s_mov_b32 s31, 20
    s_sub_u32 s54, s2, 108
    s_min_u32 s54, s54, 99
    s_mul_i32 s55, s54, 205
    s_lshr_b32 s55, s55, 10
    s_mul_i32 s0, s55, 5
    s_sub_u32 s54, s54, s0
    s_cmp_ge_u32 s54, 3
    s_cselect_b32 s101, 768, s101
    s_cmp_eq_u32 s54, 4
    s_mul_i32 s54, s54, 5
    s_addc_u32 s54, s54, 0
    s_lshl_b32 s99, s54, 7
    s_lshl_b32 s54, s54, 2
    s_mul_i32 s98, s54, 20
    s_add_u32 s98, s98, s55
    s_lshl_b32 s98, s98, 10
    s_add_u32 s98, s98, 0x1300000
    s_mul_i32 s54, s55, 205
    s_lshr_b32 s54, s54, 10
    s_mul_i32 s0, s54, 5
    s_sub_u32 s55, s55, s0
    s_mul_i32 s30, s54, 160
    s_cmp_eq_u32 s55, 4
    s_cbranch_scc1 L8
    s_mov_b32 s46, 4
    s_lshr_b32 s54, s55, 1
    s_mul_i32 s54, s54, 80
    s_add_u32 s30, s30, s54
    s_and_b32 s54, s55, 1
    s_lshl_b32 s54, s54, 3
    s_add_u32 s30, s30, s54
    s_branch L9
L8:
    s_mov_b32 s31, 40
    s_mov_b32 s46, 20
    s_add_u32 s30, s30, 16
L9:
    s_cmp_lt_u32 s2, 208
    s_cselect_b32 s18, s18, 0
    s_cselect_b32 s98, s98, 0x7efffff0
    s_mul_i32 s54, s31, s3
    s_add_u32 s54, s54, s30
    s_mul_i32 s54, s54, s47
    s_add_u32 s99, s99, s54
    v_lshrrev_b32 v238, 2, v19
    v_and_b32 v237, 3, v19
    v_mad_u32_u24 v237, v238, s46, v237
    v_mul_u32_u24 v237, s47, v237
    v_lshl_add_u32 v237, v18, 4, v237
    s_lshr_b32 s55, s101, 7
    s_sub_u32 s55, s55, 1
    s_mul_i32 s55, s55, s97
    s_add_u32 s55, s55, s94
    s_mul_i32 s55, s55, s3
    s_add_u32 s98, s98, s55
    v_and_b32 v238, 3, v1
    v_mul_u32_u24 v238, s96, v238
    s_lshr_b32 s54, s101, 2
    s_mul_i32 s54, s54, s3
    v_add_u32 v238, s54, v238
    s_mul_i32 s54, s97, 5
    s_add_u32 s54, s54, s98
    s_cmp_eq_u32 s101, 768
    s_cselect_b32 s47, s99, 0x40000000
    s_cselect_b32 s94, s54, 0x7ffffff0
    s_lshr_b32 s56, s50, 1
    s_lshl_b32 s56, s56, 2
    s_lshr_b32 s54, s51, 3
    s_add_u32 s56, s56, s54
    s_and_b32 s57, s50, 1
    s_lshl_b32 s57, s57, 3
    s_and_b32 s54, s51, 7
    s_add_u32 s57, s57, s54
    s_mul_i32 s58, s57, 153600
    s_add_u32 s58, s58, 0xf80000
    s_lshl_b32 s63, s56, 3
    s_lshr_b32 s54, s3, 1
    s_lshl_b32 s54, s54, 2
    s_add_u32 s63, s63, s54
    s_and_b32 s54, s3, 1
    s_add_u32 s63, s63, s54
    s_mul_i32 s59, s63, 20480
    s_add_u32 s59, s59, 0x100000
    v_add_u32 v8, 40960, v2
    v_and_b32 v45, 7, v1
    v_bfe_u32 v46, v1, 3, 1
    v_lshl_add_u32 v10, v5, 3, v45
    v_lshlrev_b32 v10, 4, v10
    v_lshl_add_u32 v9, v46, 9, v10
    v_add_u32 v11, 56320, v2
    v_add_u32 v12, 112640, v2
    s_lshl_b32 s30, s50, 2
    s_lshr_b32 s54, s51, 3
    s_add_u32 s30, s30, s54
    s_and_b32 s31, s51, 7
    s_lshr_b32 s24, s30, 1
    s_mov_b32 s25, s57
    s_and_b32 s54, s25, 1
    s_mul_i32 s26, s25, 7
    s_add_u32 s26, s26, s54
    s_lshr_b32 s55, s25, 1
    s_mul_i32 s27, s55, 14
    s_add_u32 s27, s27, s54
    s_add_u32 s27, s27, 6
    s_mul_i32 s55, s25, 6
    s_add_u32 s55, s55, 12
    s_cmp_lt_u32 s25, 12
    s_cselect_b32 s26, s26, s55
    s_cselect_b32 s27, s27, s55
    s_add_u32 s28, s26, s3
    s_add_u32 s29, s3, 4
    s_min_u32 s29, s29, 6
    s_add_u32 s36, s28, 4
    s_cmp_ge_u32 s3, 2
    s_cselect_b32 s36, s27, s36
    s_lshr_b32 s54, s24, 2
    s_lshl_b32 s54, s54, 9
    s_and_b32 s55, s24, 3
    s_lshl_b32 s55, s55, 14
    s_add_u32 s26, s54, s55
    s_lshr_b32 s54, s56, 1
    s_lshl_b32 s54, s54, 8
    s_and_b32 s55, s56, 1
    s_lshl_b32 s55, s55, 15
    s_add_u32 s27, s54, s55
    s_mov_b32 s24, s56
    s_mul_i32 s37, s31, 102400
    s_mul_i32 s54, s3, 25600
    s_add_u32 s37, s37, s54
    s_add_u32 s37, s37, 0x1200000
    s_lshl_b32 s54, s56, 4
    s_add_u32 s54, s54, s57
    s_lshl_b32 s54, s54, 1
    s_and_b32 s55, s3, 1
    s_add_u32 s54, s54, s55
    s_lshl_b32 s54, s54, 11
    s_add_u32 s54, s54, 0x1800000
    s_sub_u32 s55, s54, 65536
    s_cmp_ge_u32 s3, 2
    s_cselect_b32 s32, s54, 0x40000000
    s_cselect_b32 s33, 0x40000000, s55
    s_cmp_lt_u32 s63, 2
    s_cselect_b32 s33, 0x40000000, s33
    s_mov_b32 s12, s42
    s_mov_b32 s13, s43
    s_mov_b32 s14, 0x4b0000
    s_mov_b32 s15, 0x20000
    s_and_b32 s54, s2, 3
    s_cmp_lt_u32 s2, 108
    s_cselect_b32 s55, 20, -5
    s_lshr_b32 s60, s2, 2
    s_add_u32 s55, s60, s55
    s_mul_i32 s101, s54, 1228800
    s_mul_i32 s60, s3, 307200
    s_add_u32 s101, s101, s60
    s_lshl_b32 s60, s55, 7
    s_add_u32 s101, s101, s60
    s_mul_i32 s96, s54, 15360
    s_lshl_b32 s60, s55, 8
    s_add_u32 s96, s96, s60
    s_lshl_b32 s60, s3, 6
    s_add_u32 s96, s96, s60
    s_add_u32 s96, s96, 0x20000
    s_sub_u32 s54, s2, 108
    s_cmp_ge_u32 s54, 100
    s_cselect_b32 s96, s96, 0x40000000
    v_mul_u32_u24 v240, 7680, v19
    v_lshl_add_u32 v240, v18, 4, v240
    s_lshl_b32 s46, s30, 2
    s_add_u32 s46, s46, s3
    s_sub_u32 s54, s2, 108
    s_cmp_lt_u32 s54, 100
    s_cbranch_scc0 L10
    s_mul_i32 s54, s3, 6144
    s_add_u32 m0, s54, 133120
    s_nop 0
    buffer_load_dwordx4 v237, s[16:19], s99 offen offset:0 nt lds
    s_add_u32 m0, m0, 896
    s_nop 0
    buffer_load_dwordx4 v237, s[16:19], s99 offen offset:128 nt lds
    s_add_u32 m0, m0, 896
    s_nop 0
    buffer_load_dwordx4 v237, s[16:19], s99 offen offset:256 nt lds
    s_add_u32 m0, m0, 896
    s_nop 0
    buffer_load_dwordx4 v237, s[16:19], s99 offen offset:384 nt lds
    s_add_u32 m0, m0, 896
    s_nop 0
    buffer_load_dwordx4 v237, s[16:19], s99 offen offset:512 nt lds
    s_add_u32 m0, m0, 896
    s_nop 0
    buffer_load_dwordx4 v237, s[16:19], s47 offen offset:640 nt lds
    s_branch L_join2
L10:
    s_mul_i32 s54, s3, 5120
    s_add_u32 m0, s54, 133120
    s_nop 0
    buffer_load_dwordx4 v240, s[12:15], s101 offen nt lds
    s_add_u32 m0, m0, 1024
    s_add_u32 s101, s101, 61440
    buffer_load_dwordx4 v240, s[12:15], s101 offen nt lds
    s_add_u32 m0, m0, 1024
    s_add_u32 s101, s101, 61440
    buffer_load_dwordx4 v240, s[12:15], s101 offen nt lds
    s_add_u32 m0, m0, 1024
    s_add_u32 s101, s101, 61440
    buffer_load_dwordx4 v240, s[12:15], s101 offen nt lds
    s_add_u32 m0, m0, 1024
    s_add_u32 s101, s101, 61440
    buffer_load_dwordx4 v240, s[12:15], s101 offen nt lds
    buffer_load_dword v22, v15, s[8:11], 0 offen
L_join2:
    s_cmp_lt_u32 s2, 108
    s_cselect_b32 s18, s18, 0
    s_cselect_b32 s101, s98, 0x7efffff0
    s_cselect_b32 s98, 0x7efffff0, s98
    v_and_b32 v205, 0xffff0000, v250
    v_lshlrev_b32 v206, 16, v251
    v_and_b32 v207, 0xffff0000, v251
    v_lshlrev_b32 v208, 16, v252
    v_and_b32 v209, 0xffff0000, v252
    v_lshlrev_b32 v210, 16, v253
    v_and_b32 v211, 0xffff0000, v253
    v_lshlrev_b32 v212, 16, v254
    v_and_b32 v213, 0xffff0000, v254
    v_lshlrev_b32 v214, 16, v255
    v_and_b32 v215, 0xffff0000, v255
    v_lshlrev_b32 v216, 16, v232
    v_and_b32 v217, 0xffff0000, v232
    v_lshlrev_b32 v218, 16, v233
    v_and_b32 v219, 0xffff0000, v233
    s_lshl_b32 s54, s3, 3
    s_lshr_b32 s54, 0x24180c00, s54
    s_and_b32 s54, s54, 0xff
    s_mul_i32 s55, s3, 6
    s_add_u32 s55, s55, 24
    v_cmp_gt_u32 vcc, 12, v1
    v_mov_b32 v20, s54
    v_mov_b32 v21, s55
    v_cndmask_b32 v20, v21, v20, vcc
    v_add_u32 v20, v20, v1
    v_min_u32 v20, 59, v20
    s_lshr_b32 s54, s57, 3
    s_lshl_b32 s54, s54, 8
    s_add_u32 s54, s54, 0x10080
    v_lshl_add_u32 v20, v20, 9, s54
    s_lshr_b32 s55, s31, 2
    s_mul_i32 s54, s3, 10
    s_add_u32 s54, s54, s55
    s_lshl_b32 s54, s54, 8
    s_add_u32 s54, s54, 0x1a480
    v_min_u32 v21, 22, v1
    v_cmp_le_u32 vcc, 18, v1
    v_lshl_add_u32 v21, v21, 9, s54
    s_nop 0
    v_cndmask_b32 v20, v20, v21, vcc
    v_min_u32 v103, 39, v1
    v_cmp_lt_u32 vcc, 19, v103
    v_lshlrev_b32 v103, 4, v103
    v_mov_b32 v102, 2240
    s_mul_i32 s54, s50, 61440
    v_cndmask_b32 v102, 0, v102, vcc
    v_cndmask_b32 v100, 0, 1.0, vcc
    s_mul_i32 s55, s31, 320
    s_add_u32 s54, s54, s55
    v_add3_u32 v102, v102, v103, s54
    v_add_u32 v103, 157696, v103
    v_mul_u32_u24 v104, 80, v5
    v_add_u32 v104, 157696, v104
    v_bfe_i32 v94, v5, 0, 1
    v_lshlrev_b32 v13, 7, v5
    v_and_b32 v94, 0x7feffff0, v94
    v_lshl_add_u32 v13, v4, 4, v13
    v_add_u32 v13, v94, v13
    s_mul_i32 s20, s46, 20480
    s_lshr_b32 s55, s31, 1
    s_mul_i32 s55, s55, 5120
    s_add_u32 s20, s20, s55
    s_add_u32 s20, s20, 0x100000
    s_and_b32 s54, s31, 1
    s_lshl_b32 s55, s54, 9
    s_add_u32 s21, s20, s55
    s_add_u32 s21, s21, 4096
    s_lshl_b32 s54, s54, 11
    s_add_u32 s20, s20, s54
    v_bfe_u32 v106, v14, 0, 8
    v_bfe_u32 v107, v14, 8, 8
    v_bfe_u32 v108, v14, 16, 8
    v_bfe_u32 v109, v14, 24, 8
    s_add_u32 s54, s1, 0x10080
    s_cmp_eq_u32 s3, 3
    s_cselect_b32 s54, s54, 0x7ffffff0
    s_waitcnt vmcnt(6)
    s_barrier
    buffer_store_dword v14, v15, s[8:11], s54 offen sc1
    s_waitcnt vmcnt(4)
    s_mov_b32 s55, 0x20000
    buffer_load_dwordx4 v[44:47], v102, s[8:11], s55 offen sc1
    s_mov_b32 s55, 0x23c00
    buffer_load_dwordx4 v[48:51], v102, s[8:11], s55 offen sc1
    s_mov_b32 s55, 0x27800
    buffer_load_dwordx4 v[52:55], v102, s[8:11], s55 offen sc1
    s_mov_b32 s55, 0x2b400
    buffer_load_dwordx4 v[56:59], v102, s[8:11], s55 offen sc1
    buffer_load_dwordx4 v[60:63], v2, s[8:11], s23 offen sc1
    buffer_load_dwordx4 v[64:67], v2, s[8:11], s23 offen offset:1024 sc1
    s_branch W0
L_wret:
    s_waitcnt vmcnt(0)
    v_xor_b32 v44, v106, v44
    v_xor_b32 v45, v107, v45
    v_xor_b32 v46, v108, v46
    v_xor_b32 v47, v109, v47
    v_xor_b32 v48, v106, v48
    v_xor_b32 v49, v107, v49
    v_xor_b32 v50, v108, v50
    v_xor_b32 v51, v109, v51
    v_xor_b32 v52, v106, v52
    v_xor_b32 v53, v107, v53
    v_xor_b32 v54, v108, v54
    v_xor_b32 v55, v109, v55
    v_xor_b32 v56, v106, v56
    v_xor_b32 v57, v107, v57
    v_xor_b32 v58, v108, v58
    v_xor_b32 v59, v109, v59
    v_xor_b32 v62, s52, v62
    v_xor_b32 v66, s52, v66
    v_or3_b32 v94, v44, v45, v46
    v_or3_b32 v95, v47, v48, v49
    v_or3_b32 v95, v95, v50, v51
    v_or3_b32 v94, v94, v52, v53
    v_or3_b32 v95, v95, v54, v55
    v_or3_b32 v94, v94, v56, v57
    v_or3_b32 v95, v95, v58, v59
    v_or_b32 v94, v94, v95
    v_and_b32 v94, 0xff, v94
    v_or3_b32 v94, v94, v62, v66
    v_cmp_ne_u32 vcc, 0, v94
    s_nop 0
    s_cmp_lg_u64 vcc, 0
    s_cbranch_scc1 L11
L12:
    buffer_load_dword v21, v20, s[8:11], 0 offen sc1
    v_pk_add_f32 v[44:45], v[44:45], v[48:49]
    v_pk_add_f32 v[46:47], v[46:47], v[50:51]
    v_pk_add_f32 v[52:53], v[52:53], v[56:57]
    v_pk_add_f32 v[54:55], v[54:55], v[58:59]
    v_pk_add_f32 v[44:45], v[44:45], v[52:53]
    v_pk_add_f32 v[46:47], v[46:47], v[54:55]
    v_cvt_pk_bf16_f32 v44, 0, v44
    v_cvt_pk_bf16_f32 v45, 0, v45
    v_cvt_pk_bf16_f32 v46, 0, v46
    v_cvt_pk_bf16_f32 v47, 0, v47
    v_add_f32 v44, v100, v44
    v_add_f32 v45, v100, v45
    v_add_f32 v46, v100, v46
    v_add_f32 v47, v100, v47
    v_cvt_pk_bf16_f32 v44, 0, v44
    v_cvt_pk_bf16_f32 v45, 0, v45
    v_cvt_pk_bf16_f32 v46, 0, v46
    v_cvt_pk_bf16_f32 v47, 0, v47
    ds_write_b128 v103, v[44:47] offset:0
    ds_read_b128 v[128:131], v104 offset:0
    ds_read_b128 v[132:135], v104 offset:320
    ds_read_b128 v[136:139], v104 offset:16
    ds_read_b128 v[140:143], v104 offset:336
    ds_read_b128 v[144:147], v104 offset:32
    ds_read_b128 v[148:151], v104 offset:352
    ds_read_b128 v[152:155], v104 offset:48
    ds_read_b128 v[156:159], v104 offset:368
    ds_read_b128 v[160:163], v104 offset:64
    ds_read_b128 v[164:167], v104 offset:384
    v_pk_add_f32 v[60:61], v[60:61], v[64:65]
    v_mov_b32 v94, v60
    v_mov_b32 v95, v61
    s_nop 0
    v_permlane16_swap_b32 v60, v94
    v_permlane16_swap_b32 v61, v95
    v_add_f32 v60, v60, v94
    v_add_f32 v61, v61, v95
    v_mov_b32 v94, v60
    v_mov_b32 v95, v61
    s_nop 0
    v_permlane32_swap_b32 v60, v94
    v_permlane32_swap_b32 v61, v95
    v_add_f32 v60, v60, v94
    v_add_f32 v61, v61, v95
    v_mul_f32 v60, 0x3acccccd, v60
    v_mul_f32 v61, 0x3acccccd, v61
    v_fma_f32 v61, -v60, v60, v61
    v_max_f32 v61, 0, v61
    v_add_f32 v61, 0x3727c5ac, v61
    v_rsq_f32 v61, v61
    s_nop 0
    v_mul_f32 v60, -v60, v61
    v_pk_fma_f32 v[200:201], v[200:201], v[60:61], v[60:61] op_sel:[0,1,0] op_sel_hi:[1,1,0]
    v_pk_fma_f32 v[202:203], v[202:203], v[60:61], v[60:61] op_sel:[0,1,0] op_sel_hi:[1,1,0]
    v_pk_fma_f32 v[204:205], v[204:205], v[60:61], v[60:61] op_sel:[0,1,0] op_sel_hi:[1,1,0]
    v_pk_fma_f32 v[206:207], v[206:207], v[60:61], v[60:61] op_sel:[0,1,0] op_sel_hi:[1,1,0]
    v_pk_fma_f32 v[208:209], v[208:209], v[60:61], v[60:61] op_sel:[0,1,0] op_sel_hi:[1,1,0]
    v_pk_fma_f32 v[210:211], v[210:211], v[60:61], v[60:61] op_sel:[0,1,0] op_sel_hi:[1,1,0]
    v_pk_fma_f32 v[212:213], v[212:213], v[60:61], v[60:61] op_sel:[0,1,0] op_sel_hi:[1,1,0]
    v_pk_fma_f32 v[214:215], v[214:215], v[60:61], v[60:61] op_sel:[0,1,0] op_sel_hi:[1,1,0]
    v_pk_fma_f32 v[216:217], v[216:217], v[60:61], v[60:61] op_sel:[0,1,0] op_sel_hi:[1,1,0]
    v_pk_fma_f32 v[218:219], v[218:219], v[60:61], v[60:61] op_sel:[0,1,0] op_sel_hi:[1,1,0]
    s_waitcnt lgkmcnt(0)
    v_pk_fma_f32 v[216:217], v[216:217], v[164:165], v[160:161]
    v_pk_fma_f32 v[218:219], v[218:219], v[166:167], v[162:163]
    v_cvt_pk_bf16_f32 v76, v216, v217
    v_cvt_pk_bf16_f32 v77, v218, v219
    v_cvt_pk_bf16_f32 v78, v216, v217
    v_cvt_pk_bf16_f32 v79, v218, v219
    v_pk_fma_f32 v[200:201], v[200:201], v[132:133], v[128:129]
    v_pk_fma_f32 v[202:203], v[202:203], v[134:135], v[130:131]
    v_cvt_pk_bf16_f32 v68, v200, v201
    v_cvt_pk_bf16_f32 v69, v202, v203
    v_permlane16_swap_b32 v76, v78
    v_permlane16_swap_b32 v77, v79
    buffer_store_dwordx4 v[76:79], v13, s[8:11], s21 offen sc1
    v_pk_fma_f32 v[204:205], v[204:205], v[140:141], v[136:137]
    v_pk_fma_f32 v[206:207], v[206:207], v[142:143], v[138:139]
    v_cvt_pk_bf16_f32 v70, v204, v205
    v_cvt_pk_bf16_f32 v71, v206, v207
    buffer_store_dwordx4 v[68:71], v2, s[8:11], s20 offen offset:0 sc1
    v_pk_fma_f32 v[208:209], v[208:209], v[148:149], v[144:145]
    v_pk_fma_f32 v[210:211], v[210:211], v[150:151], v[146:147]
    v_cvt_pk_bf16_f32 v72, v208, v209
    v_cvt_pk_bf16_f32 v73, v210, v211
    v_pk_fma_f32 v[212:213], v[212:213], v[156:157], v[152:153]
    v_pk_fma_f32 v[214:215], v[214:215], v[158:159], v[154:155]
    v_cvt_pk_bf16_f32 v74, v212, v213
    v_cvt_pk_bf16_f32 v75, v214, v215
    buffer_store_dwordx4 v[72:75], v2, s[8:11], s20 offen offset:1024 sc1
    s_mul_i32 s54, s3, 22528
    s_mov_b32 m0, s54
    s_add_u32 s61, s54, s58
    s_add_u32 s54, s1, 0x10000
    s_cmp_eq_u32 s3, 0
    s_cselect_b32 s54, s54, 0x7ffffff0
    s_barrier
    s_waitcnt vmcnt(3)
    v_cmp_ne_u32 vcc, s52, v21
    s_nop 0
    s_cmp_eq_u64 vcc, 0
    s_cbranch_scc0 L13
    buffer_load_dwordx4 v2, s[8:11], s61 offen offset:0 sc1 lds
    buffer_load_dwordx4 v2, s[8:11], s61 offen offset:1024 sc1 lds
    buffer_load_dwordx4 v2, s[8:11], s61 offen offset:2048 sc1 lds
    buffer_load_dwordx4 v2, s[8:11], s61 offen offset:3072 sc1 lds
    s_add_u32 m0, m0, 4096
    s_add_u32 s61, s61, 4096
    buffer_load_dwordx4 v2, s[8:11], s61 offen offset:0 sc1 lds
    buffer_load_dwordx4 v2, s[8:11], s61 offen offset:1024 sc1 lds
    buffer_load_dwordx4 v2, s[8:11], s61 offen offset:2048 sc1 lds
    buffer_load_dwordx4 v2, s[8:11], s61 offen offset:3072 sc1 lds
    s_add_u32 m0, m0, 4096
    s_add_u32 s61, s61, 4096
    buffer_load_dwordx4 v2, s[8:11], s61 offen offset:0 sc1 lds
    buffer_load_dwordx4 v2, s[8:11], s61 offen offset:1024 sc1 lds
    s_waitcnt vmcnt(10)
    s_barrier
    buffer_store_dword v14, v15, s[8:11], s54 offen sc1
    s_branch L_joinE
L13:
    buffer_load_dword v21, v20, s[8:11], 0 offen sc1
    s_waitcnt vmcnt(1)
    s_barrier
    buffer_store_dword v14, v15, s[8:11], s54 offen sc1
    s_waitcnt vmcnt(1)
    v_cmp_ne_u32 vcc, s52, v21
    s_nop 0
    s_cmp_lg_u64 vcc, 0
    s_cbranch_scc1 L14
L15:
    buffer_load_dwordx4 v2, s[8:11], s61 offen offset:0 sc1 lds
    buffer_load_dwordx4 v2, s[8:11], s61 offen offset:1024 sc1 lds
    buffer_load_dwordx4 v2, s[8:11], s61 offen offset:2048 sc1 lds
    buffer_load_dwordx4 v2, s[8:11], s61 offen offset:3072 sc1 lds
    s_add_u32 m0, m0, 4096
    s_add_u32 s61, s61, 4096
    buffer_load_dwordx4 v2, s[8:11], s61 offen offset:0 sc1 lds
    buffer_load_dwordx4 v2, s[8:11], s61 offen offset:1024 sc1 lds
    buffer_load_dwordx4 v2, s[8:11], s61 offen offset:2048 sc1 lds
    buffer_load_dwordx4 v2, s[8:11], s61 offen offset:3072 sc1 lds
    s_add_u32 m0, m0, 4096
    s_add_u32 s61, s61, 4096
    buffer_load_dwordx4 v2, s[8:11], s61 offen offset:0 sc1 lds
    buffer_load_dwordx4 v2, s[8:11], s61 offen offset:1024 sc1 lds
L_joinE:
    v_bfe_u32 v147, v1, 2, 2
    v_lshlrev_b32 v147, 7, v147
    s_movk_i32 s0, 6144
    v_mad_u32_u24 v147, v5, s0, v147
    s_cmp_lt_u32 s2, 108
    s_cselect_b32 s0, 0, 133120
    v_add_u32 v147, s0, v147
    s_movk_i32 s0, 896
    v_lshrrev_b32 v6, 7, v238
    v_mad_u32_u24 v6, v6, s0, v238
    v_add_u32 v238, s95, v238
    v_add_u32 v6, v6, v147
    v_lshrrev_b32 v7, 7, v238
    v_mad_u32_u24 v7, v7, s0, v238
    v_add_u32 v238, s95, v238
    v_add_u32 v7, v7, v147
    v_lshrrev_b32 v240, 7, v238
    v_mad_u32_u24 v240, v240, s0, v238
    v_add_u32 v238, s95, v238
    v_add_u32 v240, v240, v147
    v_lshrrev_b32 v241, 7, v238
    v_mad_u32_u24 v241, v241, s0, v238
    v_add_u32 v238, s95, v238
    v_add_u32 v241, v241, v147
    v_lshrrev_b32 v242, 7, v238
    v_mad_u32_u24 v242, v242, s0, v238
    v_add_u32 v238, s95, v238
    v_add_u32 v242, v242, v147
    v_lshrrev_b32 v146, 7, v238
    v_mad_u32_u24 v146, v146, s0, v238
    v_add_u32 v146, v146, v147
    v_bfe_u32 v132, v1, 2, 2
    v_lshl_add_u32 v132, v5, 3, v132
    v_and_b32 v133, 3, v1
    v_lshlrev_b32 v132, 7, v132
    v_lshl_add_u32 v132, v133, 3, v132
    s_lshl_b32 s0, s3, 5
    s_add_u32 s0, s0, 133120
    v_add_u32 v132, s0, v132
    v_add_u32 v133, 0x07060500, v133
    v_lshl_add_u32 v134, v5, 4, v40
    v_lshlrev_b32 v135, 28, v5
    v_lshl_add_u32 v135, v4, 2, v135
    ds_read_b128 v[112:115], v134 offset:5696
    ds_read_b128 v[116:119], v134 offset:5760
    ds_read_b128 v[120:123], v134 offset:5824
    ds_read_b128 v[124:127], v134 offset:5888
    ds_read_b128 v[128:131], v134 offset:5952
    s_sub_u32 s0, s2, 108
    s_cmp_lt_u32 s0, 100
    s_cbranch_scc0 L17
    ds_read_b64_tr_b16 v[172:173], v6
    ds_read_b64_tr_b16 v[174:175], v6 offset:512
    ds_read_b64_tr_b16 v[176:177], v7
    ds_read_b64_tr_b16 v[178:179], v7 offset:512
    ds_read_b64_tr_b16 v[180:181], v240
    ds_read_b64_tr_b16 v[182:183], v240 offset:512
    ds_read_b64_tr_b16 v[184:185], v241
    ds_read_b64_tr_b16 v[186:187], v241 offset:512
    ds_read_b64_tr_b16 v[188:189], v242
    ds_read_b64_tr_b16 v[190:191], v242 offset:512
    ds_read_b64_tr_b16 v[192:193], v146
    ds_read_b64_tr_b16 v[194:195], v146 offset:512
    s_branch L16
L17:
    ds_read_b64_tr_b16 v[200:201], v132 offset:0
    ds_read_b64_tr_b16 v[202:203], v132 offset:512
    ds_read_b64_tr_b16 v[204:205], v132 offset:4096
    ds_read_b64_tr_b16 v[206:207], v132 offset:4608
    ds_read_b64_tr_b16 v[208:209], v132 offset:8192
    ds_read_b64_tr_b16 v[210:211], v132 offset:8704
    ds_read_b64_tr_b16 v[212:213], v132 offset:12288
    ds_read_b64_tr_b16 v[214:215], v132 offset:12800
    ds_read_b64_tr_b16 v[216:217], v132 offset:16384
    ds_read_b64_tr_b16 v[218:219], v132 offset:16896
    s_waitcnt lgkmcnt(8)
    v_mfma_f32_16x16x32_bf16 v[228:231], v[112:115], v[200:203], 0
    s_waitcnt lgkmcnt(6)
    v_mfma_f32_16x16x32_bf16 v[228:231], v[116:119], v[204:207], v[228:231]
    s_waitcnt lgkmcnt(4)
    v_mfma_f32_16x16x32_bf16 v[228:231], v[120:123], v[208:211], v[228:231]
    s_waitcnt lgkmcnt(2)
    v_mfma_f32_16x16x32_bf16 v[228:231], v[124:127], v[212:215], v[228:231]
    s_waitcnt lgkmcnt(0)
    v_mfma_f32_16x16x32_bf16 v[228:231], v[128:131], v[216:219], v[228:231]
L16:
    s_nop 7
    v_perm_b32 v228, v228, v14, v133
    buffer_store_dword v228, v135, s[8:11], s96 offen sc1
    s_cmp_ge_u32 s3, 2
    s_cbranch_scc0 L18
    v_not_b32 v128, v14
    v_not_b32 v129, v14
    v_not_b32 v130, v14
    v_not_b32 v131, v14
    buffer_store_dwordx4 v[128:131], v2, s[8:11], s32 offen offset:0 sc1
    buffer_store_dwordx4 v[128:131], v2, s[8:11], s32 offen offset:1024 sc1
L18:
    s_cmp_lg_u32 s3, 3
    s_cbranch_scc0 L19
    buffer_load_dwordx4 v2, s[8:11], s61 offen offset:2048 sc1 lds
    buffer_load_dwordx4 v2, s[8:11], s61 offen offset:3072 sc1 lds
    s_add_u32 m0, m0, 4096
    s_add_u32 s61, s61, 4096
    buffer_load_dwordx4 v2, s[8:11], s61 offen offset:0 sc1 lds
    buffer_load_dwordx4 v2, s[8:11], s61 offen offset:1024 sc1 lds
    buffer_load_dwordx4 v2, s[8:11], s61 offen offset:2048 sc1 lds
    buffer_load_dwordx4 v2, s[8:11], s61 offen offset:3072 sc1 lds
    s_add_u32 m0, m0, 4096
    s_add_u32 s61, s61, 4096
    buffer_load_dwordx4 v2, s[8:11], s61 offen offset:0 sc1 lds
    buffer_load_dwordx4 v2, s[8:11], s61 offen offset:1024 sc1 lds
    buffer_load_dwordx4 v2, s[8:11], s61 offen offset:2048 sc1 lds
    buffer_load_dwordx4 v2, s[8:11], s61 offen offset:3072 sc1 lds
    s_add_u32 m0, m0, 4096
    s_add_u32 s61, s61, 4096
    buffer_load_dwordx4 v2, s[8:11], s61 offen offset:0 sc1 lds
    buffer_load_dwordx4 v2, s[8:11], s61 offen offset:1024 sc1 lds
    s_branch L_joinH
L19:
    s_add_u32 s54, s27, 0x10000
    v_lshl_add_u32 v20, v4, 11, s54
    buffer_load_dwordx4 v2, s[8:11], s61 offen offset:2048 sc1 lds
    buffer_load_dwordx4 v2, s[8:11], s61 offen offset:3072 sc1 lds
    s_add_u32 m0, m0, 4096
    s_add_u32 s61, s61, 4096
    buffer_load_dwordx4 v2, s[8:11], s61 offen offset:0 sc1 lds
    buffer_load_dwordx4 v2, s[8:11], s61 offen offset:1024 sc1 lds
    buffer_load_dwordx4 v2, s[8:11], s61 offen offset:2048 sc1 lds
    buffer_load_dwordx4 v2, s[8:11], s61 offen offset:3072 sc1 lds
    s_add_u32 m0, m0, 4096
    s_add_u32 s61, s61, 4096
    buffer_load_dwordx4 v2, s[8:11], s61 offen offset:0 sc1 lds
    buffer_load_dwordx4 v2, s[8:11], s61 offen offset:1024 sc1 lds
    buffer_load_dwordx4 v2, s[8:11], s61 offen offset:2048 sc1 lds
    buffer_load_dwordx4 v2, s[8:11], s61 offen offset:3072 sc1 lds
    s_mov_b32 s53, 200000
L20:
    buffer_load_dword v243, v20, s[8:11], 0 offen sc1
    s_waitcnt vmcnt(0)
    v_cmp_ne_u32 vcc, s52, v243
    s_nop 0
    s_cmp_eq_u64 vcc, 0
    s_cbranch_scc1 L21
    s_sub_u32 s53, s53, 1
    s_cmp_lg_u32 s53, 0
    s_cbranch_scc1 L20
L21:
L_joinH:
    s_waitcnt lgkmcnt(0)
    s_barrier
    buffer_load_dwordx4 a[96:99], v2, s[8:11], s59 offen offset:0 sc1
    buffer_load_dwordx4 a[100:103], v8, s[8:11], s59 offen offset:0 sc1
    buffer_load_dwordx4 a[104:107], v2, s[8:11], s59 offen offset:1024 sc1
    buffer_load_dwordx4 a[108:111], v8, s[8:11], s59 offen offset:1024 sc1
    buffer_load_dwordx4 a[112:115], v2, s[8:11], s59 offen offset:2048 sc1
    buffer_load_dwordx4 a[116:119], v8, s[8:11], s59 offen offset:2048 sc1
    buffer_load_dwordx4 a[120:123], v2, s[8:11], s59 offen offset:3072 sc1
    buffer_load_dwordx4 a[124:127], v8, s[8:11], s59 offen offset:3072 sc1
    s_add_u32 s59, s59, 4096
    buffer_load_dwordx4 a[128:131], v2, s[8:11], s59 offen offset:0 sc1
    buffer_load_dwordx4 a[132:135], v8, s[8:11], s59 offen offset:0 sc1
    buffer_load_dwordx4 a[136:139], v2, s[8:11], s59 offen offset:1024 sc1
    buffer_load_dwordx4 a[140:143], v8, s[8:11], s59 offen offset:1024 sc1
    buffer_load_dwordx4 a[144:147], v2, s[8:11], s59 offen offset:2048 sc1
    buffer_load_dwordx4 a[148:151], v8, s[8:11], s59 offen offset:2048 sc1
    buffer_load_dwordx4 a[152:155], v2, s[8:11], s59 offen offset:3072 sc1
    buffer_load_dwordx4 a[156:159], v8, s[8:11], s59 offen offset:3072 sc1
    s_mul_i32 s54, s3, 6144
    s_add_u32 s54, s54, 88064
    s_mov_b32 m0, s54
    s_add_u32 s61, s54, s58
    s_waitcnt vmcnt(16)
    s_barrier
    ds_read_b128 v[80:83], v2 offset:0
    ds_read_b128 v[84:87], v2 offset:1024
    ds_read_b128 v[88:91], v9 offset:4096
    ds_read_b128 v[92:95], v2 offset:2048
    ds_read_b128 v[96:99], v2 offset:3072
    ds_read_b128 v[100:103], v10 offset:5120
    ds_read_b128 v[104:107], v2 offset:5632
    ds_read_b128 v[108:111], v2 offset:6656
    s_waitcnt vmcnt(14) lgkmcnt(7)
    v_mfma_f32_16x16x32_bf16 v[24:27], v[80:83], a[96:99], 0
    buffer_load_dwordx4 v2, s[8:11], s61 offen offset:0 sc1 lds
    v_lshlrev_b32 v243, 2, v5
    v_mfma_f32_16x16x32_bf16 v[56:59], v[80:83], a[100:103], 0
    s_waitcnt lgkmcnt(6)
    ds_read_b128 v[80:83], v9 offset:9728
    v_sub_u32 v243, v4, v243
    v_mfma_f32_16x16x32_bf16 v[28:31], v[84:87], a[96:99], 0
    v_mov_b32 v244, 0xf149f2ca
    v_mfma_f32_16x16x32_bf16 v[60:63], v[84:87], a[100:103], 0
    s_waitcnt lgkmcnt(6)
    s_cmp_lt_u32 s63, 2
    s_cselect_b64 s[54:55], 0, -1
    v_mfma_f32_16x16x32_bf16 v[32:35], v[88:91], a[96:99], 0
    ds_read_b128 v[84:87], v2 offset:7680
    buffer_load_dwordx4 v2, s[8:11], s61 offen offset:1024 sc1 lds
    v_mfma_f32_16x16x32_bf16 v[64:67], v[88:91], a[100:103], 0
    s_waitcnt lgkmcnt(6)
    ds_read_b128 v[88:91], v2 offset:8704
    s_add_u32 s59, s59, 4096
    v_mfma_f32_16x16x32_bf16 v[36:39], a[96:99], v[92:95], 0
    v_subrev_u32 v245, 0, v243
    v_cmp_ge_u32 vcc, 7, v245
    v_mfma_f32_16x16x32_bf16 v[68:71], a[100:103], v[92:95], 0
    s_waitcnt lgkmcnt(6)
    ds_read_b128 v[92:95], v10 offset:10752
    v_ashrrev_i32 v246, 31, v245
    v_mfma_f32_16x16x32_bf16 v[40:43], a[96:99], v[96:99], 0
    buffer_load_dwordx4 a[160:163], v2, s[8:11], s59 offen offset:0 sc1
    v_cndmask_b32 v148, v244, 0, vcc
    v_mfma_f32_16x16x32_bf16 v[72:75], a[100:103], v[96:99], 0
    s_waitcnt lgkmcnt(6)
    ds_read_b128 v[96:99], v2 offset:11264
    v_cmp_ge_i32 vcc, -9, v245
    v_mfma_f32_16x16x32_bf16 v[44:47], a[96:99], v[100:103], 0
    v_mov_b32 v166, 0x3f803f80
    v_cndmask_b32 v152, v244, 0, vcc
    v_mfma_f32_16x16x32_bf16 v[76:79], a[100:103], v[100:103], 0
    s_waitcnt vmcnt(15) lgkmcnt(6)
    ds_read_b128 v[100:103], v2 offset:12288
    v_mov_b32 v115, s52
    v_mfma_f32_16x16x32_bf16 v[24:27], v[104:107], a[104:107], v[24:27]
    buffer_load_dwordx4 a[164:167], v8, s[8:11], s59 offen offset:0 sc1
    v_cndmask_b32 v156, v244, v152, s[54:55]
    v_mfma_f32_16x16x32_bf16 v[56:59], v[104:107], a[108:111], v[56:59]
    s_waitcnt lgkmcnt(6)
    ds_read_b128 v[104:107], v9 offset:15360
    v_subrev_u32 v245, 1, v243
    v_mfma_f32_16x16x32_bf16 v[28:31], v[108:111], a[104:107], v[28:31]
    v_cmp_ge_u32 vcc, 7, v245
    v_ashrrev_i32 v247, 31, v245
    v_mfma_f32_16x16x32_bf16 v[60:63], v[108:111], a[108:111], v[60:63]
    s_waitcnt lgkmcnt(6)
    ds_read_b128 v[108:111], v2 offset:13312
    v_cndmask_b32 v149, v244, 0, vcc
    v_mfma_f32_16x16x32_bf16 v[32:35], v[80:83], a[104:107], v[32:35]
    buffer_load_dwordx4 v2, s[8:11], s61 offen offset:2048 sc1 lds
    v_cmp_ge_i32 vcc, -9, v245
    v_mfma_f32_16x16x32_bf16 v[64:67], v[80:83], a[108:111], v[64:67]
    s_waitcnt lgkmcnt(6)
    ds_read_b128 v[80:83], v2 offset:14336
    v_mov_b32 v167, 0x3f803f80
    v_mfma_f32_16x16x32_bf16 v[36:39], a[104:107], v[84:87], v[36:39]
    v_cndmask_b32 v153, v244, 0, vcc
    v_mov_b32 v119, s52
    v_mfma_f32_16x16x32_bf16 v[68:71], a[108:111], v[84:87], v[68:71]
    s_waitcnt lgkmcnt(6)
    ds_read_b128 v[84:87], v10 offset:16384
    v_cndmask_b32 v157, v244, v153, s[54:55]
    v_mfma_f32_16x16x32_bf16 v[40:43], a[104:107], v[88:91], v[40:43]
    v_and_b32 v246, 0xffff, v246
    v_and_b32 v247, 0xffff0000, v247
    v_mfma_f32_16x16x32_bf16 v[72:75], a[108:111], v[88:91], v[72:75]
    s_waitcnt lgkmcnt(6)
    ds_read_b128 v[88:91], v2 offset:16896
    buffer_load_dwordx4 v2, s[8:11], s61 offen offset:3072 sc1 lds
    v_mfma_f32_16x16x32_bf16 v[44:47], a[104:107], v[92:95], v[44:47]
    v_or_b32 v162, v246, v247
    v_not_b32 v160, v162
    v_mfma_f32_16x16x32_bf16 v[76:79], a[108:111], v[92:95], v[76:79]
    s_waitcnt vmcnt(16) lgkmcnt(6)
    ds_read_b128 v[92:95], v2 offset:17920
    v_subrev_u32 v245, 2, v243
    v_mfma_f32_16x16x32_bf16 v[24:27], v[96:99], a[112:115], v[24:27]
    v_cmp_ge_u32 vcc, 7, v245
    v_ashrrev_i32 v246, 31, v245
    v_mfma_f32_16x16x32_bf16 v[56:59], v[96:99], a[116:119], v[56:59]
    s_waitcnt lgkmcnt(6)
    ds_read_b128 v[96:99], v9 offset:20992
    buffer_load_dwordx4 a[168:171], v2, s[8:11], s59 offen offset:1024 sc1
    v_mfma_f32_16x16x32_bf16 v[28:31], v[100:103], a[112:115], v[28:31]
    v_cndmask_b32 v150, v244, 0, vcc
    v_cmp_ge_i32 vcc, -9, v245
    v_mfma_f32_16x16x32_bf16 v[60:63], v[100:103], a[116:119], v[60:63]
    s_waitcnt lgkmcnt(6)
    ds_read_b128 v[100:103], v2 offset:18944
    v_mov_b32 v168, 0x3f803f80
    v_mfma_f32_16x16x32_bf16 v[32:35], v[104:107], a[112:115], v[32:35]
    v_cndmask_b32 v154, v244, 0, vcc
    v_mov_b32 v123, s52
    v_mfma_f32_16x16x32_bf16 v[64:67], v[104:107], a[116:119], v[64:67]
    s_waitcnt lgkmcnt(6)
    ds_read_b128 v[104:107], v2 offset:19968
    buffer_load_dwordx4 a[172:175], v8, s[8:11], s59 offen offset:1024 sc1
    v_mfma_f32_16x16x32_bf16 v[36:39], a[112:115], v[108:111], v[36:39]
    s_add_u32 m0, m0, 4096
    s_add_u32 s61, s61, 4096
    v_cndmask_b32 v158, v244, v154, s[54:55]
    v_mfma_f32_16x16x32_bf16 v[68:71], a[116:119], v[108:111], v[68:71]
    s_waitcnt lgkmcnt(6)
    ds_read_b128 v[108:111], v10 offset:22016
    v_subrev_u32 v245, 3, v243
    v_mfma_f32_16x16x32_bf16 v[40:43], a[112:115], v[80:83], v[40:43]
    v_cmp_ge_u32 vcc, 7, v245
    v_ashrrev_i32 v247, 31, v245
    v_mfma_f32_16x16x32_bf16 v[72:75], a[116:119], v[80:83], v[72:75]
    s_waitcnt lgkmcnt(6)
    ds_read_b128 v[80:83], v2 offset:22528
    buffer_load_dwordx4 v2, s[8:11], s61 offen offset:0 sc1 lds
    v_mfma_f32_16x16x32_bf16 v[44:47], a[112:115], v[84:87], v[44:47]
    v_cndmask_b32 v151, v244, 0, vcc
    v_cmp_ge_i32 vcc, -9, v245
    v_mfma_f32_16x16x32_bf16 v[76:79], a[116:119], v[84:87], v[76:79]
    s_waitcnt vmcnt(17) lgkmcnt(6)
    ds_read_b128 v[84:87], v2 offset:23552
    v_mov_b32 v169, 0x3f803f80
    v_mfma_f32_16x16x32_bf16 v[24:27], v[88:91], a[120:123], v[24:27]
    v_cndmask_b32 v155, v244, 0, vcc
    v_mov_b32 v127, s52
    v_mfma_f32_16x16x32_bf16 v[56:59], v[88:91], a[124:127], v[56:59]
    s_waitcnt lgkmcnt(6)
    ds_read_b128 v[88:91], v9 offset:26624
    buffer_load_dwordx4 v2, s[8:11], s61 offen offset:1024 sc1 lds
    v_mfma_f32_16x16x32_bf16 v[28:31], v[92:95], a[120:123], v[28:31]
    v_cndmask_b32 v159, v244, v155, s[54:55]
    v_and_b32 v246, 0xffff, v246
    v_mfma_f32_16x16x32_bf16 v[60:63], v[92:95], a[124:127], v[60:63]
    s_waitcnt lgkmcnt(6)
    ds_read_b128 v[92:95], v2 offset:24576
    v_and_b32 v247, 0xffff0000, v247
    v_mfma_f32_16x16x32_bf16 v[32:35], v[96:99], a[120:123], v[32:35]
    v_or_b32 v163, v246, v247
    v_not_b32 v161, v163
    v_mfma_f32_16x16x32_bf16 v[64:67], v[96:99], a[124:127], v[64:67]
    s_waitcnt lgkmcnt(6)
    ds_read_b128 v[96:99], v2 offset:25600
    v_cmp_eq_u32 vcc, 0, v5
    v_mfma_f32_16x16x32_bf16 v[36:39], a[120:123], v[100:103], v[36:39]
    buffer_load_dwordx4 a[176:179], v2, s[8:11], s59 offen offset:2048 sc1
    v_lshlrev_b32 v170, 4, v4
    v_mfma_f32_16x16x32_bf16 v[68:71], a[124:127], v[100:103], v[68:71]
    s_waitcnt lgkmcnt(6)
    ds_read_b128 v[100:103], v10 offset:27648
    v_cndmask_b32 v164, 0, -1, vcc
    v_mfma_f32_16x16x32_bf16 v[40:43], a[120:123], v[104:107], v[40:43]
    v_cmp_eq_u32 vcc, 1, v5
    v_lshl_add_u32 v170, v5, 3, v170
    v_mfma_f32_16x16x32_bf16 v[72:75], a[124:127], v[104:107], v[72:75]
    s_waitcnt lgkmcnt(6)
    ds_read_b128 v[104:107], v2 offset:28160
    v_cndmask_b32 v165, 0, -1, vcc
    v_mfma_f32_16x16x32_bf16 v[44:47], a[120:123], v[108:111], v[44:47]
    buffer_load_dwordx4 a[180:183], v8, s[8:11], s59 offen offset:2048 sc1
    v_cmp_gt_u32 vcc, 32, v1
    v_mfma_f32_16x16x32_bf16 v[76:79], a[124:127], v[108:111], v[76:79]
    s_waitcnt vmcnt(18) lgkmcnt(6)
    ds_read_b128 v[108:111], v2 offset:29184
    v_mov_b32 v245, 0x7ffffff0
    v_mfma_f32_16x16x32_bf16 v[24:27], v[80:83], a[128:131], v[24:27]
    v_cndmask_b32 v170, v245, v170, vcc
    s_lshl_b32 s40, s2, 2
    v_mfma_f32_16x16x32_bf16 v[56:59], v[80:83], a[132:135], v[56:59]
    s_waitcnt lgkmcnt(6)
    ds_read_b128 v[80:83], v9 offset:32256
    s_add_u32 s40, s40, 0x8000
    v_mfma_f32_16x16x32_bf16 v[28:31], v[84:87], a[128:131], v[28:31]
    s_cmp_eq_u32 s3, 0
    s_cselect_b32 s40, s40, 0x7ffffff0
    buffer_load_dwordx4 a[184:187], v2, s[8:11], s59 offen offset:3072 sc1
    v_mfma_f32_16x16x32_bf16 v[60:63], v[84:87], a[132:135], v[60:63]
    s_waitcnt lgkmcnt(6)
    s_cmp_lt_u32 s2, 108
    s_cselect_b32 s47, s40, 0x7ffffff0
    s_cselect_b32 s40, 0x7ffffff0, s40
    v_mfma_f32_16x16x32_bf16 v[32:35], v[88:91], a[128:131], v[32:35]
    ds_read_b128 v[84:87], v2 offset:30208
    v_and_b32 v145, 7, v4
    v_mfma_f32_16x16x32_bf16 v[64:67], v[88:91], a[132:135], v[64:67]
    s_waitcnt lgkmcnt(6)
    ds_read_b128 v[88:91], v2 offset:31232
    v_lshl_add_u32 v145, v5, 3, v145
    v_mfma_f32_16x16x32_bf16 v[36:39], a[128:131], v[92:95], v[36:39]
    buffer_load_dwordx4 a[188:191], v8, s[8:11], s59 offen offset:3072 sc1
    s_add_u32 s59, s59, 4096
    v_mfma_f32_16x16x32_bf16 v[68:71], a[132:135], v[92:95], v[68:71]
    s_waitcnt lgkmcnt(6)
    ds_read_b128 v[92:95], v10 offset:33280
    v_lshlrev_b32 v145, 4, v145
    v_mfma_f32_16x16x32_bf16 v[40:43], a[128:131], v[96:99], v[40:43]
    v_mov_b32 v245, 0x40000000
    v_add_u32 v234, 512, v2
    v_mfma_f32_16x16x32_bf16 v[72:75], a[132:135], v[96:99], v[72:75]
    s_waitcnt lgkmcnt(6)
    s_cmp_lt_u32 s33, 0x40000000
    s_cselect_b32 s54, s52, 0
    v_mfma_f32_16x16x32_bf16 v[44:47], a[128:131], v[100:103], v[44:47]
    ds_read_b128 v[96:99], v2 offset:33792
    buffer_load_dwordx4 a[192:195], v2, s[8:11], s59 offen offset:0 sc1
    v_mfma_f32_16x16x32_bf16 v[76:79], a[132:135], v[100:103], v[76:79]
    s_waitcnt vmcnt(19) lgkmcnt(6)
    ds_read_b128 v[100:103], v2 offset:34816
    v_cmp_lt_u32 vcc, 7, v4
    v_mfma_f32_16x16x32_bf16 v[24:27], v[104:107], a[136:139], v[24:27]
    v_mov_b32 v246, s54
    v_cndmask_b32 v145, v245, v145, vcc
    v_mfma_f32_16x16x32_bf16 v[56:59], v[104:107], a[140:143], v[56:59]
    s_waitcnt lgkmcnt(6)
    ds_read_b128 v[104:107], v9 offset:37888
    v_cndmask_b32 v235, 0, v246, vcc
    v_mfma_f32_16x16x32_bf16 v[28:31], v[108:111], a[136:139], v[28:31]
    v_cmp_lt_u32 vcc, 31, v1
    s_add_u32 s54, s3, 2
    v_mfma_f32_16x16x32_bf16 v[60:63], v[108:111], a[140:143], v[60:63]
    s_waitcnt lgkmcnt(6)
    ds_read_b128 v[108:111], v2 offset:35840
    buffer_load_dwordx4 a[196:199], v8, s[8:11], s59 offen offset:0 sc1
    v_mfma_f32_16x16x32_bf16 v[32:35], v[80:83], a[136:139], v[32:35]
    s_and_b32 s54, s54, 3
    v_cndmask_b32 v234, v245, v234, vcc
    v_cndmask_b32 v236, 0, v246, vcc
    v_mfma_f32_16x16x32_bf16 v[64:67], v[80:83], a[140:143], v[64:67]
    s_waitcnt lgkmcnt(6)
    ds_read_b128 v[80:83], v2 offset:36864
    s_lshl_b32 s54, s54, 12
    v_mfma_f32_16x16x32_bf16 v[36:39], a[136:139], v[84:87], v[36:39]
    s_add_u32 s54, s54, 77824
    v_add_u32 v171, s54, v2
    v_mfma_f32_16x16x32_bf16 v[68:71], a[140:143], v[84:87], v[68:71]
    s_waitcnt lgkmcnt(6)
    s_cmp_ge_u32 s3, 2
    s_cselect_b64 s[42:43], -1, 0
    v_mfma_f32_16x16x32_bf16 v[40:43], a[136:139], v[88:91], v[40:43]
    ds_read_b128 v[84:87], v10 offset:38912
    buffer_load_dwordx4 a[200:203], v2, s[8:11], s59 offen offset:1024 sc1
    v_mfma_f32_16x16x32_bf16 v[72:75], a[140:143], v[88:91], v[72:75]
    s_waitcnt lgkmcnt(6)
    ds_read_b128 v[88:91], v2 offset:39424
    v_min_u32 v243, 59, v1
    v_mfma_f32_16x16x32_bf16 v[44:47], a[136:139], v[92:95], v[44:47]
    v_cmp_gt_u32 vcc, 40, v243
    s_mul_i32 s54, s3, 640
    v_mfma_f32_16x16x32_bf16 v[76:79], a[140:143], v[92:95], v[76:79]
    s_waitcnt vmcnt(19) lgkmcnt(6)
    ds_read_b128 v[92:95], v2 offset:40448
    buffer_load_dwordx4 a[204:207], v8, s[8:11], s59 offen offset:1024 sc1
    v_mfma_f32_16x16x32_bf16 v[24:27], v[96:99], a[144:147], v[24:27]
    s_mul_i32 s55, s31, 320
    s_sub_u32 s55, s55, 3200
    v_mov_b32 v146, s55
    v_mfma_f32_16x16x32_bf16 v[56:59], v[96:99], a[148:151], v[56:59]
    s_waitcnt lgkmcnt(6)
    ds_read_b128 v[96:99], v9 offset:43520
    v_mov_b32 v147, s54
    v_mfma_f32_16x16x32_bf16 v[28:31], v[100:103], a[144:147], v[28:31]
    v_cndmask_b32 v146, v146, v147, vcc
    v_lshl_add_u32 v146, v243, 4, v146
    v_mfma_f32_16x16x32_bf16 v[60:63], v[100:103], a[148:151], v[60:63]
    s_waitcnt lgkmcnt(6)
    ds_read_b128 v[100:103], v2 offset:41472
    buffer_load_dwordx4 a[208:211], v2, s[8:11], s59 offen offset:2048 sc1
    v_mfma_f32_16x16x32_bf16 v[32:35], v[104:107], a[144:147], v[32:35]
    s_mul_i32 s54, s50, 10240
    s_add_u32 s54, s54, 0xe0a00
    v_add_u32 v146, s54, v146
    v_mfma_f32_16x16x32_bf16 v[64:67], v[104:107], a[148:151], v[64:67]
    s_waitcnt lgkmcnt(6)
    ds_read_b128 v[104:107], v2 offset:42496
    v_mov_b32 v147, 7680
    v_mfma_f32_16x16x32_bf16 v[36:39], a[144:147], v[108:111], v[36:39]
    v_mov_b32 v244, 2560
    v_cndmask_b32 v147, v147, v244, vcc
    v_mfma_f32_16x16x32_bf16 v[68:71], a[148:151], v[108:111], v[68:71]
    s_waitcnt lgkmcnt(6)
    ds_read_b128 v[108:111], v10 offset:44544
    buffer_load_dwordx4 a[212:215], v8, s[8:11], s59 offen offset:2048 sc1
    v_mfma_f32_16x16x32_bf16 v[40:43], a[144:147], v[80:83], v[40:43]
    v_add_u32 v147, v146, v147
    v_cndmask_b32 v144, 0, 1.0, vcc
    v_mfma_f32_16x16x32_bf16 v[72:75], a[148:151], v[80:83], v[72:75]
    s_waitcnt lgkmcnt(6)
    ds_read_b128 v[80:83], v2 offset:45056
    s_mul_i32 s54, s3, 320
    v_mfma_f32_16x16x32_bf16 v[44:47], a[144:147], v[84:87], v[44:47]
    v_mov_b32 v238, 1280
    v_mov_b32 v244, s54
    v_mfma_f32_16x16x32_bf16 v[76:79], a[148:151], v[84:87], v[76:79]
    s_waitcnt vmcnt(20) lgkmcnt(6)
    ds_read_b128 v[84:87], v2 offset:46080
    v_cndmask_b32 v238, v238, v244, vcc
    v_mfma_f32_16x16x32_bf16 v[24:27], v[88:91], a[152:155], v[24:27]
    buffer_load_dwordx4 a[216:219], v2, s[8:11], s59 offen offset:3072 sc1
    v_mul_u32_u24 v245, 205, v243
    v_mfma_f32_16x16x32_bf16 v[56:59], v[88:91], a[156:159], v[56:59]
    s_waitcnt lgkmcnt(6)
    ds_read_b128 v[88:91], v9 offset:49152
    v_lshrrev_b32 v245, 10, v245
    v_mfma_f32_16x16x32_bf16 v[28:31], v[92:95], a[152:155], v[28:31]
    v_mul_u32_u24 v246, 5, v245
    v_sub_u32 v246, v243, v246
    v_mfma_f32_16x16x32_bf16 v[60:63], v[92:95], a[156:159], v[60:63]
    s_waitcnt lgkmcnt(6)
    ds_read_b128 v[92:95], v2 offset:47104
    v_and_b32 v245, 7, v245
    v_mfma_f32_16x16x32_bf16 v[32:35], v[96:99], a[152:155], v[32:35]
    buffer_load_dwordx4 a[220:223], v8, s[8:11], s59 offen offset:3072 sc1
    s_add_u32 s59, s59, 4096
    v_mfma_f32_16x16x32_bf16 v[64:67], v[96:99], a[156:159], v[64:67]
    s_waitcnt lgkmcnt(6)
    ds_read_b128 v[96:99], v2 offset:48128
    v_and_b32 v247, 4, v245
    v_mfma_f32_16x16x32_bf16 v[36:39], a[152:155], v[100:103], v[36:39]
    s_barrier
    v_add_lshl_u32 v247, v247, v245, 4
    v_lshlrev_b32 v245, 3, v245
    v_mfma_f32_16x16x32_bf16 v[68:71], a[156:159], v[100:103], v[68:71]
    s_waitcnt lgkmcnt(6)
    ds_read_b128 v[100:103], v10 offset:50176
    v_cmp_eq_u32 vcc, 4, v246
    v_mfma_f32_16x16x32_bf16 v[40:43], a[152:155], v[104:107], v[40:43]
    buffer_load_dwordx4 a[224:227], v2, s[8:11], s59 offen offset:0 sc1
    v_and_b32 v244, 6, v246
    v_mfma_f32_16x16x32_bf16 v[72:75], a[156:159], v[104:107], v[72:75]
    s_waitcnt lgkmcnt(6)
    ds_read_b128 v[104:107], v2 offset:50688
    v_lshl_add_u32 v247, v244, 5, v247
    v_mfma_f32_16x16x32_bf16 v[44:47], a[152:155], v[108:111], v[44:47]
    v_and_b32 v246, 1, v246
    v_lshl_add_u32 v247, v246, 3, v247
    v_mfma_f32_16x16x32_bf16 v[76:79], a[156:159], v[108:111], v[76:79]
    s_waitcnt vmcnt(19) lgkmcnt(6)
    ds_read_b128 v[108:111], v2 offset:51712
    v_add_u32 v245, 256, v245
    v_mfma_f32_16x16x32_bf16 v[24:27], v[80:83], a[160:163], v[24:27]
    buffer_load_dwordx4 a[228:231], v8, s[8:11], s59 offen offset:0 sc1
    v_cndmask_b32 v247, v247, v245, vcc
    v_mfma_f32_16x16x32_bf16 v[56:59], v[80:83], a[164:167], v[56:59]
    s_waitcnt lgkmcnt(6)
    ds_read_b128 v[80:83], v9 offset:54784
    v_add_u32 v238, v247, v238
    v_mfma_f32_16x16x32_bf16 v[28:31], v[84:87], a[160:163], v[28:31]
    v_add_u32 v238, 153600, v238
    v_min_u32 v239, 384, v2
    v_mfma_f32_16x16x32_bf16 v[60:63], v[84:87], a[164:167], v[60:63]
    s_waitcnt lgkmcnt(6)
    ds_read_b128 v[84:87], v2 offset:52736
    v_add_u32 v239, 0x81b0, v239
    v_mfma_f32_16x16x32_bf16 v[32:35], v[88:91], a[160:163], v[32:35]
    buffer_load_dwordx4 a[232:235], v2, s[8:11], s59 offen offset:1024 sc1
    v_mfma_f32_16x16x32_bf16 v[64:67], v[88:91], a[164:167], v[64:67]
    s_waitcnt lgkmcnt(6)
    ds_read_b128 v[88:91], v2 offset:53760
    v_mfma_f32_16x16x32_bf16 v[36:39], a[160:163], v[92:95], v[36:39]
    v_mfma_f32_16x16x32_bf16 v[68:71], a[164:167], v[92:95], v[68:71]
    s_waitcnt lgkmcnt(6)
    ds_read_b128 v[92:95], v10 offset:55808
    v_mfma_f32_16x16x32_bf16 v[40:43], a[160:163], v[96:99], v[40:43]
    v_mfma_f32_16x16x32_bf16 v[72:75], a[164:167], v[96:99], v[72:75]
    s_waitcnt lgkmcnt(6)
    v_add_u32 v9, 56320, v9
    v_add_u32 v10, 56320, v10
    v_mfma_f32_16x16x32_bf16 v[44:47], a[160:163], v[100:103], v[44:47]
    ds_read_b128 v[96:99], v11 offset:0
    buffer_load_dwordx4 a[236:239], v8, s[8:11], s59 offen offset:1024 sc1
    v_mfma_f32_16x16x32_bf16 v[76:79], a[164:167], v[100:103], v[76:79]
    s_waitcnt vmcnt(18) lgkmcnt(6)
    ds_read_b128 v[100:103], v11 offset:1024
    v_mfma_f32_16x16x32_bf16 v[24:27], v[104:107], a[168:171], v[24:27]
    v_mfma_f32_16x16x32_bf16 v[56:59], v[104:107], a[172:175], v[56:59]
    s_waitcnt lgkmcnt(6)
    ds_read_b128 v[104:107], v9 offset:4096
    buffer_load_dwordx4 a[240:243], v2, s[8:11], s59 offen offset:2048 sc1
    v_mfma_f32_16x16x32_bf16 v[28:31], v[108:111], a[168:171], v[28:31]
    v_mfma_f32_16x16x32_bf16 v[60:63], v[108:111], a[172:175], v[60:63]
    s_waitcnt lgkmcnt(6)
    ds_read_b128 v[108:111], v11 offset:2048
    v_mfma_f32_16x16x32_bf16 v[32:35], v[80:83], a[168:171], v[32:35]
    v_mfma_f32_16x16x32_bf16 v[64:67], v[80:83], a[172:175], v[64:67]
    s_waitcnt lgkmcnt(6)
    ds_read_b128 v[80:83], v11 offset:3072
    buffer_load_dwordx4 a[244:247], v8, s[8:11], s59 offen offset:2048 sc1
    v_mfma_f32_16x16x32_bf16 v[36:39], a[168:171], v[84:87], v[36:39]
    v_mfma_f32_16x16x32_bf16 v[68:71], a[172:175], v[84:87], v[68:71]
    s_waitcnt lgkmcnt(6)
    ds_read_b128 v[84:87], v10 offset:5120
    v_mfma_f32_16x16x32_bf16 v[40:43], a[168:171], v[88:91], v[40:43]
    v_mfma_f32_16x16x32_bf16 v[72:75], a[172:175], v[88:91], v[72:75]
    s_waitcnt lgkmcnt(6)
    ds_read_b128 v[88:91], v11 offset:5632
    buffer_load_dwordx4 a[248:251], v2, s[8:11], s59 offen offset:3072 sc1
    v_mfma_f32_16x16x32_bf16 v[44:47], a[168:171], v[92:95], v[44:47]
    v_mfma_f32_16x16x32_bf16 v[76:79], a[172:175], v[92:95], v[76:79]
    s_waitcnt vmcnt(17) lgkmcnt(6)
    ds_read_b128 v[92:95], v11 offset:6656
    v_mfma_f32_16x16x32_bf16 v[24:27], v[96:99], a[176:179], v[24:27]
    v_mfma_f32_16x16x32_bf16 v[56:59], v[96:99], a[180:183], v[56:59]
    s_waitcnt lgkmcnt(6)
    ds_read_b128 v[96:99], v9 offset:9728
    buffer_load_dwordx4 a[252:255], v8, s[8:11], s59 offen offset:3072 sc1
    v_mfma_f32_16x16x32_bf16 v[28:31], v[100:103], a[176:179], v[28:31]
    s_mul_i32 m0, s3, 6144
    v_mfma_f32_16x16x32_bf16 v[60:63], v[100:103], a[180:183], v[60:63]
    s_waitcnt lgkmcnt(6)
    ds_read_b128 v[100:103], v11 offset:7680
    v_mfma_f32_16x16x32_bf16 v[32:35], v[104:107], a[176:179], v[32:35]
    v_mfma_f32_16x16x32_bf16 v[64:67], v[104:107], a[180:183], v[64:67]
    s_waitcnt lgkmcnt(6)
    ds_read_b128 v[104:107], v11 offset:8704
    s_cmp_lt_u32 s2, 108
    s_cbranch_scc0 L24
    v_mfma_f32_16x16x32_bf16 v[36:39], a[176:179], v[108:111], v[36:39]
    buffer_load_dwordx4 v237, s[16:19], s99 offen offset:0 nt lds
    s_add_u32 m0, m0, 896
    v_mfma_f32_16x16x32_bf16 v[68:71], a[180:183], v[108:111], v[68:71]
    s_waitcnt lgkmcnt(6)
    ds_read_b128 v[108:111], v10 offset:10752
    v_mfma_f32_16x16x32_bf16 v[40:43], a[176:179], v[80:83], v[40:43]
    v_mfma_f32_16x16x32_bf16 v[72:75], a[180:183], v[80:83], v[72:75]
    s_waitcnt lgkmcnt(6)
    ds_read_b128 v[80:83], v11 offset:11264
    buffer_load_dwordx4 v237, s[16:19], s99 offen offset:128 nt lds
    v_mfma_f32_16x16x32_bf16 v[44:47], a[176:179], v[84:87], v[44:47]
    s_add_u32 m0, m0, 896
    v_mfma_f32_16x16x32_bf16 v[76:79], a[180:183], v[84:87], v[76:79]
    s_waitcnt vmcnt(16) lgkmcnt(6)
    ds_read_b128 v[84:87], v11 offset:12288
    v_mfma_f32_16x16x32_bf16 v[24:27], v[88:91], a[184:187], v[24:27]
    s_add_u32 s98, s98, s97
    v_mfma_f32_16x16x32_bf16 v[56:59], v[88:91], a[188:191], v[56:59]
    s_waitcnt lgkmcnt(6)
    ds_read_b128 v[88:91], v9 offset:15360
    buffer_load_dwordx4 v237, s[16:19], s99 offen offset:256 nt lds
    v_mfma_f32_16x16x32_bf16 v[28:31], v[92:95], a[184:187], v[28:31]
    s_add_u32 m0, m0, 896
    v_mfma_f32_16x16x32_bf16 v[60:63], v[92:95], a[188:191], v[60:63]
    s_waitcnt lgkmcnt(6)
    ds_read_b128 v[92:95], v11 offset:13312
    buffer_load_dwordx4 v237, s[16:19], s99 offen offset:384 nt lds
    v_mfma_f32_16x16x32_bf16 v[32:35], v[96:99], a[184:187], v[32:35]
    s_add_u32 m0, m0, 896
    v_mfma_f32_16x16x32_bf16 v[64:67], v[96:99], a[188:191], v[64:67]
    s_waitcnt lgkmcnt(6)
    ds_read_b128 v[96:99], v11 offset:14336
    v_mfma_f32_16x16x32_bf16 v[36:39], a[184:187], v[100:103], v[36:39]
    s_add_u32 s98, s98, s97
    v_mfma_f32_16x16x32_bf16 v[68:71], a[188:191], v[100:103], v[68:71]
    s_waitcnt lgkmcnt(6)
    ds_read_b128 v[100:103], v10 offset:16384
    buffer_load_dwordx4 v237, s[16:19], s99 offen offset:512 nt lds
    v_mfma_f32_16x16x32_bf16 v[40:43], a[184:187], v[104:107], v[40:43]
    s_mul_i32 s60, s3, 10240
    s_add_u32 s60, s60, 112640
    s_mov_b32 m0, s60
    v_mfma_f32_16x16x32_bf16 v[72:75], a[188:191], v[104:107], v[72:75]
    s_waitcnt lgkmcnt(6)
    s_add_u32 s61, s58, s60
    ds_read_b128 v[104:107], v11 offset:16896
    v_mfma_f32_16x16x32_bf16 v[44:47], a[184:187], v[108:111], v[44:47]
    v_mfma_f32_16x16x32_bf16 v[76:79], a[188:191], v[108:111], v[76:79]
    s_waitcnt vmcnt(14) lgkmcnt(6)
    ds_read_b128 v[108:111], v11 offset:17920
    buffer_load_dwordx4 v2, s[8:11], s61 offen offset:0 sc1 lds
    v_mfma_f32_16x16x32_bf16 v[24:27], v[80:83], a[192:195], v[24:27]
    s_add_u32 s98, s98, s97
    v_mfma_f32_16x16x32_bf16 v[56:59], v[80:83], a[196:199], v[56:59]
    s_waitcnt lgkmcnt(6)
    ds_read_b128 v[80:83], v9 offset:20992
    v_mfma_f32_16x16x32_bf16 v[28:31], v[84:87], a[192:195], v[28:31]
    v_mfma_f32_16x16x32_bf16 v[60:63], v[84:87], a[196:199], v[60:63]
    s_waitcnt lgkmcnt(6)
    ds_read_b128 v[84:87], v11 offset:18944
    v_mfma_f32_16x16x32_bf16 v[32:35], v[88:91], a[192:195], v[32:35]
    v_mfma_f32_16x16x32_bf16 v[64:67], v[88:91], a[196:199], v[64:67]
    s_waitcnt lgkmcnt(6)
    ds_read_b128 v[88:91], v11 offset:19968
    v_mfma_f32_16x16x32_bf16 v[36:39], a[192:195], v[92:95], v[36:39]
    s_add_u32 s98, s98, s97
    v_mfma_f32_16x16x32_bf16 v[68:71], a[196:199], v[92:95], v[68:71]
    s_waitcnt lgkmcnt(6)
    ds_read_b128 v[92:95], v10 offset:22016
    buffer_load_dwordx4 v2, s[8:11], s61 offen offset:1024 sc1 lds
    v_mfma_f32_16x16x32_bf16 v[40:43], a[192:195], v[96:99], v[40:43]
    v_mfma_f32_16x16x32_bf16 v[72:75], a[196:199], v[96:99], v[72:75]
    s_waitcnt lgkmcnt(6)
    ds_read_b128 v[96:99], v11 offset:22528
    v_mfma_f32_16x16x32_bf16 v[44:47], a[192:195], v[100:103], v[44:47]
    v_mfma_f32_16x16x32_bf16 v[76:79], a[196:199], v[100:103], v[76:79]
    s_waitcnt vmcnt(14) lgkmcnt(6)
    ds_read_b128 v[100:103], v11 offset:23552
    v_mfma_f32_16x16x32_bf16 v[24:27], v[104:107], a[200:203], v[24:27]
    v_mfma_f32_16x16x32_bf16 v[56:59], v[104:107], a[204:207], v[56:59]
    s_waitcnt lgkmcnt(6)
    ds_read_b128 v[104:107], v9 offset:26624
    v_mfma_f32_16x16x32_bf16 v[28:31], v[108:111], a[200:203], v[28:31]
    v_mfma_f32_16x16x32_bf16 v[60:63], v[108:111], a[204:207], v[60:63]
    s_waitcnt lgkmcnt(6)
    ds_read_b128 v[108:111], v11 offset:24576
    v_mfma_f32_16x16x32_bf16 v[32:35], v[80:83], a[200:203], v[32:35]
    v_mfma_f32_16x16x32_bf16 v[64:67], v[80:83], a[204:207], v[64:67]
    s_waitcnt lgkmcnt(6)
    ds_read_b128 v[80:83], v11 offset:25600
    buffer_load_dwordx4 v2, s[8:11], s61 offen offset:2048 sc1 lds
    v_mfma_f32_16x16x32_bf16 v[36:39], a[200:203], v[84:87], v[36:39]
    v_mfma_f32_16x16x32_bf16 v[68:71], a[204:207], v[84:87], v[68:71]
    s_waitcnt lgkmcnt(6)
    ds_read_b128 v[84:87], v10 offset:27648
    v_mfma_f32_16x16x32_bf16 v[40:43], a[200:203], v[88:91], v[40:43]
    s_barrier
    v_mfma_f32_16x16x32_bf16 v[72:75], a[204:207], v[88:91], v[72:75]
    s_waitcnt lgkmcnt(6)
    ds_read_b128 v[88:91], v11 offset:28160
    v_mfma_f32_16x16x32_bf16 v[44:47], a[200:203], v[92:95], v[44:47]
    v_mfma_f32_16x16x32_bf16 v[76:79], a[204:207], v[92:95], v[76:79]
    s_waitcnt vmcnt(13) lgkmcnt(6)
    ds_read_b128 v[92:95], v11 offset:29184
    v_mfma_f32_16x16x32_bf16 v[24:27], v[96:99], a[208:211], v[24:27]
    v_mfma_f32_16x16x32_bf16 v[56:59], v[96:99], a[212:215], v[56:59]
    s_waitcnt lgkmcnt(6)
    ds_read_b128 v[96:99], v9 offset:32256
    v_mfma_f32_16x16x32_bf16 v[28:31], v[100:103], a[208:211], v[28:31]
    v_mfma_f32_16x16x32_bf16 v[60:63], v[100:103], a[212:215], v[60:63]
    s_waitcnt lgkmcnt(6)
    ds_read_b128 v[100:103], v11 offset:30208
    buffer_load_dwordx4 v2, s[8:11], s61 offen offset:3072 sc1 lds
    v_mfma_f32_16x16x32_bf16 v[32:35], v[104:107], a[208:211], v[32:35]
    s_add_u32 m0, m0, 4096
    s_add_u32 s61, s61, 4096
    v_mfma_f32_16x16x32_bf16 v[64:67], v[104:107], a[212:215], v[64:67]
    s_waitcnt lgkmcnt(6)
    ds_read_b128 v[104:107], v11 offset:31232
    v_mfma_f32_16x16x32_bf16 v[36:39], a[208:211], v[108:111], v[36:39]
    v_mfma_f32_16x16x32_bf16 v[68:71], a[212:215], v[108:111], v[68:71]
    s_waitcnt lgkmcnt(6)
    ds_read_b128 v[108:111], v10 offset:33280
    v_mfma_f32_16x16x32_bf16 v[40:43], a[208:211], v[80:83], v[40:43]
    v_mfma_f32_16x16x32_bf16 v[72:75], a[212:215], v[80:83], v[72:75]
    s_waitcnt lgkmcnt(6)
    ds_read_b128 v[80:83], v11 offset:33792
    v_mfma_f32_16x16x32_bf16 v[44:47], a[208:211], v[84:87], v[44:47]
    v_mfma_f32_16x16x32_bf16 v[76:79], a[212:215], v[84:87], v[76:79]
    s_waitcnt vmcnt(12) lgkmcnt(6)
    ds_read_b128 v[84:87], v11 offset:34816
    v_mfma_f32_16x16x32_bf16 v[24:27], v[88:91], a[216:219], v[24:27]
    v_mfma_f32_16x16x32_bf16 v[56:59], v[88:91], a[220:223], v[56:59]
    s_waitcnt lgkmcnt(6)
    ds_read_b128 v[88:91], v9 offset:37888
    buffer_load_dwordx4 v2, s[8:11], s61 offen offset:0 sc1 lds
    v_mfma_f32_16x16x32_bf16 v[28:31], v[92:95], a[216:219], v[28:31]
    v_mfma_f32_16x16x32_bf16 v[60:63], v[92:95], a[220:223], v[60:63]
    s_waitcnt lgkmcnt(6)
    ds_read_b128 v[92:95], v11 offset:35840
    v_mfma_f32_16x16x32_bf16 v[32:35], v[96:99], a[216:219], v[32:35]
    v_mfma_f32_16x16x32_bf16 v[64:67], v[96:99], a[220:223], v[64:67]
    s_waitcnt lgkmcnt(6)
    ds_read_b128 v[96:99], v11 offset:36864
    v_mfma_f32_16x16x32_bf16 v[36:39], a[216:219], v[100:103], v[36:39]
    v_mfma_f32_16x16x32_bf16 v[68:71], a[220:223], v[100:103], v[68:71]
    s_waitcnt lgkmcnt(6)
    ds_read_b128 v[100:103], v10 offset:38912
    v_mfma_f32_16x16x32_bf16 v[40:43], a[216:219], v[104:107], v[40:43]
    v_mfma_f32_16x16x32_bf16 v[72:75], a[220:223], v[104:107], v[72:75]
    s_waitcnt lgkmcnt(6)
    ds_read_b128 v[104:107], v11 offset:39424
    v_mfma_f32_16x16x32_bf16 v[44:47], a[216:219], v[108:111], v[44:47]
    v_mfma_f32_16x16x32_bf16 v[76:79], a[220:223], v[108:111], v[76:79]
    s_waitcnt vmcnt(11) lgkmcnt(6)
    v_mfma_f32_16x16x32_bf16 v[24:27], v[80:83], a[224:227], v[24:27]
    ds_read_b128 v[108:111], v11 offset:40448
    buffer_load_dwordx4 v2, s[8:11], s61 offen offset:1024 sc1 lds
    v_mfma_f32_16x16x32_bf16 v[56:59], v[80:83], a[228:231], v[56:59]
    s_waitcnt lgkmcnt(6)
    ds_read_b128 v[80:83], v9 offset:43520
    v_mfma_f32_16x16x32_bf16 v[28:31], v[84:87], a[224:227], v[28:31]
    v_mfma_f32_16x16x32_bf16 v[60:63], v[84:87], a[228:231], v[60:63]
    s_waitcnt lgkmcnt(6)
    ds_read_b128 v[84:87], v11 offset:41472
    buffer_load_dwordx4 v2, s[8:11], s61 offen offset:2048 sc1 lds
    v_mfma_f32_16x16x32_bf16 v[32:35], v[88:91], a[224:227], v[32:35]
    v_mfma_f32_16x16x32_bf16 v[64:67], v[88:91], a[228:231], v[64:67]
    s_waitcnt lgkmcnt(6)
    v_mfma_f32_16x16x32_bf16 v[36:39], a[224:227], v[92:95], v[36:39]
    v_mfma_f32_16x16x32_bf16 v[68:71], a[228:231], v[92:95], v[68:71]
    s_waitcnt lgkmcnt(5)
    v_mfma_f32_16x16x32_bf16 v[40:43], a[224:227], v[96:99], v[40:43]
    ds_read_b128 v[88:91], v11 offset:42496
    ds_read_b128 v[92:95], v10 offset:44544
    v_mfma_f32_16x16x32_bf16 v[72:75], a[228:231], v[96:99], v[72:75]
    s_waitcnt lgkmcnt(6)
    v_mfma_f32_16x16x32_bf16 v[44:47], a[224:227], v[100:103], v[44:47]
    ds_read_b128 v[96:99], v11 offset:45056
    buffer_load_dwordx4 v2, s[8:11], s61 offen offset:3072 sc1 lds
    v_mfma_f32_16x16x32_bf16 v[76:79], a[228:231], v[100:103], v[76:79]
    s_waitcnt vmcnt(12) lgkmcnt(6)
    s_add_u32 m0, m0, 4096
    s_add_u32 s61, s61, 4096
    v_mfma_f32_16x16x32_bf16 v[24:27], v[104:107], a[232:235], v[24:27]
    ds_read_b128 v[100:103], v11 offset:46080
    buffer_load_dwordx4 v2, s[8:11], s61 offen offset:0 sc1 lds
    v_mfma_f32_16x16x32_bf16 v[56:59], v[104:107], a[236:239], v[56:59]
    s_waitcnt lgkmcnt(6)
    ds_read_b128 v[104:107], v9 offset:49152
    v_mfma_f32_16x16x32_bf16 v[28:31], v[108:111], a[232:235], v[28:31]
    v_mfma_f32_16x16x32_bf16 v[60:63], v[108:111], a[236:239], v[60:63]
    s_waitcnt lgkmcnt(6)
    ds_read_b128 v[108:111], v11 offset:47104
    buffer_load_dwordx4 v2, s[8:11], s61 offen offset:1024 sc1 lds
    v_mfma_f32_16x16x32_bf16 v[32:35], v[80:83], a[232:235], v[32:35]
    v_mfma_f32_16x16x32_bf16 v[64:67], v[80:83], a[236:239], v[64:67]
    s_waitcnt lgkmcnt(6)
    ds_read_b128 v[80:83], v11 offset:48128
    v_mfma_f32_16x16x32_bf16 v[36:39], a[232:235], v[84:87], v[36:39]
    v_mfma_f32_16x16x32_bf16 v[68:71], a[236:239], v[84:87], v[68:71]
    s_waitcnt lgkmcnt(6)
    v_mfma_f32_16x16x32_bf16 v[40:43], a[232:235], v[88:91], v[40:43]
    v_mfma_f32_16x16x32_bf16 v[72:75], a[236:239], v[88:91], v[72:75]
    s_waitcnt lgkmcnt(5)
    v_mfma_f32_16x16x32_bf16 v[44:47], a[232:235], v[92:95], v[44:47]
    ds_read_b128 v[84:87], v10 offset:50176
    ds_read_b128 v[88:91], v11 offset:50688
    v_mfma_f32_16x16x32_bf16 v[76:79], a[236:239], v[92:95], v[76:79]
    s_waitcnt vmcnt(12) lgkmcnt(6)
    v_mfma_f32_16x16x32_bf16 v[24:27], v[96:99], a[240:243], v[24:27]
    ds_read_b128 v[92:95], v11 offset:51712
    buffer_load_dwordx4 a[0:3], v2, s[8:11], s37 offen offset:0 sc1
    v_mfma_f32_16x16x32_bf16 v[56:59], v[96:99], a[244:247], v[56:59]
    s_waitcnt lgkmcnt(6)
    ds_read_b128 v[96:99], v9 offset:54784
    buffer_load_dwordx4 a[4:7], v2, s[8:11], s37 offen offset:1024 sc1
    v_mfma_f32_16x16x32_bf16 v[28:31], v[100:103], a[240:243], v[28:31]
    v_mfma_f32_16x16x32_bf16 v[60:63], v[100:103], a[244:247], v[60:63]
    s_waitcnt lgkmcnt(6)
    ds_read_b128 v[100:103], v11 offset:52736
    v_mfma_f32_16x16x32_bf16 v[32:35], v[104:107], a[240:243], v[32:35]
    buffer_load_dwordx4 a[8:11], v2, s[8:11], s37 offen offset:2048 sc1
    v_mfma_f32_16x16x32_bf16 v[64:67], v[104:107], a[244:247], v[64:67]
    s_waitcnt lgkmcnt(6)
    ds_read_b128 v[104:107], v11 offset:53760
    v_mfma_f32_16x16x32_bf16 v[36:39], a[240:243], v[108:111], v[36:39]
    v_mfma_f32_16x16x32_bf16 v[68:71], a[244:247], v[108:111], v[68:71]
    s_waitcnt lgkmcnt(6)
    ds_read_b128 v[108:111], v10 offset:55808
    s_waitcnt vmcnt(3)
    v_mfma_f32_16x16x32_bf16 v[40:43], a[240:243], v[80:83], v[40:43]
    s_barrier
    buffer_load_dwordx4 a[12:15], v2, s[8:11], s37 offen offset:3072 sc1
    v_mfma_f32_16x16x32_bf16 v[72:75], a[244:247], v[80:83], v[72:75]
    s_waitcnt lgkmcnt(6)
    s_add_u32 s37, s37, 4096
    ds_read_b128 v[80:83], v12 offset:0
    v_mfma_f32_16x16x32_bf16 v[44:47], a[240:243], v[84:87], v[44:47]
    v_mfma_f32_16x16x32_bf16 v[76:79], a[244:247], v[84:87], v[76:79]
    s_waitcnt vmcnt(14) lgkmcnt(6)
    ds_read_b128 v[84:87], v12 offset:2048
    v_mfma_f32_16x16x32_bf16 v[24:27], v[88:91], a[248:251], v[24:27]
    buffer_load_dwordx4 a[16:19], v2, s[8:11], s37 offen offset:0 sc1
    v_mfma_f32_16x16x32_bf16 v[56:59], v[88:91], a[252:255], v[56:59]
    s_waitcnt lgkmcnt(6)
    ds_read_b128 v[88:91], v12 offset:4096
    v_mfma_f32_16x16x32_bf16 v[28:31], v[92:95], a[248:251], v[28:31]
    v_mfma_f32_16x16x32_bf16 v[60:63], v[92:95], a[252:255], v[60:63]
    s_waitcnt lgkmcnt(6)
    ds_read_b128 v[92:95], v12 offset:6144
    v_mfma_f32_16x16x32_bf16 v[32:35], v[96:99], a[248:251], v[32:35]
    v_mfma_f32_16x16x32_bf16 v[64:67], v[96:99], a[252:255], v[64:67]
    s_waitcnt lgkmcnt(6)
    ds_read_b128 v[96:99], v12 offset:8192
    buffer_load_dwordx4 a[20:23], v2, s[8:11], s37 offen offset:1024 sc1
    v_mfma_f32_16x16x32_bf16 v[36:39], a[248:251], v[100:103], v[36:39]
    v_mfma_f32_16x16x32_bf16 v[68:71], a[252:255], v[100:103], v[68:71]
    s_waitcnt lgkmcnt(6)
    ds_read_b128 v[100:103], v12 offset:10240
    v_mfma_f32_16x16x32_bf16 v[40:43], a[248:251], v[104:107], v[40:43]
    v_mfma_f32_16x16x32_bf16 v[72:75], a[252:255], v[104:107], v[72:75]
    s_waitcnt lgkmcnt(6)
    ds_read_b128 v[104:107], v12 offset:12288
    buffer_load_dwordx4 a[24:27], v2, s[8:11], s37 offen offset:2048 sc1
    s_branch L25
W0:
    s_branch W1
L24:
    v_mfma_f32_16x16x32_bf16 v[36:39], a[176:179], v[108:111], v[36:39]
    s_add_u32 m0, m0, 896
    v_mfma_f32_16x16x32_bf16 v[68:71], a[180:183], v[108:111], v[68:71]
    s_waitcnt lgkmcnt(6)
    ds_read_b128 v[108:111], v10 offset:10752
    v_mfma_f32_16x16x32_bf16 v[40:43], a[176:179], v[80:83], v[40:43]
    v_mfma_f32_16x16x32_bf16 v[72:75], a[180:183], v[80:83], v[72:75]
    s_waitcnt lgkmcnt(6)
    ds_read_b128 v[80:83], v11 offset:11264
    v_mfma_f32_16x16x32_bf16 v[44:47], a[176:179], v[84:87], v[44:47]
    s_add_u32 m0, m0, 896
    v_mfma_f32_16x16x32_bf16 v[76:79], a[180:183], v[84:87], v[76:79]
    s_waitcnt vmcnt(16) lgkmcnt(6)
    ds_read_b128 v[84:87], v11 offset:12288
    v_mfma_f32_16x16x32_bf16 v[24:27], v[88:91], a[184:187], v[24:27]
    buffer_store_dwordx4 v[172:175], v2, s[8:11], s98 offen sc1
    s_add_u32 s98, s98, s97
    v_mfma_f32_16x16x32_bf16 v[56:59], v[88:91], a[188:191], v[56:59]
    s_waitcnt lgkmcnt(6)
    ds_read_b128 v[88:91], v9 offset:15360
    v_mfma_f32_16x16x32_bf16 v[28:31], v[92:95], a[184:187], v[28:31]
    s_add_u32 m0, m0, 896
    v_mfma_f32_16x16x32_bf16 v[60:63], v[92:95], a[188:191], v[60:63]
    s_waitcnt lgkmcnt(6)
    ds_read_b128 v[92:95], v11 offset:13312
    v_mfma_f32_16x16x32_bf16 v[32:35], v[96:99], a[184:187], v[32:35]
    s_add_u32 m0, m0, 896
    v_mfma_f32_16x16x32_bf16 v[64:67], v[96:99], a[188:191], v[64:67]
    s_waitcnt lgkmcnt(6)
    ds_read_b128 v[96:99], v11 offset:14336
    v_mfma_f32_16x16x32_bf16 v[36:39], a[184:187], v[100:103], v[36:39]
    buffer_store_dwordx4 v[176:179], v2, s[8:11], s98 offen sc1
    s_add_u32 s98, s98, s97
    v_mfma_f32_16x16x32_bf16 v[68:71], a[188:191], v[100:103], v[68:71]
    s_waitcnt lgkmcnt(6)
    ds_read_b128 v[100:103], v10 offset:16384
    v_mfma_f32_16x16x32_bf16 v[40:43], a[184:187], v[104:107], v[40:43]
    s_mul_i32 s60, s3, 10240
    s_add_u32 s60, s60, 112640
    s_mov_b32 m0, s60
    v_mfma_f32_16x16x32_bf16 v[72:75], a[188:191], v[104:107], v[72:75]
    s_waitcnt lgkmcnt(6)
    s_add_u32 s61, s58, s60
    ds_read_b128 v[104:107], v11 offset:16896
    v_mfma_f32_16x16x32_bf16 v[44:47], a[184:187], v[108:111], v[44:47]
    s_sub_u32 s0, s2, 208
    s_cmp_lt_u32 s0, 40
    s_cselect_b64 s[20:21], -1, 0
    s_cselect_b32 s0, s0, 0x400000
    v_mfma_f32_16x16x32_bf16 v[76:79], a[188:191], v[108:111], v[76:79]
    s_waitcnt vmcnt(14) lgkmcnt(6)
    ds_read_b128 v[108:111], v11 offset:17920
    buffer_load_dwordx4 v2, s[8:11], s61 offen offset:0 sc1 lds
    v_mfma_f32_16x16x32_bf16 v[24:27], v[80:83], a[192:195], v[24:27]
    buffer_store_dwordx4 v[180:183], v2, s[8:11], s98 offen sc1
    s_add_u32 s98, s98, s97
    v_mfma_f32_16x16x32_bf16 v[56:59], v[80:83], a[196:199], v[56:59]
    s_waitcnt lgkmcnt(6)
    ds_read_b128 v[80:83], v9 offset:20992
    v_mul_u32_u24 v204, 15360, v5
    v_mfma_f32_16x16x32_bf16 v[28:31], v[84:87], a[192:195], v[28:31]
    s_lshl_b32 s22, s0, 8
    v_lshl_add_u32 v204, v4, 4, v204
    s_add_u32 s0, s22, 0x21400
    v_mfma_f32_16x16x32_bf16 v[60:63], v[84:87], a[196:199], v[60:63]
    s_waitcnt lgkmcnt(6)
    ds_read_b128 v[84:87], v11 offset:18944
    buffer_load_dwordx4 v[196:199], v204, s[8:11], s0 offen sc1
    v_mfma_f32_16x16x32_bf16 v[32:35], v[88:91], a[192:195], v[32:35]
    v_bfe_u32 v200, v14, 0, 8
    v_bfe_u32 v201, v14, 8, 8
    v_mfma_f32_16x16x32_bf16 v[64:67], v[88:91], a[196:199], v[64:67]
    s_waitcnt lgkmcnt(6)
    ds_read_b128 v[88:91], v11 offset:19968
    v_bfe_u32 v202, v14, 16, 8
    v_mfma_f32_16x16x32_bf16 v[36:39], a[192:195], v[92:95], v[36:39]
    buffer_store_dwordx4 v[184:187], v2, s[8:11], s98 offen sc1
    s_add_u32 s98, s98, s97
    v_mfma_f32_16x16x32_bf16 v[68:71], a[196:199], v[92:95], v[68:71]
    s_waitcnt lgkmcnt(6)
    ds_read_b128 v[92:95], v10 offset:22016
    buffer_load_dwordx4 v2, s[8:11], s61 offen offset:1024 sc1 lds
    v_mfma_f32_16x16x32_bf16 v[40:43], a[192:195], v[96:99], v[40:43]
    v_bfe_u32 v203, v14, 24, 8
    s_and_b32 s23, s3, 1
    v_mfma_f32_16x16x32_bf16 v[72:75], a[196:199], v[96:99], v[72:75]
    s_waitcnt lgkmcnt(6)
    ds_read_b128 v[96:99], v11 offset:22528
    s_mul_i32 s23, s23, 40960
    v_mfma_f32_16x16x32_bf16 v[44:47], a[192:195], v[100:103], v[44:47]
    s_add_u32 s22, s22, s23
    s_add_u32 s22, s22, 0xe0000
    v_mul_u32_u24 v205, 10240, v5
    v_mfma_f32_16x16x32_bf16 v[76:79], a[196:199], v[100:103], v[76:79]
    s_waitcnt vmcnt(14) lgkmcnt(6)
    ds_read_b128 v[100:103], v11 offset:23552
    v_lshl_add_u32 v205, v4, 4, v205
    v_mfma_f32_16x16x32_bf16 v[24:27], v[104:107], a[200:203], v[24:27]
    buffer_store_dwordx4 v[188:191], v2, s[8:11], s98 offen sc1
    v_mfma_f32_16x16x32_bf16 v[56:59], v[104:107], a[204:207], v[56:59]
    s_waitcnt lgkmcnt(6)
    ds_read_b128 v[104:107], v9 offset:26624
    v_mfma_f32_16x16x32_bf16 v[28:31], v[108:111], a[200:203], v[28:31]
    v_mfma_f32_16x16x32_bf16 v[60:63], v[108:111], a[204:207], v[60:63]
    s_waitcnt lgkmcnt(6)
    ds_read_b128 v[108:111], v11 offset:24576
    v_mfma_f32_16x16x32_bf16 v[32:35], v[80:83], a[200:203], v[32:35]
    v_mfma_f32_16x16x32_bf16 v[64:67], v[80:83], a[204:207], v[64:67]
    s_waitcnt lgkmcnt(6)
    ds_read_b128 v[80:83], v11 offset:25600
    buffer_load_dwordx4 v2, s[8:11], s61 offen offset:2048 sc1 lds
    v_mfma_f32_16x16x32_bf16 v[36:39], a[200:203], v[84:87], v[36:39]
    buffer_store_dwordx4 v[192:195], v2, s[8:11], s94 offen sc1
    v_mfma_f32_16x16x32_bf16 v[68:71], a[204:207], v[84:87], v[68:71]
    s_waitcnt lgkmcnt(6)
    ds_read_b128 v[84:87], v10 offset:27648
    v_mfma_f32_16x16x32_bf16 v[40:43], a[200:203], v[88:91], v[40:43]
    s_barrier
    v_mfma_f32_16x16x32_bf16 v[72:75], a[204:207], v[88:91], v[72:75]
    s_waitcnt lgkmcnt(6)
    ds_read_b128 v[88:91], v11 offset:28160
    v_mfma_f32_16x16x32_bf16 v[44:47], a[200:203], v[92:95], v[44:47]
    v_mfma_f32_16x16x32_bf16 v[76:79], a[204:207], v[92:95], v[76:79]
    s_waitcnt vmcnt(13) lgkmcnt(6)
    ds_read_b128 v[92:95], v11 offset:29184
    v_mfma_f32_16x16x32_bf16 v[24:27], v[96:99], a[208:211], v[24:27]
    v_mfma_f32_16x16x32_bf16 v[56:59], v[96:99], a[212:215], v[56:59]
    s_waitcnt lgkmcnt(6)
    ds_read_b128 v[96:99], v9 offset:32256
    v_mfma_f32_16x16x32_bf16 v[28:31], v[100:103], a[208:211], v[28:31]
    v_mfma_f32_16x16x32_bf16 v[60:63], v[100:103], a[212:215], v[60:63]
    s_waitcnt lgkmcnt(6)
    ds_read_b128 v[100:103], v11 offset:30208
    buffer_load_dwordx4 v2, s[8:11], s61 offen offset:3072 sc1 lds
    v_mfma_f32_16x16x32_bf16 v[32:35], v[104:107], a[208:211], v[32:35]
    s_add_u32 m0, m0, 4096
    s_add_u32 s61, s61, 4096
    v_mfma_f32_16x16x32_bf16 v[64:67], v[104:107], a[212:215], v[64:67]
    s_waitcnt lgkmcnt(6)
    ds_read_b128 v[104:107], v11 offset:31232
    v_mfma_f32_16x16x32_bf16 v[36:39], a[208:211], v[108:111], v[36:39]
    v_mfma_f32_16x16x32_bf16 v[68:71], a[212:215], v[108:111], v[68:71]
    s_waitcnt lgkmcnt(6)
    ds_read_b128 v[108:111], v10 offset:33280
    v_mfma_f32_16x16x32_bf16 v[40:43], a[208:211], v[80:83], v[40:43]
    v_mfma_f32_16x16x32_bf16 v[72:75], a[212:215], v[80:83], v[72:75]
    s_waitcnt lgkmcnt(6)
    ds_read_b128 v[80:83], v11 offset:33792
    v_mfma_f32_16x16x32_bf16 v[44:47], a[208:211], v[84:87], v[44:47]
    v_mfma_f32_16x16x32_bf16 v[76:79], a[212:215], v[84:87], v[76:79]
    s_waitcnt vmcnt(12) lgkmcnt(6)
    ds_read_b128 v[84:87], v11 offset:34816
    v_mfma_f32_16x16x32_bf16 v[24:27], v[88:91], a[216:219], v[24:27]
    v_mfma_f32_16x16x32_bf16 v[56:59], v[88:91], a[220:223], v[56:59]
    s_waitcnt lgkmcnt(6)
    ds_read_b128 v[88:91], v9 offset:37888
    buffer_load_dwordx4 v2, s[8:11], s61 offen offset:0 sc1 lds
    v_mfma_f32_16x16x32_bf16 v[28:31], v[92:95], a[216:219], v[28:31]
    v_mfma_f32_16x16x32_bf16 v[60:63], v[92:95], a[220:223], v[60:63]
    s_waitcnt lgkmcnt(6)
    ds_read_b128 v[92:95], v11 offset:35840
    v_mfma_f32_16x16x32_bf16 v[32:35], v[96:99], a[216:219], v[32:35]
    v_mfma_f32_16x16x32_bf16 v[64:67], v[96:99], a[220:223], v[64:67]
    s_waitcnt lgkmcnt(6)
    ds_read_b128 v[96:99], v11 offset:36864
    v_mfma_f32_16x16x32_bf16 v[36:39], a[216:219], v[100:103], v[36:39]
    s_waitcnt vmcnt(7)
    v_xor_b32 v196, v200, v196
    v_xor_b32 v197, v201, v197
    v_mfma_f32_16x16x32_bf16 v[68:71], a[220:223], v[100:103], v[68:71]
    s_waitcnt lgkmcnt(6)
    ds_read_b128 v[100:103], v10 offset:38912
    v_xor_b32 v198, v202, v198
    v_mfma_f32_16x16x32_bf16 v[40:43], a[216:219], v[104:107], v[40:43]
    v_xor_b32 v199, v203, v199
    v_or3_b32 v206, v196, v197, v198
    v_mfma_f32_16x16x32_bf16 v[72:75], a[220:223], v[104:107], v[72:75]
    s_waitcnt lgkmcnt(6)
    ds_read_b128 v[104:107], v11 offset:39424
    v_or_b32 v206, v206, v199
    v_mfma_f32_16x16x32_bf16 v[44:47], a[216:219], v[108:111], v[44:47]
    v_and_b32 v206, 0xff, v206
    v_cmp_ne_u32 vcc, 0, v206
    v_mfma_f32_16x16x32_bf16 v[76:79], a[220:223], v[108:111], v[76:79]
    s_waitcnt vmcnt(11) lgkmcnt(6)
    s_and_b64 vcc, vcc, s[20:21]
    s_cbranch_scc1 L22
L23:
    v_mfma_f32_16x16x32_bf16 v[24:27], v[80:83], a[224:227], v[24:27]
    ds_read_b128 v[108:111], v11 offset:40448
    buffer_load_dwordx4 v2, s[8:11], s61 offen offset:1024 sc1 lds
    v_mfma_f32_16x16x32_bf16 v[56:59], v[80:83], a[228:231], v[56:59]
    s_waitcnt lgkmcnt(6)
    ds_read_b128 v[80:83], v9 offset:43520
    v_mov_b32 v200, v196
    v_mfma_f32_16x16x32_bf16 v[28:31], v[84:87], a[224:227], v[28:31]
    v_mov_b32 v201, v197
    v_mov_b32 v202, v198
    v_mfma_f32_16x16x32_bf16 v[60:63], v[84:87], a[228:231], v[60:63]
    s_waitcnt lgkmcnt(6)
    ds_read_b128 v[84:87], v11 offset:41472
    buffer_load_dwordx4 v2, s[8:11], s61 offen offset:2048 sc1 lds
    v_mfma_f32_16x16x32_bf16 v[32:35], v[88:91], a[224:227], v[32:35]
    v_mov_b32 v203, v199
    v_mfma_f32_16x16x32_bf16 v[64:67], v[88:91], a[228:231], v[64:67]
    s_waitcnt lgkmcnt(6)
    v_permlane16_swap_b32 v196, v200
    v_mfma_f32_16x16x32_bf16 v[36:39], a[224:227], v[92:95], v[36:39]
    v_permlane16_swap_b32 v197, v201
    v_mfma_f32_16x16x32_bf16 v[68:71], a[228:231], v[92:95], v[68:71]
    s_waitcnt lgkmcnt(5)
    v_permlane16_swap_b32 v198, v202
    v_mfma_f32_16x16x32_bf16 v[40:43], a[224:227], v[96:99], v[40:43]
    ds_read_b128 v[88:91], v11 offset:42496
    ds_read_b128 v[92:95], v10 offset:44544
    v_mfma_f32_16x16x32_bf16 v[72:75], a[228:231], v[96:99], v[72:75]
    s_waitcnt lgkmcnt(6)
    v_permlane16_swap_b32 v199, v203
    v_mfma_f32_16x16x32_bf16 v[44:47], a[224:227], v[100:103], v[44:47]
    ds_read_b128 v[96:99], v11 offset:45056
    buffer_load_dwordx4 v2, s[8:11], s61 offen offset:3072 sc1 lds
    v_mfma_f32_16x16x32_bf16 v[76:79], a[228:231], v[100:103], v[76:79]
    s_waitcnt vmcnt(12) lgkmcnt(6)
    s_add_u32 m0, m0, 4096
    s_add_u32 s61, s61, 4096
    v_mfma_f32_16x16x32_bf16 v[24:27], v[104:107], a[232:235], v[24:27]
    ds_read_b128 v[100:103], v11 offset:46080
    buffer_load_dwordx4 v2, s[8:11], s61 offen offset:0 sc1 lds
    v_mfma_f32_16x16x32_bf16 v[56:59], v[104:107], a[236:239], v[56:59]
    s_waitcnt lgkmcnt(6)
    ds_read_b128 v[104:107], v9 offset:49152
    v_add_f32 v196, v196, v200
    v_mfma_f32_16x16x32_bf16 v[28:31], v[108:111], a[232:235], v[28:31]
    v_add_f32 v197, v197, v201
    v_add_f32 v198, v198, v202
    v_mfma_f32_16x16x32_bf16 v[60:63], v[108:111], a[236:239], v[60:63]
    s_waitcnt lgkmcnt(6)
    ds_read_b128 v[108:111], v11 offset:47104
    buffer_load_dwordx4 v2, s[8:11], s61 offen offset:1024 sc1 lds
    v_mfma_f32_16x16x32_bf16 v[32:35], v[80:83], a[232:235], v[32:35]
    v_add_f32 v199, v199, v203
    v_mov_b32 v200, v196
    v_mfma_f32_16x16x32_bf16 v[64:67], v[80:83], a[236:239], v[64:67]
    s_waitcnt lgkmcnt(6)
    ds_read_b128 v[80:83], v11 offset:48128
    v_mov_b32 v201, v197
    v_mfma_f32_16x16x32_bf16 v[36:39], a[232:235], v[84:87], v[36:39]
    v_mov_b32 v202, v198
    v_mov_b32 v203, v199
    v_mfma_f32_16x16x32_bf16 v[68:71], a[236:239], v[84:87], v[68:71]
    s_waitcnt lgkmcnt(6)
    v_permlane32_swap_b32 v196, v200
    v_mfma_f32_16x16x32_bf16 v[40:43], a[232:235], v[88:91], v[40:43]
    v_permlane32_swap_b32 v197, v201
    v_mfma_f32_16x16x32_bf16 v[72:75], a[236:239], v[88:91], v[72:75]
    s_waitcnt lgkmcnt(5)
    v_permlane32_swap_b32 v198, v202
    v_mfma_f32_16x16x32_bf16 v[44:47], a[232:235], v[92:95], v[44:47]
    ds_read_b128 v[84:87], v10 offset:50176
    ds_read_b128 v[88:91], v11 offset:50688
    v_mfma_f32_16x16x32_bf16 v[76:79], a[236:239], v[92:95], v[76:79]
    s_waitcnt vmcnt(12) lgkmcnt(6)
    v_permlane32_swap_b32 v199, v203
    v_mfma_f32_16x16x32_bf16 v[24:27], v[96:99], a[240:243], v[24:27]
    ds_read_b128 v[92:95], v11 offset:51712
    buffer_load_dwordx4 a[0:3], v2, s[8:11], s37 offen offset:0 sc1
    v_mfma_f32_16x16x32_bf16 v[56:59], v[96:99], a[244:247], v[56:59]
    s_waitcnt lgkmcnt(6)
    ds_read_b128 v[96:99], v9 offset:54784
    buffer_load_dwordx4 a[4:7], v2, s[8:11], s37 offen offset:1024 sc1
    v_mfma_f32_16x16x32_bf16 v[28:31], v[100:103], a[240:243], v[28:31]
    v_add_f32 v196, v196, v200
    v_add_f32 v197, v197, v201
    v_mfma_f32_16x16x32_bf16 v[60:63], v[100:103], a[244:247], v[60:63]
    s_waitcnt lgkmcnt(6)
    ds_read_b128 v[100:103], v11 offset:52736
    v_add_f32 v198, v198, v202
    v_mfma_f32_16x16x32_bf16 v[32:35], v[104:107], a[240:243], v[32:35]
    buffer_load_dwordx4 a[8:11], v2, s[8:11], s37 offen offset:2048 sc1
    v_add_f32 v199, v199, v203
    v_mfma_f32_16x16x32_bf16 v[64:67], v[104:107], a[244:247], v[64:67]
    s_waitcnt lgkmcnt(6)
    ds_read_b128 v[104:107], v11 offset:53760
    s_mov_b32 s23, 0x07060500
    v_mfma_f32_16x16x32_bf16 v[36:39], a[240:243], v[108:111], v[36:39]
    v_perm_b32 v196, v196, v14, s23
    s_mov_b32 s23, 0x07060501
    v_mfma_f32_16x16x32_bf16 v[68:71], a[244:247], v[108:111], v[68:71]
    s_waitcnt lgkmcnt(6)
    ds_read_b128 v[108:111], v10 offset:55808
    s_waitcnt vmcnt(3)
    v_mfma_f32_16x16x32_bf16 v[40:43], a[240:243], v[80:83], v[40:43]
    s_barrier
    buffer_store_dword v14, v15, s[8:11], s40 offen sc1
    buffer_load_dwordx4 a[12:15], v2, s[8:11], s37 offen offset:3072 sc1
    v_mfma_f32_16x16x32_bf16 v[72:75], a[244:247], v[80:83], v[72:75]
    s_waitcnt lgkmcnt(6)
    s_add_u32 s37, s37, 4096
    ds_read_b128 v[80:83], v12 offset:0
    v_mfma_f32_16x16x32_bf16 v[44:47], a[240:243], v[84:87], v[44:47]
    v_perm_b32 v197, v197, v14, s23
    s_mov_b32 s23, 0x07060502
    v_mfma_f32_16x16x32_bf16 v[76:79], a[244:247], v[84:87], v[76:79]
    s_waitcnt vmcnt(14) lgkmcnt(6)
    ds_read_b128 v[84:87], v12 offset:2048
    v_perm_b32 v198, v198, v14, s23
    v_mfma_f32_16x16x32_bf16 v[24:27], v[88:91], a[248:251], v[24:27]
    s_mov_b32 s23, 0x07060503
    buffer_load_dwordx4 a[16:19], v2, s[8:11], s37 offen offset:0 sc1
    v_perm_b32 v199, v199, v14, s23
    v_mfma_f32_16x16x32_bf16 v[56:59], v[88:91], a[252:255], v[56:59]
    s_waitcnt lgkmcnt(6)
    ds_read_b128 v[88:91], v12 offset:4096
    buffer_store_dwordx4 v[196:199], v205, s[8:11], s22 offen sc1
    v_mfma_f32_16x16x32_bf16 v[28:31], v[92:95], a[248:251], v[28:31]
    v_mfma_f32_16x16x32_bf16 v[60:63], v[92:95], a[252:255], v[60:63]
    s_waitcnt lgkmcnt(6)
    ds_read_b128 v[92:95], v12 offset:6144
    v_mfma_f32_16x16x32_bf16 v[32:35], v[96:99], a[248:251], v[32:35]
    v_mfma_f32_16x16x32_bf16 v[64:67], v[96:99], a[252:255], v[64:67]
    s_waitcnt lgkmcnt(6)
    ds_read_b128 v[96:99], v12 offset:8192
    buffer_load_dwordx4 a[20:23], v2, s[8:11], s37 offen offset:1024 sc1
    v_mfma_f32_16x16x32_bf16 v[36:39], a[248:251], v[100:103], v[36:39]
    v_mfma_f32_16x16x32_bf16 v[68:71], a[252:255], v[100:103], v[68:71]
    s_waitcnt lgkmcnt(6)
    ds_read_b128 v[100:103], v12 offset:10240
    v_mfma_f32_16x16x32_bf16 v[40:43], a[248:251], v[104:107], v[40:43]
    v_mfma_f32_16x16x32_bf16 v[72:75], a[252:255], v[104:107], v[72:75]
    s_waitcnt lgkmcnt(6)
    ds_read_b128 v[104:107], v12 offset:12288
    buffer_load_dwordx4 a[24:27], v2, s[8:11], s37 offen offset:2048 sc1
    s_branch L25
W1:
    s_branch W2
L25:
    v_mfma_f32_16x16x32_bf16 v[44:47], a[248:251], v[108:111], v[44:47]
    v_mfma_f32_16x16x32_bf16 v[76:79], a[252:255], v[108:111], v[76:79]
    s_waitcnt lgkmcnt(6)
    ds_read_b128 v[108:111], v12 offset:14336
    s_cmp_ge_u32 s3, 2
    s_cbranch_scc0 L26
    v_mfma_f32_16x16x32_bf16 v[16:19], v[80:83], a[96:99], 0
    v_cvt_pk_bf16_f32 v186, v64, v65
    v_cvt_pk_bf16_f32 v187, v66, v67
    v_mfma_f32_16x16x32_bf16 v[48:51], v[80:83], a[100:103], 0
    s_waitcnt lgkmcnt(6)
    ds_read_b128 v[80:83], v12 offset:16384
    buffer_load_dwordx4 a[28:31], v2, s[8:11], s37 offen offset:3072 sc1
    v_mfma_f32_16x16x32_bf16 v[16:19], v[84:87], a[104:107], v[16:19]
    s_add_u32 s37, s37, 4096
    v_cvt_pk_bf16_f32 v226, v64, v65
    v_cvt_pk_bf16_f32 v227, v66, v67
    v_mfma_f32_16x16x32_bf16 v[48:51], v[84:87], a[108:111], v[48:51]
    s_waitcnt lgkmcnt(6)
    ds_read_b128 v[84:87], v12 offset:18432
    v_cvt_pk_bf16_f32 v184, v56, v57
    v_mfma_f32_16x16x32_bf16 v[16:19], v[88:91], a[112:115], v[16:19]
    v_cvt_pk_bf16_f32 v185, v58, v59
    v_cvt_pk_bf16_f32 v188, v60, v61
    v_mfma_f32_16x16x32_bf16 v[48:51], v[88:91], a[116:119], v[48:51]
    s_waitcnt lgkmcnt(6)
    ds_read_b128 v[88:91], v12 offset:20480
    buffer_load_dwordx4 a[32:35], v2, s[8:11], s37 offen offset:0 sc1
    v_mfma_f32_16x16x32_bf16 v[16:19], v[92:95], a[120:123], v[16:19]
    v_cvt_pk_bf16_f32 v189, v62, v63
    v_mfma_f32_16x16x32_bf16 v[48:51], v[92:95], a[124:127], v[48:51]
    s_waitcnt lgkmcnt(6)
    v_permlane32_swap_b32 v226, v186
    v_mfma_f32_16x16x32_bf16 v[16:19], v[96:99], a[128:131], v[16:19]
    v_permlane32_swap_b32 v227, v187
    v_mfma_f32_16x16x32_bf16 v[48:51], v[96:99], a[132:135], v[48:51]
    s_waitcnt lgkmcnt(5)
    ds_read_b128 v[92:95], v12 offset:22528
    ds_read_b128 v[96:99], v12 offset:24576
    v_mfma_f32_16x16x32_bf16 v[16:19], v[100:103], a[136:139], v[16:19]
    buffer_load_dwordx4 a[36:39], v2, s[8:11], s37 offen offset:1024 sc1
    v_cvt_pk_bf16_f32 v194, v68, v69
    v_mfma_f32_16x16x32_bf16 v[48:51], v[100:103], a[140:143], v[48:51]
    s_waitcnt lgkmcnt(6)
    ds_read_b128 v[100:103], v12 offset:26624
    v_cvt_pk_bf16_f32 v195, v70, v71
    v_mfma_f32_16x16x32_bf16 v[16:19], v[104:107], a[144:147], v[16:19]
    v_cvt_pk_bf16_f32 v200, v72, v73
    v_cvt_pk_bf16_f32 v201, v74, v75
    v_mfma_f32_16x16x32_bf16 v[48:51], v[104:107], a[148:151], v[48:51]
    s_waitcnt lgkmcnt(6)
    ds_read_b128 v[104:107], v12 offset:28672
    v_cvt_pk_bf16_f32 v206, v76, v77
    v_mfma_f32_16x16x32_bf16 v[16:19], v[108:111], a[152:155], v[16:19]
    buffer_load_dwordx4 a[40:43], v2, s[8:11], s37 offen offset:2048 sc1
    v_cvt_pk_bf16_f32 v207, v78, v79
    v_mfma_f32_16x16x32_bf16 v[48:51], v[108:111], a[156:159], v[48:51]
    s_waitcnt lgkmcnt(6)
    ds_read_b128 v[108:111], v12 offset:30720
    v_mov_b32 v112, v184
    v_mfma_f32_16x16x32_bf16 v[16:19], v[80:83], a[160:163], v[16:19]
    v_mov_b32 v113, v185
    v_mov_b32 v114, v186
    v_mfma_f32_16x16x32_bf16 v[48:51], v[80:83], a[164:167], v[48:51]
    s_waitcnt lgkmcnt(6)
    ds_read_b128 v[80:83], v12 offset:32768
    buffer_store_dwordx4 v[112:115], v145, s[8:11], s32 offen offset:0 sc1
    v_mfma_f32_16x16x32_bf16 v[16:19], v[84:87], a[168:171], v[16:19]
    buffer_load_dwordx4 a[44:47], v2, s[8:11], s37 offen offset:3072 sc1
    s_add_u32 s37, s37, 4096
    v_mfma_f32_16x16x32_bf16 v[48:51], v[84:87], a[172:175], v[48:51]
    s_waitcnt lgkmcnt(6)
    ds_read_b128 v[84:87], v12 offset:34816
    v_mov_b32 v116, v187
    v_mfma_f32_16x16x32_bf16 v[16:19], v[88:91], a[176:179], v[16:19]
    v_mov_b32 v117, v188
    v_mov_b32 v118, v189
    v_mfma_f32_16x16x32_bf16 v[48:51], v[88:91], a[180:183], v[48:51]
    s_waitcnt lgkmcnt(6)
    ds_read_b128 v[88:91], v12 offset:36864
    buffer_store_dwordx4 v[116:119], v145, s[8:11], s32 offen offset:512 sc1
    v_mfma_f32_16x16x32_bf16 v[16:19], v[92:95], a[184:187], v[16:19]
    buffer_load_dwordx4 a[48:51], v2, s[8:11], s37 offen offset:0 sc1
    v_mov_b32 v120, v194
    v_mfma_f32_16x16x32_bf16 v[48:51], v[92:95], a[188:191], v[48:51]
    s_waitcnt lgkmcnt(6)
    ds_read_b128 v[92:95], v12 offset:38912
    v_mov_b32 v121, v195
    v_mfma_f32_16x16x32_bf16 v[16:19], v[96:99], a[192:195], v[16:19]
    v_mov_b32 v122, v200
    buffer_store_dwordx4 v[120:123], v234, s[8:11], s32 offen offset:0 sc1
    v_mfma_f32_16x16x32_bf16 v[48:51], v[96:99], a[196:199], v[48:51]
    s_waitcnt lgkmcnt(6)
    ds_read_b128 v[96:99], v12 offset:1024
    v_mov_b32 v124, v201
    v_mfma_f32_16x16x32_bf16 v[16:19], v[100:103], a[200:203], v[16:19]
    buffer_load_dwordx4 a[52:55], v2, s[8:11], s37 offen offset:1024 sc1
    v_mov_b32 v125, v206
    v_mfma_f32_16x16x32_bf16 v[48:51], v[100:103], a[204:207], v[48:51]
    s_waitcnt lgkmcnt(6)
    ds_read_b128 v[100:103], v12 offset:3072
    v_mov_b32 v126, v207
    v_mfma_f32_16x16x32_bf16 v[16:19], v[104:107], a[208:211], v[16:19]
    buffer_store_dwordx4 v[124:127], v234, s[8:11], s32 offen offset:512 sc1
    v_and_b32 v218, v164, v226
    v_mfma_f32_16x16x32_bf16 v[48:51], v[104:107], a[212:215], v[48:51]
    s_waitcnt lgkmcnt(6)
    ds_read_b128 v[104:107], v12 offset:5120
    v_and_b32 v220, v165, v226
    v_mfma_f32_16x16x32_bf16 v[16:19], v[108:111], a[216:219], v[16:19]
    buffer_load_dwordx4 a[56:59], v2, s[8:11], s37 offen offset:2048 sc1
    v_and_b32 v219, v164, v227
    v_mfma_f32_16x16x32_bf16 v[48:51], v[108:111], a[220:223], v[48:51]
    s_waitcnt lgkmcnt(6)
    ds_read_b128 v[108:111], v12 offset:7168
    v_and_b32 v221, v165, v227
    v_mfma_f32_16x16x32_bf16 v[16:19], v[80:83], a[224:227], v[16:19]
    v_cvt_pk_bf16_f32 v180, v32, v33
    v_cvt_pk_bf16_f32 v181, v34, v35
    v_mfma_f32_16x16x32_bf16 v[48:51], v[80:83], a[228:231], v[48:51]
    s_waitcnt lgkmcnt(6)
    ds_read_b128 v[80:83], v12 offset:9216
    v_cvt_pk_bf16_f32 v224, v32, v33
    v_mfma_f32_16x16x32_bf16 v[16:19], v[84:87], a[232:235], v[16:19]
    v_cvt_pk_bf16_f32 v225, v34, v35
    v_cvt_pk_bf16_f32 v178, v24, v25
    v_mfma_f32_16x16x32_bf16 v[48:51], v[84:87], a[236:239], v[48:51]
    s_waitcnt lgkmcnt(6)
    ds_read_b128 v[84:87], v12 offset:11264
    buffer_load_dwordx4 a[60:63], v2, s[8:11], s37 offen offset:3072 sc1
    v_mfma_f32_16x16x32_bf16 v[16:19], v[88:91], a[240:243], v[16:19]
    s_add_u32 s37, s37, 4096
    v_cvt_pk_bf16_f32 v179, v26, v27
    v_cvt_pk_bf16_f32 v182, v28, v29
    v_mfma_f32_16x16x32_bf16 v[48:51], v[88:91], a[244:247], v[48:51]
    s_waitcnt lgkmcnt(6)
    ds_read_b128 v[88:91], v12 offset:13312
    v_cvt_pk_bf16_f32 v183, v30, v31
    v_mfma_f32_16x16x32_bf16 v[16:19], v[92:95], a[248:251], v[16:19]
    v_permlane32_swap_b32 v224, v180
    v_mfma_f32_16x16x32_bf16 v[48:51], v[92:95], a[252:255], v[48:51]
    s_waitcnt lgkmcnt(6)
    v_permlane32_swap_b32 v225, v181
    v_mfma_f32_16x16x32_bf16 v[20:23], v[96:99], a[96:99], 0
    ds_read_b128 v[92:95], v12 offset:15360
    buffer_load_dwordx4 a[64:67], v2, s[8:11], s37 offen offset:0 sc1
    v_mfma_f32_16x16x32_bf16 v[52:55], v[96:99], a[100:103], 0
    s_waitcnt lgkmcnt(6)
    ds_read_b128 v[96:99], v12 offset:17408
    v_cvt_pk_bf16_f32 v192, v36, v37
    v_mfma_f32_16x16x32_bf16 v[20:23], v[100:103], a[104:107], v[20:23]
    v_cvt_pk_bf16_f32 v193, v38, v39
    v_cvt_pk_bf16_f32 v198, v40, v41
    v_mfma_f32_16x16x32_bf16 v[52:55], v[100:103], a[108:111], v[52:55]
    s_waitcnt lgkmcnt(6)
    ds_read_b128 v[100:103], v12 offset:19456
    buffer_load_dwordx4 a[68:71], v2, s[8:11], s37 offen offset:1024 sc1
    v_mfma_f32_16x16x32_bf16 v[20:23], v[104:107], a[112:115], v[20:23]
    v_cvt_pk_bf16_f32 v199, v42, v43
    v_cvt_pk_bf16_f32 v204, v44, v45
    v_mfma_f32_16x16x32_bf16 v[52:55], v[104:107], a[116:119], v[52:55]
    s_waitcnt lgkmcnt(6)
    ds_read_b128 v[104:107], v12 offset:21504
    v_cvt_pk_bf16_f32 v205, v46, v47
    v_mfma_f32_16x16x32_bf16 v[20:23], v[108:111], a[120:123], v[20:23]
    v_and_b32 v210, v164, v224
    v_and_b32 v212, v165, v224
    v_mfma_f32_16x16x32_bf16 v[52:55], v[108:111], a[124:127], v[52:55]
    s_waitcnt lgkmcnt(6)
    ds_read_b128 v[108:111], v12 offset:23552
    buffer_load_dwordx4 a[72:75], v2, s[8:11], s37 offen offset:2048 sc1
    v_mfma_f32_16x16x32_bf16 v[20:23], v[80:83], a[128:131], v[20:23]
    v_and_b32 v211, v164, v225
    v_and_b32 v213, v165, v225
    v_mfma_f32_16x16x32_bf16 v[52:55], v[80:83], a[132:135], v[52:55]
    s_waitcnt lgkmcnt(6)
    ds_read_b128 v[80:83], v12 offset:25600
    s_waitcnt vmcnt(26)
    v_mfma_f32_16x16x32_bf16 v[20:23], v[84:87], a[136:139], v[20:23]
    s_barrier
    v_cvt_pk_bf16_f32 v216, v48, v49
    v_cvt_pk_bf16_f32 v217, v50, v51
    v_mfma_f32_16x16x32_bf16 v[52:55], v[84:87], a[140:143], v[52:55]
    s_waitcnt lgkmcnt(6)
    ds_read_b128 v[84:87], v12 offset:27648
    buffer_load_dwordx4 a[76:79], v2, s[8:11], s37 offen offset:3072 sc1
    v_mfma_f32_16x16x32_bf16 v[20:23], v[88:91], a[144:147], v[20:23]
    s_add_u32 s37, s37, 4096
    v_cvt_pk_bf16_f32 v208, v16, v17
    v_cvt_pk_bf16_f32 v209, v18, v19
    v_mfma_f32_16x16x32_bf16 v[52:55], v[88:91], a[148:151], v[52:55]
    s_waitcnt lgkmcnt(6)
    ds_read_b128 v[88:91], v12 offset:29696
    v_mfma_f32_16x16x32_bf16 v[20:23], v[92:95], a[152:155], v[20:23]
    v_mfma_f32_16x16x32_bf16 v[52:55], v[92:95], a[156:159], v[52:55]
    s_waitcnt lgkmcnt(6)
    ds_read_b128 v[92:95], v12 offset:31744
    v_mfma_f32_16x16x32_bf16 v[20:23], v[96:99], a[160:163], v[20:23]
    buffer_load_dwordx4 a[80:83], v2, s[8:11], s37 offen offset:0 sc1
    v_mfma_f32_16x16x32_bf16 v[52:55], v[96:99], a[164:167], v[52:55]
    s_waitcnt lgkmcnt(6)
    ds_read_b128 v[96:99], v12 offset:33792
    v_mfma_f32_16x16x32_bf16 v[20:23], v[100:103], a[168:171], v[20:23]
    v_mfma_f32_16x16x32_bf16 v[52:55], v[100:103], a[172:175], v[52:55]
    s_waitcnt lgkmcnt(6)
    ds_read_b128 v[100:103], v12 offset:35840
    v_mfma_f32_16x16x32_bf16 v[20:23], v[104:107], a[176:179], v[20:23]
    buffer_load_dwordx4 a[84:87], v2, s[8:11], s37 offen offset:1024 sc1
    v_mfma_f32_16x16x32_bf16 v[52:55], v[104:107], a[180:183], v[52:55]
    s_waitcnt lgkmcnt(6)
    ds_read_b128 v[104:107], v12 offset:37888
    v_mfma_f32_16x16x32_bf16 v[20:23], v[108:111], a[184:187], v[20:23]
    ds_read_b128 v[128:131], v171 offset:8192
    v_mfma_f32_16x16x32_bf16 v[52:55], v[108:111], a[188:191], v[52:55]
    s_waitcnt lgkmcnt(6)
    ds_read_b128 v[108:111], v12 offset:39936
    v_mfma_f32_16x16x32_bf16 v[20:23], v[80:83], a[192:195], v[20:23]
    buffer_load_dwordx4 a[88:91], v2, s[8:11], s37 offen offset:2048 sc1
    ds_read_b128 v[132:135], v171 offset:9216
    v_mfma_f32_16x16x32_bf16 v[52:55], v[80:83], a[196:199], v[52:55]
    s_waitcnt lgkmcnt(6)
    v_mfma_f32_16x16x32_bf16 v[20:23], v[84:87], a[200:203], v[20:23]
    ds_read_b128 v[136:139], v171 offset:10240
    v_mfma_f32_16x16x32_bf16 v[52:55], v[84:87], a[204:207], v[52:55]
    s_waitcnt lgkmcnt(5)
    v_mfma_f32_16x16x32_bf16 v[20:23], v[88:91], a[208:211], v[20:23]
    buffer_load_dwordx4 a[92:95], v2, s[8:11], s37 offen offset:3072 sc1
    ds_read_b128 v[140:143], v171 offset:11264
    v_mfma_f32_16x16x32_bf16 v[52:55], v[88:91], a[212:215], v[52:55]
    s_waitcnt lgkmcnt(4)
    v_mfma_f32_16x16x32_bf16 v[20:23], v[92:95], a[216:219], v[20:23]
    v_mfma_f32_16x16x32_bf16 v[52:55], v[92:95], a[220:223], v[52:55]
    s_waitcnt lgkmcnt(3)
    buffer_load_dwordx4 v[228:231], v239, s[8:11], 0 offen sc1
    v_mfma_f32_16x16x32_bf16 v[20:23], v[96:99], a[224:227], v[20:23]
    v_mfma_f32_16x16x32_bf16 v[52:55], v[96:99], a[228:231], v[52:55]
    s_waitcnt lgkmcnt(2)
    v_mfma_f32_16x16x32_bf16 v[20:23], v[100:103], a[232:235], v[20:23]
    v_mfma_f32_16x16x32_bf16 v[52:55], v[100:103], a[236:239], v[52:55]
    s_waitcnt lgkmcnt(1)
    buffer_load_dwordx4 v[64:67], v146, s[8:11], 0 offen sc1
    v_mfma_f32_16x16x32_bf16 v[20:23], v[104:107], a[240:243], v[20:23]
    v_mfma_f32_16x16x32_bf16 v[52:55], v[104:107], a[244:247], v[52:55]
    s_waitcnt lgkmcnt(0)
    v_mfma_f32_16x16x32_bf16 v[20:23], v[108:111], a[248:251], v[20:23]
    v_mfma_f32_16x16x32_bf16 v[52:55], v[108:111], a[252:255], v[52:55]
    buffer_load_dwordx4 v[68:71], v147, s[8:11], 0 offen sc1
    s_branch L27
W2:
    s_branch W3
L26:
    v_mfma_f32_16x16x32_bf16 v[16:19], v[80:83], a[96:99], 0
    v_cvt_pk_bf16_f32 v186, v64, v65
    v_cvt_pk_bf16_f32 v187, v66, v67
    v_mfma_f32_16x16x32_bf16 v[48:51], v[80:83], a[100:103], 0
    s_waitcnt lgkmcnt(6)
    ds_read_b128 v[80:83], v12 offset:16384
    buffer_load_dwordx4 a[28:31], v2, s[8:11], s37 offen offset:3072 sc1
    v_mfma_f32_16x16x32_bf16 v[16:19], v[84:87], a[104:107], v[16:19]
    s_add_u32 s37, s37, 4096
    v_cvt_pk_bf16_f32 v226, v64, v65
    v_cvt_pk_bf16_f32 v227, v66, v67
    v_mfma_f32_16x16x32_bf16 v[48:51], v[84:87], a[108:111], v[48:51]
    s_waitcnt lgkmcnt(6)
    ds_read_b128 v[84:87], v12 offset:18432
    v_cvt_pk_bf16_f32 v184, v56, v57
    v_mfma_f32_16x16x32_bf16 v[16:19], v[88:91], a[112:115], v[16:19]
    v_cvt_pk_bf16_f32 v185, v58, v59
    v_cvt_pk_bf16_f32 v188, v60, v61
    v_mfma_f32_16x16x32_bf16 v[48:51], v[88:91], a[116:119], v[48:51]
    s_waitcnt lgkmcnt(6)
    ds_read_b128 v[88:91], v12 offset:20480
    buffer_load_dwordx4 a[32:35], v2, s[8:11], s37 offen offset:0 sc1
    v_mfma_f32_16x16x32_bf16 v[16:19], v[92:95], a[120:123], v[16:19]
    v_cvt_pk_bf16_f32 v189, v62, v63
    v_mfma_f32_16x16x32_bf16 v[48:51], v[92:95], a[124:127], v[48:51]
    s_waitcnt lgkmcnt(6)
    v_permlane32_swap_b32 v226, v186
    v_mfma_f32_16x16x32_bf16 v[16:19], v[96:99], a[128:131], v[16:19]
    v_permlane32_swap_b32 v227, v187
    v_mfma_f32_16x16x32_bf16 v[48:51], v[96:99], a[132:135], v[48:51]
    s_waitcnt lgkmcnt(5)
    ds_read_b128 v[92:95], v12 offset:22528
    ds_read_b128 v[96:99], v12 offset:24576
    v_mfma_f32_16x16x32_bf16 v[16:19], v[100:103], a[136:139], v[16:19]
    buffer_load_dwordx4 a[36:39], v2, s[8:11], s37 offen offset:1024 sc1
    v_cvt_pk_bf16_f32 v194, v68, v69
    v_mfma_f32_16x16x32_bf16 v[48:51], v[100:103], a[140:143], v[48:51]
    s_waitcnt lgkmcnt(6)
    ds_read_b128 v[100:103], v12 offset:26624
    v_cvt_pk_bf16_f32 v195, v70, v71
    v_mfma_f32_16x16x32_bf16 v[16:19], v[104:107], a[144:147], v[16:19]
    v_cvt_pk_bf16_f32 v200, v72, v73
    v_cvt_pk_bf16_f32 v201, v74, v75
    v_mfma_f32_16x16x32_bf16 v[48:51], v[104:107], a[148:151], v[48:51]
    s_waitcnt lgkmcnt(6)
    ds_read_b128 v[104:107], v12 offset:28672
    v_cvt_pk_bf16_f32 v206, v76, v77
    v_mfma_f32_16x16x32_bf16 v[16:19], v[108:111], a[152:155], v[16:19]
    buffer_load_dwordx4 a[40:43], v2, s[8:11], s37 offen offset:2048 sc1
    v_cvt_pk_bf16_f32 v207, v78, v79
    v_mfma_f32_16x16x32_bf16 v[48:51], v[108:111], a[156:159], v[48:51]
    s_waitcnt lgkmcnt(6)
    ds_read_b128 v[108:111], v12 offset:30720
    v_mov_b32 v112, v184
    v_mfma_f32_16x16x32_bf16 v[16:19], v[80:83], a[160:163], v[16:19]
    v_mov_b32 v113, v185
    v_mov_b32 v114, v186
    v_mfma_f32_16x16x32_bf16 v[48:51], v[80:83], a[164:167], v[48:51]
    s_waitcnt lgkmcnt(6)
    ds_read_b128 v[80:83], v12 offset:32768
    ds_write_b128 v171, v[112:115] offset:0
    v_mfma_f32_16x16x32_bf16 v[16:19], v[84:87], a[168:171], v[16:19]
    buffer_load_dwordx4 a[44:47], v2, s[8:11], s37 offen offset:3072 sc1
    s_add_u32 s37, s37, 4096
    v_mfma_f32_16x16x32_bf16 v[48:51], v[84:87], a[172:175], v[48:51]
    s_waitcnt lgkmcnt(6)
    ds_read_b128 v[84:87], v12 offset:34816
    v_mov_b32 v116, v187
    v_mfma_f32_16x16x32_bf16 v[16:19], v[88:91], a[176:179], v[16:19]
    v_mov_b32 v117, v188
    v_mov_b32 v118, v189
    v_mfma_f32_16x16x32_bf16 v[48:51], v[88:91], a[180:183], v[48:51]
    s_waitcnt lgkmcnt(6)
    ds_read_b128 v[88:91], v12 offset:36864
    ds_write_b128 v171, v[116:119] offset:1024
    v_mfma_f32_16x16x32_bf16 v[16:19], v[92:95], a[184:187], v[16:19]
    buffer_load_dwordx4 a[48:51], v2, s[8:11], s37 offen offset:0 sc1
    v_mov_b32 v120, v194
    v_mfma_f32_16x16x32_bf16 v[48:51], v[92:95], a[188:191], v[48:51]
    s_waitcnt lgkmcnt(6)
    ds_read_b128 v[92:95], v12 offset:38912
    v_mov_b32 v121, v195
    v_mfma_f32_16x16x32_bf16 v[16:19], v[96:99], a[192:195], v[16:19]
    v_mov_b32 v122, v200
    ds_write_b128 v171, v[120:123] offset:2048
    v_mfma_f32_16x16x32_bf16 v[48:51], v[96:99], a[196:199], v[48:51]
    s_waitcnt lgkmcnt(6)
    ds_read_b128 v[96:99], v12 offset:1024
    v_mov_b32 v124, v201
    v_mfma_f32_16x16x32_bf16 v[16:19], v[100:103], a[200:203], v[16:19]
    buffer_load_dwordx4 a[52:55], v2, s[8:11], s37 offen offset:1024 sc1
    v_mov_b32 v125, v206
    v_mfma_f32_16x16x32_bf16 v[48:51], v[100:103], a[204:207], v[48:51]
    s_waitcnt lgkmcnt(6)
    ds_read_b128 v[100:103], v12 offset:3072
    v_mov_b32 v126, v207
    v_mfma_f32_16x16x32_bf16 v[16:19], v[104:107], a[208:211], v[16:19]
    ds_write_b128 v171, v[124:127] offset:3072
    v_and_b32 v218, v164, v226
    v_mfma_f32_16x16x32_bf16 v[48:51], v[104:107], a[212:215], v[48:51]
    s_waitcnt lgkmcnt(6)
    ds_read_b128 v[104:107], v12 offset:5120
    v_and_b32 v220, v165, v226
    v_mfma_f32_16x16x32_bf16 v[16:19], v[108:111], a[216:219], v[16:19]
    buffer_load_dwordx4 a[56:59], v2, s[8:11], s37 offen offset:2048 sc1
    v_and_b32 v219, v164, v227
    v_mfma_f32_16x16x32_bf16 v[48:51], v[108:111], a[220:223], v[48:51]
    s_waitcnt lgkmcnt(6)
    ds_read_b128 v[108:111], v12 offset:7168
    v_and_b32 v221, v165, v227
    v_mfma_f32_16x16x32_bf16 v[16:19], v[80:83], a[224:227], v[16:19]
    v_cvt_pk_bf16_f32 v180, v32, v33
    v_cvt_pk_bf16_f32 v181, v34, v35
    v_mfma_f32_16x16x32_bf16 v[48:51], v[80:83], a[228:231], v[48:51]
    s_waitcnt lgkmcnt(6)
    ds_read_b128 v[80:83], v12 offset:9216
    v_cvt_pk_bf16_f32 v224, v32, v33
    v_mfma_f32_16x16x32_bf16 v[16:19], v[84:87], a[232:235], v[16:19]
    v_cvt_pk_bf16_f32 v225, v34, v35
    v_cvt_pk_bf16_f32 v178, v24, v25
    v_mfma_f32_16x16x32_bf16 v[48:51], v[84:87], a[236:239], v[48:51]
    s_waitcnt lgkmcnt(6)
    ds_read_b128 v[84:87], v12 offset:11264
    buffer_load_dwordx4 a[60:63], v2, s[8:11], s37 offen offset:3072 sc1
    v_mfma_f32_16x16x32_bf16 v[16:19], v[88:91], a[240:243], v[16:19]
    s_add_u32 s37, s37, 4096
    v_cvt_pk_bf16_f32 v179, v26, v27
    v_cvt_pk_bf16_f32 v182, v28, v29
    v_mfma_f32_16x16x32_bf16 v[48:51], v[88:91], a[244:247], v[48:51]
    s_waitcnt lgkmcnt(6)
    ds_read_b128 v[88:91], v12 offset:13312
    v_cvt_pk_bf16_f32 v183, v30, v31
    v_mfma_f32_16x16x32_bf16 v[16:19], v[92:95], a[248:251], v[16:19]
    v_permlane32_swap_b32 v224, v180
    v_mfma_f32_16x16x32_bf16 v[48:51], v[92:95], a[252:255], v[48:51]
    s_waitcnt lgkmcnt(6)
    v_permlane32_swap_b32 v225, v181
    v_mfma_f32_16x16x32_bf16 v[20:23], v[96:99], a[96:99], 0
    ds_read_b128 v[92:95], v12 offset:15360
    buffer_load_dwordx4 a[64:67], v2, s[8:11], s37 offen offset:0 sc1
    v_mfma_f32_16x16x32_bf16 v[52:55], v[96:99], a[100:103], 0
    s_waitcnt lgkmcnt(6)
    ds_read_b128 v[96:99], v12 offset:17408
    v_cvt_pk_bf16_f32 v192, v36, v37
    v_mfma_f32_16x16x32_bf16 v[20:23], v[100:103], a[104:107], v[20:23]
    v_cvt_pk_bf16_f32 v193, v38, v39
    v_cvt_pk_bf16_f32 v198, v40, v41
    v_mfma_f32_16x16x32_bf16 v[52:55], v[100:103], a[108:111], v[52:55]
    s_waitcnt lgkmcnt(6)
    ds_read_b128 v[100:103], v12 offset:19456
    buffer_load_dwordx4 a[68:71], v2, s[8:11], s37 offen offset:1024 sc1
    v_mfma_f32_16x16x32_bf16 v[20:23], v[104:107], a[112:115], v[20:23]
    v_cvt_pk_bf16_f32 v199, v42, v43
    v_cvt_pk_bf16_f32 v204, v44, v45
    v_mfma_f32_16x16x32_bf16 v[52:55], v[104:107], a[116:119], v[52:55]
    s_waitcnt lgkmcnt(6)
    ds_read_b128 v[104:107], v12 offset:21504
    v_cvt_pk_bf16_f32 v205, v46, v47
    v_mfma_f32_16x16x32_bf16 v[20:23], v[108:111], a[120:123], v[20:23]
    v_and_b32 v210, v164, v224
    v_and_b32 v212, v165, v224
    v_mfma_f32_16x16x32_bf16 v[52:55], v[108:111], a[124:127], v[52:55]
    s_waitcnt lgkmcnt(6)
    ds_read_b128 v[108:111], v12 offset:23552
    buffer_load_dwordx4 a[72:75], v2, s[8:11], s37 offen offset:2048 sc1
    v_mfma_f32_16x16x32_bf16 v[20:23], v[80:83], a[128:131], v[20:23]
    v_and_b32 v211, v164, v225
    v_and_b32 v213, v165, v225
    v_mfma_f32_16x16x32_bf16 v[52:55], v[80:83], a[132:135], v[52:55]
    s_waitcnt lgkmcnt(6)
    ds_read_b128 v[80:83], v12 offset:25600
    s_waitcnt vmcnt(26)
    v_mfma_f32_16x16x32_bf16 v[20:23], v[84:87], a[136:139], v[20:23]
    s_barrier
    v_cvt_pk_bf16_f32 v216, v48, v49
    v_cvt_pk_bf16_f32 v217, v50, v51
    v_mfma_f32_16x16x32_bf16 v[52:55], v[84:87], a[140:143], v[52:55]
    s_waitcnt lgkmcnt(6)
    ds_read_b128 v[84:87], v12 offset:27648
    buffer_load_dwordx4 a[76:79], v2, s[8:11], s37 offen offset:3072 sc1
    v_mfma_f32_16x16x32_bf16 v[20:23], v[88:91], a[144:147], v[20:23]
    s_add_u32 s37, s37, 4096
    v_cvt_pk_bf16_f32 v208, v16, v17
    v_cvt_pk_bf16_f32 v209, v18, v19
    v_mfma_f32_16x16x32_bf16 v[52:55], v[88:91], a[148:151], v[52:55]
    s_waitcnt lgkmcnt(6)
    ds_read_b128 v[88:91], v12 offset:29696
    v_mfma_f32_16x16x32_bf16 v[20:23], v[92:95], a[152:155], v[20:23]
    v_mfma_f32_16x16x32_bf16 v[52:55], v[92:95], a[156:159], v[52:55]
    s_waitcnt lgkmcnt(6)
    ds_read_b128 v[92:95], v12 offset:31744
    v_mfma_f32_16x16x32_bf16 v[20:23], v[96:99], a[160:163], v[20:23]
    buffer_load_dwordx4 a[80:83], v2, s[8:11], s37 offen offset:0 sc1
    v_mfma_f32_16x16x32_bf16 v[52:55], v[96:99], a[164:167], v[52:55]
    s_waitcnt lgkmcnt(6)
    ds_read_b128 v[96:99], v12 offset:33792
    v_mfma_f32_16x16x32_bf16 v[20:23], v[100:103], a[168:171], v[20:23]
    v_mfma_f32_16x16x32_bf16 v[52:55], v[100:103], a[172:175], v[52:55]
    s_waitcnt lgkmcnt(6)
    ds_read_b128 v[100:103], v12 offset:35840
    v_mfma_f32_16x16x32_bf16 v[20:23], v[104:107], a[176:179], v[20:23]
    buffer_load_dwordx4 a[84:87], v2, s[8:11], s37 offen offset:1024 sc1
    v_mfma_f32_16x16x32_bf16 v[52:55], v[104:107], a[180:183], v[52:55]
    s_waitcnt lgkmcnt(6)
    ds_read_b128 v[104:107], v12 offset:37888
    v_mfma_f32_16x16x32_bf16 v[20:23], v[108:111], a[184:187], v[20:23]
    buffer_load_dwordx4 v[128:131], v145, s[8:11], s33 offen offset:0 sc1
    v_mfma_f32_16x16x32_bf16 v[52:55], v[108:111], a[188:191], v[52:55]
    s_waitcnt lgkmcnt(6)
    ds_read_b128 v[108:111], v12 offset:39936
    v_mfma_f32_16x16x32_bf16 v[20:23], v[80:83], a[192:195], v[20:23]
    buffer_load_dwordx4 a[88:91], v2, s[8:11], s37 offen offset:2048 sc1
    buffer_load_dwordx4 v[132:135], v145, s[8:11], s33 offen offset:512 sc1
    v_mfma_f32_16x16x32_bf16 v[52:55], v[80:83], a[196:199], v[52:55]
    s_waitcnt lgkmcnt(6)
    v_mfma_f32_16x16x32_bf16 v[20:23], v[84:87], a[200:203], v[20:23]
    buffer_load_dwordx4 v[136:139], v234, s[8:11], s33 offen offset:0 sc1
    v_mfma_f32_16x16x32_bf16 v[52:55], v[84:87], a[204:207], v[52:55]
    s_waitcnt lgkmcnt(5)
    v_mfma_f32_16x16x32_bf16 v[20:23], v[88:91], a[208:211], v[20:23]
    buffer_load_dwordx4 a[92:95], v2, s[8:11], s37 offen offset:3072 sc1
    buffer_load_dwordx4 v[140:143], v234, s[8:11], s33 offen offset:512 sc1
    v_mfma_f32_16x16x32_bf16 v[52:55], v[88:91], a[212:215], v[52:55]
    s_waitcnt lgkmcnt(4)
    v_mfma_f32_16x16x32_bf16 v[20:23], v[92:95], a[216:219], v[20:23]
    v_mfma_f32_16x16x32_bf16 v[52:55], v[92:95], a[220:223], v[52:55]
    s_waitcnt lgkmcnt(3)
    buffer_load_dwordx4 v[228:231], v239, s[8:11], 0 offen sc1
    v_mfma_f32_16x16x32_bf16 v[20:23], v[96:99], a[224:227], v[20:23]
    v_mfma_f32_16x16x32_bf16 v[52:55], v[96:99], a[228:231], v[52:55]
    s_waitcnt lgkmcnt(2)
    v_mfma_f32_16x16x32_bf16 v[20:23], v[100:103], a[232:235], v[20:23]
    v_mfma_f32_16x16x32_bf16 v[52:55], v[100:103], a[236:239], v[52:55]
    s_waitcnt lgkmcnt(1)
    buffer_load_dwordx4 v[64:67], v146, s[8:11], 0 offen sc1
    v_mfma_f32_16x16x32_bf16 v[20:23], v[104:107], a[240:243], v[20:23]
    v_mfma_f32_16x16x32_bf16 v[52:55], v[104:107], a[244:247], v[52:55]
    s_waitcnt lgkmcnt(0)
    v_mfma_f32_16x16x32_bf16 v[20:23], v[108:111], a[248:251], v[20:23]
    v_mfma_f32_16x16x32_bf16 v[52:55], v[108:111], a[252:255], v[52:55]
    buffer_load_dwordx4 v[68:71], v147, s[8:11], 0 offen sc1
    s_branch L27
W3:
    s_branch W4
L27:
    s_cmp_lt_u32 s2, 108
    s_cbranch_scc0 L28
    ds_read_b64_tr_b16 v[112:113], v6
    ds_read_b64_tr_b16 v[114:115], v6 offset:512
    ds_read_b64_tr_b16 v[116:117], v7
    ds_read_b64_tr_b16 v[118:119], v7 offset:512
    ds_read_b64_tr_b16 v[120:121], v240
    ds_read_b64_tr_b16 v[122:123], v240 offset:512
    ds_read_b64_tr_b16 v[124:125], v241
    ds_read_b64_tr_b16 v[126:127], v241 offset:512
    ds_read_b64_tr_b16 v[76:77], v242
    ds_read_b64_tr_b16 v[78:79], v242 offset:512
L28:
    s_nop 3
    v_cvt_pk_bf16_f32 v222, v52, v53
    v_cvt_pk_bf16_f32 v223, v54, v55
    v_cvt_pk_bf16_f32 v214, v20, v21
    v_cvt_pk_bf16_f32 v215, v22, v23
    s_mov_b32 s60, 0x3ea52b5c
    v_mfma_f32_16x16x32_bf16 v[80:83], v[184:187], v[216:219], v[148:151]
    s_add_u32 s37, s37, 4096
    buffer_load_dwordx4 a[96:99], v2, s[8:11], s37 offen offset:0 sc1
    s_mul_i32 s54, s63, 20480
    v_mfma_f32_16x16x32_bf16 v[84:87], v[178:181], v[216:219], v[152:155]
    s_add_u32 s54, s54, 0x380000
    v_mfma_f32_16x16x32_bf16 v[88:91], v[186:189], v[220:223], v[148:151]
    s_lshl_b32 s55, s57, 8
    v_mfma_f32_16x16x32_bf16 v[92:95], v[180:183], v[220:223], v[152:155]
    s_add_u32 s55, s55, s54
    v_mfma_f32_16x16x32_bf16 v[96:99], v[178:181], v[208:211], v[148:151]
    s_add_u32 s55, s55, 16384
    v_mfma_f32_16x16x32_bf16 v[104:107], v[180:183], v[212:215], v[148:151]
    s_lshl_b32 s58, s57, 10
    v_max_f32 v80, v80, v84
    s_nop 1
    v_max_f32 v88, v88, v92
    v_max_f32 v81, v81, v85
    v_max_f32 v89, v89, v93
    v_max_f32 v82, v82, v86
    v_max_f32 v90, v90, v94
    v_max_f32 v83, v83, v87
    v_max_f32 v91, v91, v95
    v_max3_f32 v240, v80, v81, v82
    v_max3_f32 v241, v88, v89, v90
    v_max_f32 v240, v240, v83
    v_max_f32 v241, v241, v91
    v_mov_b32 v244, v240
    v_mov_b32 v245, v241
    s_add_u32 s54, s54, s58
    v_permlane16_swap_b32 v240, v244
    v_permlane16_swap_b32 v241, v245
    v_max_f32 v240, v240, v244
    v_max_f32 v241, v241, v245
    v_mov_b32 v244, v240
    v_mov_b32 v245, v241
    s_add_u32 s58, s54, 40960
    v_permlane32_swap_b32 v240, v244
    v_permlane32_swap_b32 v241, v245
    v_max_f32 v240, v240, v244
    v_max_f32 v241, v241, v245
    v_mul_f32 v240, s60, v240
    v_mul_f32 v241, s60, v241
    v_fma_f32 v80, v80, s60, -v240
    v_fma_f32 v81, v81, s60, -v240
    v_fma_f32 v82, v82, s60, -v240
    v_fma_f32 v83, v83, s60, -v240
    v_fma_f32 v88, v88, s60, -v241
    v_fma_f32 v89, v89, s60, -v241
    v_fma_f32 v90, v90, s60, -v241
    v_fma_f32 v91, v91, s60, -v241
    v_exp_f32 v80, v80
    v_exp_f32 v81, v81
    v_exp_f32 v82, v82
    v_exp_f32 v83, v83
    v_exp_f32 v88, v88
    v_exp_f32 v89, v89
    v_exp_f32 v90, v90
    v_exp_f32 v91, v91
    v_cvt_pk_bf16_f32 v84, v80, v81
    v_cvt_pk_bf16_f32 v85, v82, v83
    v_cvt_pk_bf16_f32 v92, v88, v89
    v_cvt_pk_bf16_f32 v93, v90, v91
    v_and_b32 v40, v162, v84
    v_and_b32 v42, v160, v84
    v_and_b32 v41, v163, v85
    v_and_b32 v43, v161, v85
    v_and_b32 v44, v162, v92
    v_and_b32 v46, v160, v92
    v_and_b32 v45, v163, v93
    v_and_b32 v47, v161, v93
    s_add_u32 s59, s55, 40960
    v_mfma_f32_16x16x32_bf16 v[24:27], v[166:169], v[40:43], 0
    v_mfma_f32_16x16x32_bf16 v[36:39], v[166:169], v[44:47], 0
    s_waitcnt vmcnt(4) lgkmcnt(0)
    v_xor_b32 v131, v235, v131
    v_xor_b32 v135, v235, v135
    v_xor_b32 v139, v236, v139
    v_xor_b32 v143, v236, v143
    v_or3_b32 v131, v131, v135, v139
    v_or_b32 v131, v131, v143
    v_cmp_ne_u32 vcc, 0, v131
    s_nop 0
    s_andn2_b64 vcc, vcc, s[42:43]
    s_cbranch_scc1 L29
L30:
    s_cmp_lt_u32 s2, 108
    s_cbranch_scc0 L31
    s_waitcnt lgkmcnt(0)
    buffer_store_dwordx4 v[112:115], v2, s[8:11], s101 offen offset:0 sc1
    buffer_store_dwordx4 v[116:119], v2, s[8:11], s101 offen offset:1024 sc1
    buffer_store_dwordx4 v[120:123], v2, s[8:11], s101 offen offset:2048 sc1
    buffer_store_dwordx4 v[124:127], v2, s[8:11], s101 offen offset:3072 sc1
    s_add_u32 s101, s101, 4096
    buffer_store_dwordx4 v[76:79], v2, s[8:11], s101 offen offset:0 sc1
L31:
    v_mov_b32 v172, v128
    v_mov_b32 v173, v129
    v_mfma_f32_16x16x32_bf16 v[16:19], v[192:195], v[40:43], 0
    v_mov_b32 v174, v130
    v_mov_b32 v175, v132
    v_mfma_f32_16x16x32_bf16 v[28:31], v[198:201], v[44:47], 0
    v_mov_b32 v176, v133
    v_mov_b32 v177, v134
    v_mfma_f32_16x16x32_bf16 v[20:23], v[204:207], v[40:43], 0
    v_mfma_f32_16x16x32_bf16 v[100:103], v[172:175], v[208:211], v[156:159]
    v_mov_b32 v190, v136
    v_mov_b32 v191, v137
    v_mfma_f32_16x16x32_bf16 v[108:111], v[174:177], v[212:215], v[156:159]
    v_mov_b32 v196, v138
    v_mov_b32 v197, v140
    v_mfma_f32_16x16x32_bf16 v[32:35], v[204:207], v[44:47], 0
    v_mov_b32 v202, v141
    v_mov_b32 v203, v142
    v_cmp_ne_u32 vcc, 0, v164
    v_max_f32 v96, v96, v100
    s_nop 0
    v_max_f32 v104, v104, v108
    v_max_f32 v97, v97, v101
    v_max_f32 v105, v105, v109
    v_max_f32 v98, v98, v102
    v_max_f32 v106, v106, v110
    v_max_f32 v99, v99, v103
    v_max_f32 v107, v107, v111
    v_max3_f32 v242, v96, v97, v98
    v_max3_f32 v243, v104, v105, v106
    v_max_f32 v242, v242, v99
    v_max_f32 v243, v243, v107
    v_mov_b32 v246, v242
    v_mov_b32 v247, v243
    v_rcp_f32 v24, v24
    v_permlane16_swap_b32 v242, v246
    v_permlane16_swap_b32 v243, v247
    v_max_f32 v242, v242, v246
    v_max_f32 v243, v243, v247
    v_mov_b32 v246, v242
    v_mov_b32 v247, v243
    v_rcp_f32 v36, v36
    v_permlane32_swap_b32 v242, v246
    v_permlane32_swap_b32 v243, v247
    v_max_f32 v242, v242, v246
    v_max_f32 v243, v243, v247
    v_mul_f32 v242, s60, v242
    v_mul_f32 v243, s60, v243
    v_fma_f32 v96, v96, s60, -v242
    v_fma_f32 v97, v97, s60, -v242
    v_fma_f32 v98, v98, s60, -v242
    v_fma_f32 v99, v99, s60, -v242
    v_fma_f32 v104, v104, s60, -v243
    v_fma_f32 v105, v105, s60, -v243
    v_fma_f32 v106, v106, s60, -v243
    v_fma_f32 v107, v107, s60, -v243
    v_exp_f32 v96, v96
    v_exp_f32 v97, v97
    v_exp_f32 v98, v98
    v_exp_f32 v99, v99
    v_exp_f32 v104, v104
    v_exp_f32 v105, v105
    v_exp_f32 v106, v106
    v_exp_f32 v107, v107
    v_cvt_pk_bf16_f32 v100, v96, v97
    v_cvt_pk_bf16_f32 v101, v98, v99
    v_cvt_pk_bf16_f32 v108, v104, v105
    v_cvt_pk_bf16_f32 v109, v106, v107
    v_and_b32 v128, v162, v100
    v_and_b32 v130, v160, v100
    v_and_b32 v129, v163, v101
    v_and_b32 v131, v161, v101
    v_and_b32 v132, v162, v108
    v_and_b32 v134, v160, v108
    v_and_b32 v133, v163, v109
    v_and_b32 v135, v161, v109
    v_mfma_f32_16x16x32_bf16 v[48:51], v[166:169], v[128:131], 0
    v_pk_mul_f32 v[16:17], v[16:17], v[24:25] op_sel_hi:[1,0]
    v_pk_mul_f32 v[18:19], v[18:19], v[24:25] op_sel_hi:[1,0]
    v_pk_mul_f32 v[28:29], v[28:29], v[36:37] op_sel_hi:[1,0]
    v_mfma_f32_16x16x32_bf16 v[60:63], v[166:169], v[132:135], 0
    v_pk_mul_f32 v[30:31], v[30:31], v[36:37] op_sel_hi:[1,0]
    v_cndmask_b32 v26, v36, v24, vcc
    v_cvt_pk_bf16_f32 v80, v16, v17
    v_mfma_f32_16x16x32_bf16 v[40:43], v[190:193], v[128:131], 0
    v_cvt_pk_bf16_f32 v81, v18, v19
    v_cvt_pk_bf16_f32 v82, v28, v29
    v_cvt_pk_bf16_f32 v83, v30, v31
    v_mfma_f32_16x16x32_bf16 v[52:55], v[196:199], v[132:135], 0
    buffer_store_dwordx4 v[80:83], v2, s[8:11], s58 offen sc1
    v_cndmask_b32 v20, v32, v20, vcc
    v_cndmask_b32 v21, v33, v21, vcc
    v_mfma_f32_16x16x32_bf16 v[44:47], v[202:205], v[128:131], 0
    v_cndmask_b32 v22, v34, v22, vcc
    v_cndmask_b32 v23, v35, v23, vcc
    v_pk_mul_f32 v[20:21], v[20:21], v[26:27] op_sel_hi:[1,0]
    v_mfma_f32_16x16x32_bf16 v[56:59], v[202:205], v[132:135], 0
    v_pk_mul_f32 v[22:23], v[22:23], v[26:27] op_sel_hi:[1,0]
    v_cvt_pk_bf16_f32 v84, v20, v21
    v_cvt_pk_bf16_f32 v85, v22, v23
    buffer_store_dwordx2 v[84:85], v170, s[8:11], s59 offen sc1
    v_rcp_f32 v48, v48
    v_rcp_f32 v60, v60
    v_pk_mul_f32 v[40:41], v[40:41], v[48:49] op_sel_hi:[1,0]
    v_pk_mul_f32 v[42:43], v[42:43], v[48:49] op_sel_hi:[1,0]
    v_pk_mul_f32 v[52:53], v[52:53], v[60:61] op_sel_hi:[1,0]
    v_pk_mul_f32 v[54:55], v[54:55], v[60:61] op_sel_hi:[1,0]
    v_cndmask_b32 v50, v60, v48, vcc
    v_cvt_pk_bf16_f32 v88, v40, v41
    v_cvt_pk_bf16_f32 v89, v42, v43
    v_cvt_pk_bf16_f32 v90, v52, v53
    v_cvt_pk_bf16_f32 v91, v54, v55
    buffer_store_dwordx4 v[88:91], v2, s[8:11], s54 offen sc1
    v_cndmask_b32 v44, v56, v44, vcc
    v_cndmask_b32 v45, v57, v45, vcc
    v_cndmask_b32 v46, v58, v46, vcc
    v_cndmask_b32 v47, v59, v47, vcc
    v_pk_mul_f32 v[44:45], v[44:45], v[50:51] op_sel_hi:[1,0]
    v_pk_mul_f32 v[46:47], v[46:47], v[50:51] op_sel_hi:[1,0]
    v_cvt_pk_bf16_f32 v92, v44, v45
    v_cvt_pk_bf16_f32 v93, v46, v47
    buffer_store_dwordx2 v[92:93], v170, s[8:11], s55 offen sc1
    s_waitcnt vmcnt(5)
    v_xor_b32 v228, s52, v228
    v_xor_b32 v229, s52, v229
    v_xor_b32 v230, s52, v230
    v_xor_b32 v231, s52, v231
    v_or3_b32 v228, v228, v229, v230
    v_or_b32 v228, v228, v231
    v_cmp_ne_u32 vcc, 0, v228
    s_nop 0
    s_cmp_lg_u64 vcc, 0
    s_cbranch_scc1 L32
L33:
    s_lshr_b32 s54, s3, 1
    s_add_u32 s54, s54, 0
    s_and_b32 s55, s3, 1
    s_mul_i32 s55, s55, 10240
    s_mul_i32 s61, s54, 21504
    s_add_u32 m0, s61, s55
    s_add_u32 s54, s54, s28
    s_sub_u32 s54, s54, s3
    s_mul_i32 s61, s54, 20480
    s_add_u32 s61, s61, s55
    s_add_u32 s61, s61, 0x1300000
    s_barrier
    buffer_load_dwordx4 v2, s[8:11], s61 offen offset:0 sc1 lds
    s_bfe_u32 s59, s52, 0x80000
    s_bfe_u32 s60, s52, 0x80008
    s_bfe_u32 s62, s52, 0x80010
    s_bfe_u32 s63, s52, 0x80018
    v_xor_b32 v64, s59, v64
    v_xor_b32 v65, s60, v65
    v_xor_b32 v66, s62, v66
    v_xor_b32 v67, s63, v67
    v_xor_b32 v68, s59, v68
    v_xor_b32 v69, s60, v69
    v_xor_b32 v70, s62, v70
    v_xor_b32 v71, s63, v71
    v_or3_b32 v188, v64, v65, v66
    v_or3_b32 v189, v67, v68, v69
    v_or3_b32 v188, v188, v70, v71
    buffer_load_dwordx4 v2, s[8:11], s61 offen offset:1024 sc1 lds
    v_or_b32 v188, v188, v189
    v_and_b32 v188, 0xff, v188
    v_cmp_ne_u32 vcc, 0, v188
    s_nop 0
    s_cmp_lg_u64 vcc, 0
    s_cbranch_scc1 L34
L35:
    s_add_u32 s54, s26, 0x10008
    v_lshrrev_b32 v189, 3, v4
    v_and_b32 v188, 7, v4
    v_lshl_add_u32 v188, v188, 3, v189
    v_lshl_add_u32 v188, v188, 8, s54
    v_cvt_pk_bf16_f32 v72, v64, v65
    v_cvt_pk_bf16_f32 v73, v66, v67
    v_cvt_pk_bf16_f32 v68, 0, v68
    v_cvt_pk_bf16_f32 v69, 0, v69
    buffer_load_dwordx4 v2, s[8:11], s61 offen offset:2048 sc1 lds
    v_cvt_pk_bf16_f32 v70, 0, v70
    v_cvt_pk_bf16_f32 v71, 0, v71
    v_add_f32 v68, v144, v68
    v_add_f32 v69, v144, v69
    v_add_f32 v70, v144, v70
    v_add_f32 v71, v144, v71
    v_cvt_pk_bf16_f32 v74, v68, v69
    v_cvt_pk_bf16_f32 v75, v70, v71
    ds_write_b64 v238, v[72:73]
    ds_write_b64 v238, v[74:75] offset:1600
    v_lshlrev_b32 v190, 3, v0
    v_add_u32 v190, 156800, v190
    ds_write_b64 v190, v[166:167]
    s_mul_i32 s55, s3, 5120
    s_add_u32 s55, s55, 0x380000
    buffer_load_dwordx4 v2, s[8:11], s61 offen offset:3072 sc1 lds
    s_lshl_b32 s56, s30, 2
    s_add_u32 s54, s3, 1
    s_and_b32 s54, s54, 3
    s_add_u32 s54, s54, s56
    s_mul_i32 s54, s54, 20480
    s_add_u32 s94, s54, s55
    s_add_u32 s54, s3, 2
    s_and_b32 s54, s54, 3
    s_add_u32 s54, s54, s56
    s_mul_i32 s54, s54, 20480
    s_add_u32 s95, s54, s55
    s_add_u32 s54, s3, 3
    s_and_b32 s54, s54, 3
    s_add_u32 s54, s54, s56
    s_mul_i32 s54, s54, 20480
    s_add_u32 m0, m0, 4096
    s_add_u32 s61, s61, 4096
    buffer_load_dwordx4 v2, s[8:11], s61 offen offset:0 sc1 lds
    s_add_u32 s96, s54, s55
    s_add_u32 s54, s3, 4
    s_and_b32 s54, s54, 3
    s_add_u32 s54, s54, s56
    s_mul_i32 s54, s54, 20480
    s_add_u32 s97, s54, s55
    s_add_u32 s54, s3, 1
    s_and_b32 s54, s54, 3
    s_mul_i32 s54, s54, 15360
    s_add_u32 s98, s54, 86016
    s_add_u32 s54, s3, 2
    s_and_b32 s54, s54, 3
    s_mul_i32 s54, s54, 15360
    s_add_u32 s99, s54, 91136
    s_add_u32 s54, s3, 3
    buffer_load_dwordx4 v2, s[8:11], s61 offen offset:1024 sc1 lds
    s_and_b32 s54, s54, 3
    s_mul_i32 s54, s54, 15360
    s_add_u32 s100, s54, 96256
    s_mul_i32 s54, s3, 15360
    s_add_u32 s54, s54, 86016
    v_add_u32 v7, s54, v2
    v_mov_b32 v216, 153600
    v_lshl_add_u32 v11, v5, 4, v216
    v_lshl_add_u32 v12, v5, 3, v216
    s_lshr_b32 s54, s31, 1
    s_mul_i32 s54, s54, 320
    s_and_b32 s55, s31, 1
    s_lshl_b32 s56, s55, 7
    s_add_u32 s56, s56, s54
    s_lshl_b32 s55, s55, 5
    buffer_load_dwordx4 v2, s[8:11], s61 offen offset:2048 sc1 lds
    s_add_u32 s55, s55, s54
    v_cmp_eq_u32 vcc, 1, v4
    v_mov_b32 v216, 1600
    v_add_u32 v212, s56, v11
    v_cndmask_b32 v216, 0, v216, vcc
    v_cmp_eq_u32 vcc, 0, v4
    v_mov_b32 v217, 3200
    v_add_u32 v213, s55, v12
    v_cndmask_b32 v216, v216, v217, vcc
    v_add_u32 v214, v216, v212
    v_add_u32 v215, v216, v213
    v_add_u32 v8, 4096, v2
    s_add_u32 s58, s1, 0x10008
    s_cmp_eq_u32 s3, 0
    s_cselect_b32 s58, s58, 0x7ffffff0
    buffer_load_dwordx4 v2, s[8:11], s61 offen offset:3072 sc1 lds
    s_waitcnt vmcnt(8) lgkmcnt(0)
    s_barrier
    buffer_store_dword v14, v15, s[8:11], s58 offen sc1
    buffer_store_dword v14, v15, s[8:11], s47 offen sc1
    s_add_u32 m0, m0, 4096
    s_add_u32 s61, s61, 4096
    buffer_load_dwordx4 v2, s[8:11], s61 offen offset:0 sc1 lds
    ds_read_b128 v[192:195], v11 offset:1280
    ds_read_b128 v[196:199], v11 offset:1344
    ds_read_b64 v[200:201], v12 offset:1536
    ds_read_b128 v[202:205], v212 offset:1600
    ds_read_b128 v[206:209], v212 offset:1664
    ds_read_b64 v[210:211], v213 offset:1856
    ds_read_b128 v[156:159], v214 offset:0
    ds_read_b128 v[160:163], v214 offset:64
    ds_read_b64 v[164:165], v215 offset:256
    s_cmp_eq_u32 s3, 3
    s_cselect_b32 s54, 0x7ffefff0, 0
    v_add_u32 v9, s54, v2
    v_add_u32 v10, s54, v8
    s_mul_i32 s37, s31, 286720
    s_mul_i32 s54, s3, 71680
    buffer_load_dwordx4 v2, s[8:11], s61 offen offset:1024 sc1 lds
    s_add_u32 s37, s37, s54
    s_add_u32 s37, s37, 0x1540000
    v_add_u32 v216, 0x8000, v2
    s_lshl_b32 s54, s2, 2
    s_add_u32 s54, s54, s3
    s_cmp_eq_u32 s54, 1
    s_cselect_b32 s101, 0, 0x7ffffff0
    v_lshlrev_b32 v154, 16, v233
    v_and_b32 v155, 0xffff0000, v233
    v_lshlrev_b32 v152, 16, v232
    v_and_b32 v153, 0xffff0000, v232
    v_lshlrev_b32 v136, 16, v248
    v_and_b32 v137, 0xffff0000, v248
    v_lshlrev_b32 v138, 16, v249
    v_and_b32 v139, 0xffff0000, v249
    s_add_u32 m0, m0, 34816
    s_add_u32 s61, s61, 32768
    buffer_load_dwordx4 v2, s[8:11], s61 offen offset:0 sc1 lds
    v_lshlrev_b32 v140, 16, v250
    v_and_b32 v141, 0xffff0000, v250
    v_lshlrev_b32 v142, 16, v251
    v_and_b32 v143, 0xffff0000, v251
    v_lshlrev_b32 v144, 16, v252
    v_and_b32 v145, 0xffff0000, v252
    v_lshlrev_b32 v146, 16, v253
    v_and_b32 v147, 0xffff0000, v253
    v_lshlrev_b32 v148, 16, v254
    v_and_b32 v149, 0xffff0000, v254
    v_lshlrev_b32 v150, 16, v255
    v_and_b32 v151, 0xffff0000, v255
    s_waitcnt lgkmcnt(0)
    v_lshlrev_b32 v96, 16, v192
    v_and_b32 v97, 0xffff0000, v192
    buffer_load_dwordx4 v2, s[8:11], s61 offen offset:1024 sc1 lds
    v_lshlrev_b32 v98, 16, v193
    v_and_b32 v99, 0xffff0000, v193
    v_lshlrev_b32 v100, 16, v194
    v_and_b32 v101, 0xffff0000, v194
    v_lshlrev_b32 v102, 16, v195
    v_and_b32 v103, 0xffff0000, v195
    v_lshlrev_b32 v104, 16, v196
    v_and_b32 v105, 0xffff0000, v196
    v_lshlrev_b32 v106, 16, v197
    v_and_b32 v107, 0xffff0000, v197
    v_lshlrev_b32 v108, 16, v198
    v_and_b32 v109, 0xffff0000, v198
    v_lshlrev_b32 v110, 16, v199
    v_and_b32 v111, 0xffff0000, v199
    v_lshlrev_b32 v112, 16, v200
    buffer_load_dwordx4 v2, s[8:11], s61 offen offset:2048 sc1 lds
    v_and_b32 v113, 0xffff0000, v200
    v_lshlrev_b32 v114, 16, v201
    v_and_b32 v115, 0xffff0000, v201
    v_lshlrev_b32 v116, 16, v202
    v_and_b32 v117, 0xffff0000, v202
    v_lshlrev_b32 v118, 16, v203
    v_and_b32 v119, 0xffff0000, v203
    v_lshlrev_b32 v120, 16, v204
    v_and_b32 v121, 0xffff0000, v204
    v_lshlrev_b32 v122, 16, v205
    v_and_b32 v123, 0xffff0000, v205
    v_lshlrev_b32 v124, 16, v206
    v_and_b32 v125, 0xffff0000, v206
    v_lshlrev_b32 v126, 16, v207
    v_and_b32 v127, 0xffff0000, v207
    buffer_load_dwordx4 v2, s[8:11], s61 offen offset:3072 sc1 lds
    v_lshlrev_b32 v128, 16, v208
    v_and_b32 v129, 0xffff0000, v208
    v_lshlrev_b32 v130, 16, v209
    v_and_b32 v131, 0xffff0000, v209
    v_lshlrev_b32 v132, 16, v210
    v_and_b32 v133, 0xffff0000, v210
    v_lshlrev_b32 v134, 16, v211
    v_and_b32 v135, 0xffff0000, v211
    v_cmp_gt_u32 vcc, 3, v4
    v_mov_b32 v166, 0
    v_mov_b32 v167, 0
    v_mov_b32 v182, 0
    v_mov_b32 v183, 0
    v_mov_b32 v194, 0
    v_mov_b32 v195, 0
    s_add_u32 m0, m0, 4096
    s_add_u32 s61, s61, 4096
    buffer_load_dwordx4 v2, s[8:11], s61 offen offset:0 sc1 lds
    v_cndmask_b32 v156, 0, v156, vcc
    v_cndmask_b32 v157, 0, v157, vcc
    v_cndmask_b32 v158, 0, v158, vcc
    v_cndmask_b32 v159, 0, v159, vcc
    v_cndmask_b32 v160, 0, v160, vcc
    v_cndmask_b32 v161, 0, v161, vcc
    v_cndmask_b32 v162, 0, v162, vcc
    v_cndmask_b32 v163, 0, v163, vcc
    v_cndmask_b32 v164, 0, v164, vcc
    v_cndmask_b32 v165, 0, v165, vcc
    v_cmp_eq_u32 vcc, 3, v4
    v_mov_b32 v212, 0x3f803f80
    v_lshlrev_b32 v210, 3, v4
    v_cndmask_b32 v168, 0, v212, vcc
    v_cndmask_b32 v169, 0, v212, vcc
    buffer_load_dwordx4 v2, s[8:11], s61 offen offset:1024 sc1 lds
    v_cndmask_b32 v170, 0, v212, vcc
    v_cndmask_b32 v171, 0, v212, vcc
    s_mul_i32 s54, s46, 20480
    s_lshr_b32 s55, s31, 1
    s_mul_i32 s55, s55, 5120
    s_add_u32 s54, s54, s55
    s_add_u32 s54, s54, 0x600000
    s_and_b32 s56, s31, 1
    s_lshl_b32 s55, s56, 9
    s_add_u32 s55, s55, s54
    s_add_u32 s55, s55, 4096
    s_lshl_b32 s56, s56, 11
    s_add_u32 s54, s54, s56
    s_lshl_b32 s58, s46, 3
    s_add_u32 s58, s58, s31
    buffer_load_dwordx4 v2, s[8:11], s61 offen offset:2048 sc1 lds
    s_lshl_b32 s58, s58, 9
    s_add_u32 s58, s58, 0x1780000
    s_mov_b32 s56, 0xcccccccc
    s_mov_b32 s57, 0xcccccccc
    s_mov_b32 s62, 0xaaaaaaaa
    s_mov_b32 s63, 0xaaaaaaaa
    buffer_load_dwordx4 v2, s[8:11], s61 offen offset:3072 sc1 lds
    s_add_u32 m0, m0, 4096
    s_add_u32 s61, s61, 4096
    buffer_load_dwordx4 v2, s[8:11], s61 offen offset:0 sc1 lds
    buffer_load_dwordx4 v2, s[8:11], s61 offen offset:1024 sc1 lds
    s_cmp_eq_u32 s3, 3
    s_cbranch_scc0 L36
    s_mov_b32 s53, 200000
L37:
    buffer_load_dword v189, v188, s[8:11], 0 offen sc1
    s_waitcnt vmcnt(0)
    v_cmp_ne_u32 vcc, s52, v189
    s_nop 0
    s_cmp_eq_u64 vcc, 0
    s_cbranch_scc1 L38
    s_sub_u32 s53, s53, 1
    s_cmp_lg_u32 s53, 0
    s_cbranch_scc1 L37
L38:
L36:
    s_barrier
    buffer_load_dwordx4 a[100:103], v2, s[8:11], s94 offen offset:0 sc1
    buffer_load_dwordx4 a[104:107], v2, s[8:11], s94 offen offset:1024 sc1
    buffer_load_dwordx4 a[108:111], v2, s[8:11], s94 offen offset:2048 sc1
    buffer_load_dwordx4 a[112:115], v2, s[8:11], s94 offen offset:3072 sc1
    buffer_load_dwordx4 a[116:119], v8, s[8:11], s94 offen offset:0 sc1
    buffer_load_dwordx4 a[120:123], v2, s[8:11], s95 offen offset:0 sc1
    buffer_load_dwordx4 a[124:127], v2, s[8:11], s95 offen offset:1024 sc1
    s_waitcnt vmcnt(6)
    v_mfma_f32_16x16x32_bf16 v[16:19], a[0:3], a[100:103], 0
    buffer_load_dwordx4 a[128:131], v2, s[8:11], s95 offen offset:2048 sc1
    v_mfma_f32_16x16x32_bf16 v[20:23], a[4:7], a[100:103], 0
    v_mfma_f32_16x16x32_bf16 v[24:27], a[8:11], a[100:103], 0
    buffer_load_dwordx4 a[132:135], v2, s[8:11], s95 offen offset:3072 sc1
    v_mfma_f32_16x16x32_bf16 v[28:31], a[12:15], a[100:103], 0
    v_mfma_f32_16x16x32_bf16 v[32:35], a[16:19], a[100:103], 0
    s_waitcnt vmcnt(7)
    buffer_load_dwordx4 a[136:139], v8, s[8:11], s95 offen offset:0 sc1
    v_mfma_f32_16x16x32_bf16 v[16:19], a[20:23], a[104:107], v[16:19]
    v_mfma_f32_16x16x32_bf16 v[20:23], a[24:27], a[104:107], v[20:23]
    buffer_load_dwordx4 a[140:143], v2, s[8:11], s96 offen offset:0 sc1
    v_mfma_f32_16x16x32_bf16 v[24:27], a[28:31], a[104:107], v[24:27]
    v_mfma_f32_16x16x32_bf16 v[28:31], a[32:35], a[104:107], v[28:31]
    buffer_load_dwordx4 a[144:147], v2, s[8:11], s96 offen offset:1024 sc1
    v_mfma_f32_16x16x32_bf16 v[32:35], a[36:39], a[104:107], v[32:35]
    s_waitcnt vmcnt(9)
    v_mfma_f32_16x16x32_bf16 v[16:19], a[40:43], a[108:111], v[16:19]
    buffer_load_dwordx4 a[148:151], v2, s[8:11], s96 offen offset:2048 sc1
    v_mfma_f32_16x16x32_bf16 v[20:23], a[44:47], a[108:111], v[20:23]
    v_mfma_f32_16x16x32_bf16 v[24:27], a[48:51], a[108:111], v[24:27]
    buffer_load_dwordx4 a[152:155], v2, s[8:11], s96 offen offset:3072 sc1
    v_mfma_f32_16x16x32_bf16 v[28:31], a[52:55], a[108:111], v[28:31]
    v_mfma_f32_16x16x32_bf16 v[32:35], a[56:59], a[108:111], v[32:35]
    s_waitcnt vmcnt(10)
    buffer_load_dwordx4 a[156:159], v8, s[8:11], s96 offen offset:0 sc1
    v_mfma_f32_16x16x32_bf16 v[16:19], a[60:63], a[112:115], v[16:19]
    v_mfma_f32_16x16x32_bf16 v[20:23], a[64:67], a[112:115], v[20:23]
    buffer_load_dwordx4 a[160:163], v2, s[8:11], s97 offen offset:0 sc1
    v_mfma_f32_16x16x32_bf16 v[24:27], a[68:71], a[112:115], v[24:27]
    v_mfma_f32_16x16x32_bf16 v[28:31], a[72:75], a[112:115], v[28:31]
    buffer_load_dwordx4 a[164:167], v2, s[8:11], s97 offen offset:1024 sc1
    v_mfma_f32_16x16x32_bf16 v[32:35], a[76:79], a[112:115], v[32:35]
    s_waitcnt vmcnt(12)
    v_mfma_f32_16x16x32_bf16 v[16:19], a[80:83], a[116:119], v[16:19]
    buffer_load_dwordx4 a[168:171], v2, s[8:11], s97 offen offset:2048 sc1
    v_mfma_f32_16x16x32_bf16 v[20:23], a[84:87], a[116:119], v[20:23]
    v_mfma_f32_16x16x32_bf16 v[24:27], a[88:91], a[116:119], v[24:27]
    buffer_load_dwordx4 a[172:175], v2, s[8:11], s97 offen offset:3072 sc1
    v_mfma_f32_16x16x32_bf16 v[28:31], a[92:95], a[116:119], v[28:31]
    v_mfma_f32_16x16x32_bf16 v[32:35], a[96:99], a[116:119], v[32:35]
    s_waitcnt vmcnt(13)
    buffer_load_dwordx4 a[176:179], v8, s[8:11], s97 offen offset:0 sc1
    buffer_load_dwordx4 v[220:223], v216, s[8:11], 0 offen sc1
    v_mfma_f32_16x16x32_bf16 v[36:39], a[0:3], a[120:123], 0
    v_add_u32 v6, s98, v2
    v_mfma_f32_16x16x32_bf16 v[40:43], a[4:7], a[120:123], 0
    ds_write_b128 v6, v[16:19] offset:0
    v_mfma_f32_16x16x32_bf16 v[44:47], a[8:11], a[120:123], 0
    ds_write_b128 v6, v[20:23] offset:1024
    v_mfma_f32_16x16x32_bf16 v[48:51], a[12:15], a[120:123], 0
    ds_write_b128 v6, v[24:27] offset:2048
    v_mfma_f32_16x16x32_bf16 v[52:55], a[16:19], a[120:123], 0
    s_waitcnt vmcnt(14)
    ds_write_b128 v6, v[28:31] offset:3072
    v_mfma_f32_16x16x32_bf16 v[36:39], a[20:23], a[124:127], v[36:39]
    ds_write_b128 v6, v[32:35] offset:4096
    v_mfma_f32_16x16x32_bf16 v[40:43], a[24:27], a[124:127], v[40:43]
    v_mfma_f32_16x16x32_bf16 v[44:47], a[28:31], a[124:127], v[44:47]
    v_mfma_f32_16x16x32_bf16 v[48:51], a[32:35], a[124:127], v[48:51]
    s_waitcnt lgkmcnt(0)
    s_barrier
    ds_read_b128 v[16:19], v7 offset:0
    v_mfma_f32_16x16x32_bf16 v[52:55], a[36:39], a[124:127], v[52:55]
    s_waitcnt vmcnt(13)
    ds_read_b128 v[20:23], v7 offset:1024
    ds_read_b128 v[24:27], v7 offset:2048
    v_mfma_f32_16x16x32_bf16 v[36:39], a[40:43], a[128:131], v[36:39]
    ds_read_b128 v[28:31], v7 offset:3072
    ds_read_b128 v[32:35], v7 offset:4096
    v_mfma_f32_16x16x32_bf16 v[40:43], a[44:47], a[128:131], v[40:43]
    v_mfma_f32_16x16x32_bf16 v[44:47], a[48:51], a[128:131], v[44:47]
    v_mfma_f32_16x16x32_bf16 v[48:51], a[52:55], a[128:131], v[48:51]
    v_mfma_f32_16x16x32_bf16 v[52:55], a[56:59], a[128:131], v[52:55]
    s_waitcnt vmcnt(12)
    s_waitcnt lgkmcnt(4)
    v_fmac_f32 v136, v16, v96
    v_mfma_f32_16x16x32_bf16 v[36:39], a[60:63], a[132:135], v[36:39]
    v_fmac_f32 v137, v17, v97
    v_fmac_f32 v138, v18, v98
    v_mfma_f32_16x16x32_bf16 v[40:43], a[64:67], a[132:135], v[40:43]
    v_fmac_f32 v139, v19, v99
    s_waitcnt lgkmcnt(3)
    v_mfma_f32_16x16x32_bf16 v[44:47], a[68:71], a[132:135], v[44:47]
    v_fmac_f32 v140, v20, v100
    v_fmac_f32 v141, v21, v101
    v_mfma_f32_16x16x32_bf16 v[48:51], a[72:75], a[132:135], v[48:51]
    v_fmac_f32 v142, v22, v102
    v_fmac_f32 v143, v23, v103
    v_mfma_f32_16x16x32_bf16 v[52:55], a[76:79], a[132:135], v[52:55]
    s_waitcnt vmcnt(11)
    s_waitcnt lgkmcnt(2)
    v_fmac_f32 v144, v24, v104
    v_mfma_f32_16x16x32_bf16 v[36:39], a[80:83], a[136:139], v[36:39]
    v_fmac_f32 v145, v25, v105
    v_fmac_f32 v146, v26, v106
    v_mfma_f32_16x16x32_bf16 v[40:43], a[84:87], a[136:139], v[40:43]
    v_fmac_f32 v147, v27, v107
    s_waitcnt lgkmcnt(1)
    v_mfma_f32_16x16x32_bf16 v[44:47], a[88:91], a[136:139], v[44:47]
    v_fmac_f32 v148, v28, v108
    v_fmac_f32 v149, v29, v109
    v_mfma_f32_16x16x32_bf16 v[48:51], a[92:95], a[136:139], v[48:51]
    v_fmac_f32 v150, v30, v110
    v_fmac_f32 v151, v31, v111
    v_mfma_f32_16x16x32_bf16 v[52:55], a[96:99], a[136:139], v[52:55]
    s_waitcnt vmcnt(10)
    s_waitcnt lgkmcnt(0)
    v_fmac_f32 v152, v32, v112
    v_mfma_f32_16x16x32_bf16 v[56:59], a[0:3], a[140:143], 0
    v_fmac_f32 v153, v33, v113
    v_fmac_f32 v154, v34, v114
    v_mfma_f32_16x16x32_bf16 v[60:63], a[4:7], a[140:143], 0
    v_fmac_f32 v155, v35, v115
    v_add_u32 v6, s99, v2
    v_mfma_f32_16x16x32_bf16 v[64:67], a[8:11], a[140:143], 0
    ds_write_b128 v6, v[36:39] offset:0
    ds_write_b128 v6, v[40:43] offset:1024
    v_mfma_f32_16x16x32_bf16 v[68:71], a[12:15], a[140:143], 0
    ds_write_b128 v6, v[44:47] offset:2048
    v_mfma_f32_16x16x32_bf16 v[72:75], a[16:19], a[140:143], 0
    s_waitcnt vmcnt(9)
    ds_write_b128 v6, v[48:51] offset:3072
    v_mfma_f32_16x16x32_bf16 v[56:59], a[20:23], a[144:147], v[56:59]
    ds_write_b128 v6, v[52:55] offset:4096
    v_mfma_f32_16x16x32_bf16 v[60:63], a[24:27], a[144:147], v[60:63]
    v_mfma_f32_16x16x32_bf16 v[64:67], a[28:31], a[144:147], v[64:67]
    v_mfma_f32_16x16x32_bf16 v[68:71], a[32:35], a[144:147], v[68:71]
    s_waitcnt lgkmcnt(0)
    s_barrier
    ds_read_b128 v[36:39], v7 offset:5120
    v_mfma_f32_16x16x32_bf16 v[72:75], a[36:39], a[144:147], v[72:75]
    s_waitcnt vmcnt(8)
    ds_read_b128 v[40:43], v7 offset:6144
    ds_read_b128 v[44:47], v7 offset:7168
    v_mfma_f32_16x16x32_bf16 v[56:59], a[40:43], a[148:151], v[56:59]
    ds_read_b128 v[48:51], v7 offset:8192
    ds_read_b128 v[52:55], v7 offset:9216
    v_mfma_f32_16x16x32_bf16 v[60:63], a[44:47], a[148:151], v[60:63]
    v_mfma_f32_16x16x32_bf16 v[64:67], a[48:51], a[148:151], v[64:67]
    v_mfma_f32_16x16x32_bf16 v[68:71], a[52:55], a[148:151], v[68:71]
    v_mfma_f32_16x16x32_bf16 v[72:75], a[56:59], a[148:151], v[72:75]
    s_waitcnt vmcnt(7)
    s_waitcnt lgkmcnt(4)
    v_fmac_f32 v136, v36, v96
    v_mfma_f32_16x16x32_bf16 v[56:59], a[60:63], a[152:155], v[56:59]
    v_fmac_f32 v137, v37, v97
    v_fmac_f32 v138, v38, v98
    v_mfma_f32_16x16x32_bf16 v[60:63], a[64:67], a[152:155], v[60:63]
    s_waitcnt vmcnt(0)
    v_xor_b32 v220, s52, v220
    v_xor_b32 v221, s52, v221
    v_xor_b32 v222, s52, v222
    v_xor_b32 v223, s52, v223
    v_or3_b32 v220, v220, v221, v222
    v_or_b32 v220, v220, v223
    v_cmp_ne_u32 vcc, 0, v220
    s_nop 0
    s_cmp_lg_u64 vcc, 0
    s_cbranch_scc1 L39
L40:
    v_mfma_f32_16x16x32_bf16 v[64:67], a[68:71], a[152:155], v[64:67]
    buffer_store_dword v14, v15, s[8:11], s101 offen sc1
    s_add_u32 s33, s37, 0
    v_mfma_f32_16x16x32_bf16 v[68:71], a[72:75], a[152:155], v[68:71]
    v_fmac_f32 v139, v39, v99
    s_waitcnt lgkmcnt(3)
    v_mfma_f32_16x16x32_bf16 v[72:75], a[76:79], a[152:155], v[72:75]
    v_fmac_f32 v140, v40, v100
    v_fmac_f32 v141, v41, v101
    v_mfma_f32_16x16x32_bf16 v[56:59], a[80:83], a[156:159], v[56:59]
    buffer_load_dwordx4 a[180:183], v2, s[8:11], s33 offen offset:0 sc1
    v_fmac_f32 v142, v42, v102
    v_mfma_f32_16x16x32_bf16 v[60:63], a[84:87], a[156:159], v[60:63]
    v_fmac_f32 v143, v43, v103
    s_waitcnt lgkmcnt(2)
    v_mfma_f32_16x16x32_bf16 v[64:67], a[88:91], a[156:159], v[64:67]
    v_fmac_f32 v144, v44, v104
    v_fmac_f32 v145, v45, v105
    v_mfma_f32_16x16x32_bf16 v[68:71], a[92:95], a[156:159], v[68:71]
    v_fmac_f32 v146, v46, v106
    v_fmac_f32 v147, v47, v107
    v_mfma_f32_16x16x32_bf16 v[72:75], a[96:99], a[156:159], v[72:75]
    s_waitcnt lgkmcnt(1)
    buffer_load_dwordx4 a[184:187], v2, s[8:11], s33 offen offset:1024 sc1
    v_fmac_f32 v148, v48, v108
    v_mfma_f32_16x16x32_bf16 v[76:79], a[0:3], a[160:163], 0
    v_fmac_f32 v149, v49, v109
    v_fmac_f32 v150, v50, v110
    v_mfma_f32_16x16x32_bf16 v[80:83], a[4:7], a[160:163], 0
    v_fmac_f32 v151, v51, v111
    s_waitcnt lgkmcnt(0)
    v_mfma_f32_16x16x32_bf16 v[84:87], a[8:11], a[160:163], 0
    v_fmac_f32 v152, v52, v112
    v_fmac_f32 v153, v53, v113
    v_mfma_f32_16x16x32_bf16 v[88:91], a[12:15], a[160:163], 0
    buffer_load_dwordx4 a[188:191], v2, s[8:11], s33 offen offset:2048 sc1
    v_fmac_f32 v154, v54, v114
    v_mfma_f32_16x16x32_bf16 v[92:95], a[16:19], a[160:163], 0
    v_fmac_f32 v155, v55, v115
    v_add_u32 v6, s100, v2
    v_mfma_f32_16x16x32_bf16 v[76:79], a[20:23], a[164:167], v[76:79]
    ds_write_b128 v6, v[56:59] offset:0
    ds_write_b128 v6, v[60:63] offset:1024
    v_mfma_f32_16x16x32_bf16 v[80:83], a[24:27], a[164:167], v[80:83]
    ds_write_b128 v6, v[64:67] offset:2048
    ds_write_b128 v6, v[68:71] offset:3072
    v_mfma_f32_16x16x32_bf16 v[84:87], a[28:31], a[164:167], v[84:87]
    buffer_load_dwordx4 a[192:195], v2, s[8:11], s33 offen offset:3072 sc1
    ds_write_b128 v6, v[72:75] offset:4096
    v_mfma_f32_16x16x32_bf16 v[88:91], a[32:35], a[164:167], v[88:91]
    s_waitcnt lgkmcnt(0)
    s_barrier
    ds_read_b128 v[56:59], v7 offset:10240
    v_mfma_f32_16x16x32_bf16 v[92:95], a[36:39], a[164:167], v[92:95]
    ds_read_b128 v[60:63], v7 offset:11264
    ds_read_b128 v[64:67], v7 offset:12288
    v_mfma_f32_16x16x32_bf16 v[76:79], a[40:43], a[168:171], v[76:79]
    ds_read_b128 v[68:71], v7 offset:13312
    ds_read_b128 v[72:75], v7 offset:14336
    v_mfma_f32_16x16x32_bf16 v[80:83], a[44:47], a[168:171], v[80:83]
    buffer_load_dwordx4 a[196:199], v8, s[8:11], s33 offen offset:0 sc1
    s_add_u32 s33, s37, 20480
    v_mfma_f32_16x16x32_bf16 v[84:87], a[48:51], a[168:171], v[84:87]
    v_mfma_f32_16x16x32_bf16 v[88:91], a[52:55], a[168:171], v[88:91]
    v_mfma_f32_16x16x32_bf16 v[92:95], a[56:59], a[168:171], v[92:95]
    s_waitcnt lgkmcnt(4)
    v_fmac_f32 v136, v56, v96
    v_fmac_f32 v137, v57, v97
    v_mfma_f32_16x16x32_bf16 v[76:79], a[60:63], a[172:175], v[76:79]
    v_fmac_f32 v138, v58, v98
    v_fmac_f32 v139, v59, v99
    v_mfma_f32_16x16x32_bf16 v[80:83], a[64:67], a[172:175], v[80:83]
    s_waitcnt lgkmcnt(3)
    buffer_load_dwordx4 a[200:203], v2, s[8:11], s33 offen offset:0 sc1
    v_fmac_f32 v140, v60, v100
    v_mfma_f32_16x16x32_bf16 v[84:87], a[68:71], a[172:175], v[84:87]
    v_fmac_f32 v141, v61, v101
    v_fmac_f32 v142, v62, v102
    v_mfma_f32_16x16x32_bf16 v[88:91], a[72:75], a[172:175], v[88:91]
    v_fmac_f32 v143, v63, v103
    s_waitcnt lgkmcnt(2)
    v_mfma_f32_16x16x32_bf16 v[92:95], a[76:79], a[172:175], v[92:95]
    v_fmac_f32 v144, v64, v104
    v_fmac_f32 v145, v65, v105
    v_mfma_f32_16x16x32_bf16 v[76:79], a[80:83], a[176:179], v[76:79]
    buffer_load_dwordx4 a[204:207], v2, s[8:11], s33 offen offset:1024 sc1
    v_fmac_f32 v146, v66, v106
    v_mfma_f32_16x16x32_bf16 v[80:83], a[84:87], a[176:179], v[80:83]
    v_fmac_f32 v147, v67, v107
    s_waitcnt lgkmcnt(1)
    v_mfma_f32_16x16x32_bf16 v[84:87], a[88:91], a[176:179], v[84:87]
    v_fmac_f32 v148, v68, v108
    v_fmac_f32 v149, v69, v109
    v_mfma_f32_16x16x32_bf16 v[88:91], a[92:95], a[176:179], v[88:91]
    v_fmac_f32 v150, v70, v110
    v_fmac_f32 v151, v71, v111
    v_mfma_f32_16x16x32_bf16 v[92:95], a[96:99], a[176:179], v[92:95]
    s_waitcnt lgkmcnt(0)
    buffer_load_dwordx4 a[208:211], v2, s[8:11], s33 offen offset:2048 sc1
    v_fmac_f32 v152, v72, v112
    v_fmac_f32 v153, v73, v113
    v_fmac_f32 v154, v74, v114
    v_fmac_f32 v155, v75, v115
    buffer_load_dwordx4 a[212:215], v2, s[8:11], s33 offen offset:3072 sc1
    v_pk_fma_f32 v[136:137], v[76:77], v[96:97], v[136:137]
    v_pk_fma_f32 v[138:139], v[78:79], v[98:99], v[138:139]
    v_pk_fma_f32 v[140:141], v[80:81], v[100:101], v[140:141]
    v_pk_fma_f32 v[142:143], v[82:83], v[102:103], v[142:143]
    v_pk_fma_f32 v[144:145], v[84:85], v[104:105], v[144:145]
    v_pk_fma_f32 v[146:147], v[86:87], v[106:107], v[146:147]
    v_pk_fma_f32 v[148:149], v[88:89], v[108:109], v[148:149]
    v_pk_fma_f32 v[150:151], v[90:91], v[110:111], v[150:151]
    v_pk_fma_f32 v[152:153], v[92:93], v[112:113], v[152:153]
    v_pk_fma_f32 v[154:155], v[94:95], v[114:115], v[154:155]
    v_pk_mul_f32 v[16:17], v[136:137], v[116:117]
    v_pk_mul_f32 v[18:19], v[138:139], v[118:119]
    v_pk_mul_f32 v[20:21], v[140:141], v[120:121]
    v_pk_mul_f32 v[22:23], v[142:143], v[122:123]
    v_pk_mul_f32 v[24:25], v[144:145], v[124:125]
    v_pk_mul_f32 v[26:27], v[146:147], v[126:127]
    v_pk_mul_f32 v[28:29], v[148:149], v[128:129]
    v_pk_mul_f32 v[30:31], v[150:151], v[130:131]
    v_pk_mul_f32 v[32:33], v[152:153], v[132:133]
    v_pk_mul_f32 v[34:35], v[154:155], v[134:135]
    v_cvt_pk_bf16_f32 v184, v16, v17
    v_cvt_pk_bf16_f32 v185, v18, v19
    v_cvt_pk_bf16_f32 v186, v20, v21
    v_cvt_pk_bf16_f32 v187, v22, v23
    v_cvt_pk_bf16_f32 v188, v24, v25
    v_cvt_pk_bf16_f32 v189, v26, v27
    v_cvt_pk_bf16_f32 v190, v28, v29
    v_cvt_pk_bf16_f32 v191, v30, v31
    v_cvt_pk_bf16_f32 v192, v32, v33
    v_cvt_pk_bf16_f32 v193, v34, v35
    v_cvt_pk_bf16_f32 v212, v32, v33
    v_cvt_pk_bf16_f32 v213, v34, v35
    v_cvt_pk_bf16_f32 v214, v32, v33
    v_cvt_pk_bf16_f32 v215, v34, v35
    v_mfma_f32_16x16x32_bf16 v[200:203], v[184:187], v[184:187], 0
    v_cvt_pk_bf16_f32 v172, v136, v137
    v_cvt_pk_bf16_f32 v173, v138, v139
    v_mfma_f32_16x16x32_bf16 v[196:199], v[156:159], v[184:187], 0
    v_cvt_pk_bf16_f32 v174, v140, v141
    v_cvt_pk_bf16_f32 v175, v142, v143
    v_mfma_f32_16x16x32_bf16 v[200:203], v[188:191], v[188:191], v[200:203]
    v_cvt_pk_bf16_f32 v176, v144, v145
    v_cvt_pk_bf16_f32 v177, v146, v147
    v_mfma_f32_16x16x32_bf16 v[196:199], v[160:163], v[188:191], v[196:199]
    v_cvt_pk_bf16_f32 v178, v148, v149
    v_cvt_pk_bf16_f32 v179, v150, v151
    v_mfma_f32_16x16x32_bf16 v[200:203], v[192:195], v[192:195], v[200:203]
    v_cvt_pk_bf16_f32 v180, v152, v153
    v_cvt_pk_bf16_f32 v181, v154, v155
    v_mfma_f32_16x16x32_bf16 v[196:199], v[164:167], v[192:195], v[196:199]
    v_permlane16_swap_b32 v212, v214
    v_permlane16_swap_b32 v213, v215
    v_mfma_f32_16x16x32_bf16 v[204:207], v[172:175], v[172:175], 0
    buffer_store_dwordx4 v[184:187], v2, s[8:11], s54 offen sc1
    v_mfma_f32_16x16x32_bf16 v[196:199], v[168:171], v[172:175], v[196:199]
    v_mfma_f32_16x16x32_bf16 v[204:207], v[176:179], v[176:179], v[204:207]
    buffer_store_dwordx4 v[188:191], v2, s[8:11], s54 offen offset:1024 sc1
    v_mfma_f32_16x16x32_bf16 v[196:199], v[168:171], v[176:179], v[196:199]
    v_mfma_f32_16x16x32_bf16 v[204:207], v[180:183], v[180:183], v[204:207]
    buffer_store_dwordx4 v[212:215], v13, s[8:11], s55 offen sc1
    v_mfma_f32_16x16x32_bf16 v[196:199], v[168:171], v[180:183], v[196:199]
    v_cndmask_b32 v200, v200, v201, s[62:63]
    v_cndmask_b32 v202, v202, v203, s[62:63]
    v_cndmask_b32 v208, v200, v202, s[56:57]
    s_nop 2
    v_cndmask_b32 v204, v204, v205, s[62:63]
    v_cndmask_b32 v206, v206, v207, s[62:63]
    v_cndmask_b32 v209, v204, v206, s[56:57]
    s_mov_b32 exec_lo, 0x00f0000f
    s_mov_b32 exec_hi, 0xf0000f00
    buffer_store_dwordx2 v[208:209], v210, s[8:11], s58 offen offset:256 sc1
    s_mov_b64 exec, 0xffff
    buffer_store_dwordx4 v[196:199], v2, s[8:11], s58 offen sc1
    s_mov_b64 exec, -1
    s_mul_i32 s55, s29, 21504
    s_mul_i32 s61, s36, 20480
    s_add_u32 s61, s61, 0x1300000
    s_add_u32 s22, s61, 10240
    s_add_u32 s63, s61, 15360
    s_add_u32 s54, s28, 1
    s_mul_i32 s54, s54, 20480
    s_add_u32 s54, s54, 0x1303c00
    s_cmp_eq_u32 s3, 3
    s_cselect_b32 m0, 101376, s55
    s_cselect_b32 s61, s54, s61
    s_cselect_b32 s22, s63, s22
    s_cselect_b32 s20, 17, 1
    s_cselect_b32 s21, 16, 1
    s_lshl_b32 s20, s20, 10
    s_lshl_b32 s21, s21, 10
    s_barrier
    buffer_load_dwordx4 v2, s[8:11], s61 offen offset:0 sc1 lds
    v_and_b32 v245, 3, v4
    v_mov_b32 v244, 156800
    v_mov_b32 v246, 155200
    v_cmp_eq_u32 vcc, 0, v245
    v_mov_b32 v247, 153600
    s_lshl_b32 s54, s28, 5
    v_cndmask_b32 v244, v244, v246, vcc
    v_cmp_eq_u32 vcc, 1, v245
    v_mov_b32 v216, 0
    v_mov_b32 v217, 0
    v_cndmask_b32 v244, v244, v247, vcc
    v_lshl_add_u32 v244, v5, 4, v244
    s_lshl_b32 s55, s36, 5
    s_add_u32 s54, s54, 158848
    s_add_u32 s55, s55, 158848
    buffer_load_dwordx4 v2, s[8:11], s61 offen offset:1024 sc1 lds
    v_lshl_add_u32 v245, v4, 1, s54
    v_lshl_add_u32 v246, v4, 1, s55
    ds_read_u16_d16_hi v216, v245
    ds_read_u16_d16_hi v217, v246
    ds_read_b128 v[16:19], v244 offset:0
    ds_read_b128 v[20:23], v244 offset:64
    ds_read_b128 v[24:27], v244 offset:128
    ds_read_b128 v[28:31], v244 offset:192
    ds_read_b128 v[32:35], v244 offset:256
    ds_read_b128 v[36:39], v244 offset:320
    ds_read_b128 v[40:43], v244 offset:384
    ds_read_b128 v[44:47], v244 offset:448
    ds_read_b128 v[48:51], v244 offset:512
    ds_read_b128 v[52:55], v244 offset:576
    ds_read_b128 v[56:59], v244 offset:640
    buffer_load_dwordx4 v2, s[8:11], s61 offen offset:2048 sc1 lds
    ds_read_b128 v[60:63], v244 offset:704
    ds_read_b128 v[64:67], v244 offset:768
    ds_read_b128 v[68:71], v244 offset:832
    ds_read_b128 v[72:75], v244 offset:896
    ds_read_b128 v[76:79], v244 offset:960
    ds_read_b128 v[80:83], v244 offset:1024
    ds_read_b128 v[84:87], v244 offset:1088
    ds_read_b128 v[88:91], v244 offset:1152
    ds_read_b128 v[92:95], v244 offset:1216
    s_add_u32 s58, s1, 0x1000c
    s_cmp_eq_u32 s3, 0
    s_cselect_b32 s58, s58, 0x7ffffff0
    s_add_u32 s54, s27, 0x1000c
    v_lshl_add_u32 v240, v4, 11, s54
    s_mul_i32 s54, s3, 21504
    buffer_load_dwordx4 v2, s[8:11], s61 offen offset:3072 sc1 lds
    v_add_u32 v228, s54, v2
    ds_read_b128 v[96:99], v228 offset:0
    ds_read_b128 v[100:103], v228 offset:1024
    ds_read_b128 v[104:107], v228 offset:2048
    ds_read_b128 v[108:111], v228 offset:3072
    ds_read_b128 v[112:115], v228 offset:4096
    ds_read_b128 v[116:119], v228 offset:5120
    ds_read_b128 v[120:123], v228 offset:6144
    ds_read_b128 v[124:127], v228 offset:7168
    s_waitcnt lgkmcnt(7)
    v_mfma_f32_16x16x32_bf16 v[224:227], v[16:19], v[96:99], 0
    s_waitcnt lgkmcnt(6)
    s_add_u32 m0, m0, 4096
    s_add_u32 s61, s61, 4096
    buffer_load_dwordx4 v2, s[8:11], s61 offen offset:0 sc1 lds
    ds_read_b128 v[96:99], v228 offset:8192
    v_mfma_f32_16x16x32_bf16 v[224:227], v[20:23], v[100:103], v[224:227]
    s_waitcnt lgkmcnt(6)
    ds_read_b128 v[100:103], v228 offset:9216
    v_mfma_f32_16x16x32_bf16 v[224:227], v[24:27], v[104:107], v[224:227]
    s_waitcnt lgkmcnt(6)
    ds_read_b128 v[104:107], v228 offset:10240
    v_mfma_f32_16x16x32_bf16 v[224:227], v[28:31], v[108:111], v[224:227]
    s_add_u32 m0, m0, s20
    s_add_u32 s61, s61, s21
    buffer_load_dwordx4 v2, s[8:11], s61 offen offset:0 sc1 lds
    s_waitcnt lgkmcnt(6)
    ds_read_b128 v[108:111], v228 offset:11264
    v_mfma_f32_16x16x32_bf16 v[224:227], v[32:35], v[112:115], v[224:227]
    s_waitcnt lgkmcnt(6)
    ds_read_b128 v[112:115], v228 offset:12288
    v_mfma_f32_16x16x32_bf16 v[224:227], v[36:39], v[116:119], v[224:227]
    s_waitcnt lgkmcnt(6)
    ds_read_b128 v[116:119], v228 offset:13312
    v_mfma_f32_16x16x32_bf16 v[224:227], v[40:43], v[120:123], v[224:227]
    buffer_load_dwordx4 v2, s[8:11], s61 offen offset:1024 sc1 lds
    s_waitcnt lgkmcnt(6)
    ds_read_b128 v[120:123], v228 offset:14336
    v_mfma_f32_16x16x32_bf16 v[224:227], v[44:47], v[124:127], v[224:227]
    s_waitcnt lgkmcnt(6)
    ds_read_b128 v[124:127], v228 offset:15360
    v_mfma_f32_16x16x32_bf16 v[224:227], v[48:51], v[96:99], v[224:227]
    s_waitcnt lgkmcnt(6)
    ds_read_b128 v[96:99], v228 offset:16384
    v_mfma_f32_16x16x32_bf16 v[224:227], v[52:55], v[100:103], v[224:227]
    s_waitcnt lgkmcnt(6)
    ds_read_b128 v[100:103], v228 offset:17408
    v_mfma_f32_16x16x32_bf16 v[224:227], v[56:59], v[104:107], v[224:227]
    s_waitcnt lgkmcnt(6)
    ds_read_b128 v[104:107], v228 offset:18432
    v_mfma_f32_16x16x32_bf16 v[224:227], v[60:63], v[108:111], v[224:227]
    s_waitcnt lgkmcnt(6)
    ds_read_b128 v[108:111], v228 offset:19456
    v_mfma_f32_16x16x32_bf16 v[224:227], v[64:67], v[112:115], v[224:227]
    s_waitcnt lgkmcnt(6)
    v_mfma_f32_16x16x32_bf16 v[224:227], v[68:71], v[116:119], v[224:227]
    s_waitcnt lgkmcnt(5)
    v_mfma_f32_16x16x32_bf16 v[224:227], v[72:75], v[120:123], v[224:227]
    s_waitcnt lgkmcnt(4)
    v_mfma_f32_16x16x32_bf16 v[224:227], v[76:79], v[124:127], v[224:227]
    s_waitcnt lgkmcnt(3)
    v_mfma_f32_16x16x32_bf16 v[224:227], v[80:83], v[96:99], v[224:227]
    s_waitcnt lgkmcnt(2)
    v_mfma_f32_16x16x32_bf16 v[224:227], v[84:87], v[100:103], v[224:227]
    s_waitcnt lgkmcnt(1)
    v_mfma_f32_16x16x32_bf16 v[224:227], v[88:91], v[104:107], v[224:227]
    s_waitcnt lgkmcnt(0)
    v_mfma_f32_16x16x32_bf16 v[224:227], v[92:95], v[108:111], v[224:227]
    s_waitcnt vmcnt(7)
    s_barrier
    buffer_store_dword v14, v15, s[8:11], s58 offen sc1
    buffer_load_dwordx4 v2, s[8:11], s61 offen offset:2048 sc1 lds
    v_mfma_f32_16x16x32_bf16 v[220:223], v[16:19], v[16:19], 0
    v_mfma_f32_16x16x32_bf16 v[220:223], v[20:23], v[20:23], v[220:223]
    v_mfma_f32_16x16x32_bf16 v[220:223], v[24:27], v[24:27], v[220:223]
    v_mfma_f32_16x16x32_bf16 v[220:223], v[28:31], v[28:31], v[220:223]
    buffer_load_dwordx4 v2, s[8:11], s61 offen offset:3072 sc1 lds
    v_mfma_f32_16x16x32_bf16 v[220:223], v[32:35], v[32:35], v[220:223]
    v_mfma_f32_16x16x32_bf16 v[220:223], v[36:39], v[36:39], v[220:223]
    v_mfma_f32_16x16x32_bf16 v[220:223], v[40:43], v[40:43], v[220:223]
    v_mfma_f32_16x16x32_bf16 v[220:223], v[44:47], v[44:47], v[220:223]
    s_add_u32 m0, m0, 4096
    s_add_u32 s61, s61, 4096
    buffer_load_dwordx4 v2, s[8:11], s61 offen offset:0 sc1 lds
    v_mfma_f32_16x16x32_bf16 v[220:223], v[48:51], v[48:51], v[220:223]
    v_mfma_f32_16x16x32_bf16 v[220:223], v[52:55], v[52:55], v[220:223]
    v_mfma_f32_16x16x32_bf16 v[220:223], v[56:59], v[56:59], v[220:223]
    v_mfma_f32_16x16x32_bf16 v[220:223], v[60:63], v[60:63], v[220:223]
    s_add_u32 m0, m0, s20
    s_mov_b32 s61, s22
    buffer_load_dwordx4 v2, s[8:11], s61 offen offset:0 sc1 lds
    v_mfma_f32_16x16x32_bf16 v[220:223], v[64:67], v[64:67], v[220:223]
    v_mfma_f32_16x16x32_bf16 v[220:223], v[68:71], v[68:71], v[220:223]
    v_mfma_f32_16x16x32_bf16 v[220:223], v[72:75], v[72:75], v[220:223]
    v_mfma_f32_16x16x32_bf16 v[220:223], v[76:79], v[76:79], v[220:223]
    buffer_load_dwordx4 v2, s[8:11], s61 offen offset:1024 sc1 lds
    v_mfma_f32_16x16x32_bf16 v[220:223], v[80:83], v[80:83], v[220:223]
    v_mfma_f32_16x16x32_bf16 v[220:223], v[84:87], v[84:87], v[220:223]
    v_mfma_f32_16x16x32_bf16 v[220:223], v[88:91], v[88:91], v[220:223]
    v_mfma_f32_16x16x32_bf16 v[220:223], v[92:95], v[92:95], v[220:223]
    buffer_load_dwordx4 v2, s[8:11], s61 offen offset:2048 sc1 lds
    v_cmp_eq_u32 vcc, 0, v5
    v_cmp_gt_u32 s[56:57], 2, v5
    v_cvt_pk_bf16_f32 v232, v224, v225
    v_cvt_pk_bf16_f32 v233, v226, v216
    v_lshlrev_b32 v236, 16, v232
    v_and_b32 v237, 0xffff0000, v232
    v_lshlrev_b32 v238, 16, v233
    v_sub_f32 v236, v224, v236
    v_sub_f32 v237, v225, v237
    v_sub_f32 v238, v226, v238
    v_cvt_pk_bf16_f32 v234, v236, v237
    v_cvt_pk_bf16_f32 v235, v238, 0
    v_cndmask_b32 v232, 0, v232, s[56:57]
    v_cndmask_b32 v233, 0, v233, s[56:57]
    v_cndmask_b32 v234, 0, v234, vcc
    buffer_load_dwordx4 v2, s[8:11], s61 offen offset:3072 sc1 lds
    v_cndmask_b32 v235, 0, v235, vcc
    ds_write_b128 v228, v[232:235] offset:20480
    v_mul_f32 v220, 0x3acccccd, v220
    v_mul_f32 v221, 0x3acccccd, v221
    v_mul_f32 v222, 0x3acccccd, v222
    v_readlane_b32 s46, v220, 0
    v_readlane_b32 s47, v221, 0
    v_readlane_b32 s101, v222, 0
    v_readlane_b32 s59, v221, 1
    v_readlane_b32 s60, v222, 1
    s_lshl_b32 s63, s24, 3
    s_lshl_b32 s54, s3, 1
    s_add_u32 s63, s63, s54
    s_mul_i32 s62, s63, 20480
    s_add_u32 s62, s62, 0x600000
    s_add_u32 m0, m0, 4096
    s_add_u32 s61, s61, 4096
    buffer_load_dwordx4 v2, s[8:11], s61 offen offset:0 sc1 lds
    s_lshl_b32 s0, s63, 12
    s_add_u32 s0, s0, 0x1780000
    v_and_b32 v242, 1, v5
    v_lshrrev_b32 v243, 1, v5
    v_lshlrev_b32 v242, 12, v242
    v_lshl_add_u32 v243, v243, 11, v242
    v_lshl_add_u32 v242, v4, 4, v243
    v_lshl_add_u32 v243, v4, 3, v243
    v_add_u32 v11, 20480, v2
    s_mul_i32 s55, s3, 14336
    s_add_u32 s55, s55, 0x880000
    s_lshl_b32 s56, s30, 2
    s_add_u32 s54, s3, 1
    s_and_b32 s54, s54, 3
    s_add_u32 s54, s54, s56
    buffer_load_dwordx4 a[216:219], v8, s[8:11], s33 offen offset:0 sc1
    s_mul_i32 s54, s54, 57344
    s_add_u32 s94, s54, s55
    s_add_u32 s54, s3, 2
    s_and_b32 s54, s54, 3
    s_add_u32 s54, s54, s56
    s_mul_i32 s54, s54, 57344
    s_add_u32 s95, s54, s55
    s_add_u32 s54, s3, 3
    s_and_b32 s54, s54, 3
    s_add_u32 s54, s54, s56
    s_mul_i32 s54, s54, 57344
    s_add_u32 s96, s54, s55
    s_add_u32 s54, s3, 4
    s_and_b32 s54, s54, 3
    s_add_u32 s54, s54, s56
    s_add_u32 s33, s37, 35840
    buffer_load_dwordx4 a[220:223], v2, s[8:11], s33 offen offset:0 sc1
    s_mul_i32 s54, s54, 57344
    s_add_u32 s97, s54, s55
    s_lshl_b32 s55, s3, 2
    v_and_b32 v246, 3, v1
    v_add_u32 v246, s55, v246
    s_add_u32 s54, s26, 0x10010
    v_lshrrev_b32 v247, 3, v246
    v_and_b32 v246, 7, v246
    v_lshl_add_u32 v246, v246, 3, v247
    v_lshl_add_u32 v246, v246, 8, s54
    v_mov_b32 v0, v246
    s_mul_i32 s54, s29, 21504
    v_add_u32 v228, s54, v2
    buffer_load_dwordx4 a[224:227], v2, s[8:11], s33 offen offset:1024 sc1
    s_cmp_eq_u32 s3, 3
    s_cbranch_scc0 L41
    s_mov_b32 s53, 200000
L42:
    buffer_load_dword v241, v240, s[8:11], 0 offen sc1
    s_waitcnt vmcnt(0)
    v_cmp_ne_u32 vcc, s52, v241
    s_nop 0
    s_cmp_eq_u64 vcc, 0
    s_cbranch_scc1 L43
    s_sub_u32 s53, s53, 1
    s_cmp_lg_u32 s53, 0
    s_cbranch_scc1 L42
L43:
L41:
    s_waitcnt vmcnt(3)
    s_barrier
    buffer_load_dwordx4 a[0:3], v2, s[8:11], s62 offen offset:0 sc1
    buffer_load_dwordx4 a[4:7], v11, s[8:11], s62 offen offset:0 sc1
    buffer_load_dwordx4 a[8:11], v2, s[8:11], s62 offen offset:1024 sc1
    buffer_load_dwordx4 a[12:15], v11, s[8:11], s62 offen offset:1024 sc1
    ds_read_b128 v[96:99], v228 offset:0
    ds_read_b128 v[100:103], v228 offset:1024
    ds_read_b128 v[104:107], v228 offset:2048
    ds_read_b128 v[108:111], v228 offset:3072
    ds_read_b128 v[112:115], v228 offset:4096
    ds_read_b128 v[116:119], v228 offset:5120
    ds_read_b128 v[120:123], v228 offset:6144
    ds_read_b128 v[124:127], v228 offset:7168
    s_waitcnt lgkmcnt(7)
    v_mfma_f32_16x16x32_bf16 v[224:227], v[16:19], v[96:99], 0
    s_waitcnt lgkmcnt(6)
    ds_read_b128 v[96:99], v228 offset:8192
    buffer_load_dwordx4 a[16:19], v2, s[8:11], s62 offen offset:2048 sc1
    v_mfma_f32_16x16x32_bf16 v[224:227], v[20:23], v[100:103], v[224:227]
    s_waitcnt lgkmcnt(6)
    ds_read_b128 v[100:103], v228 offset:9216
    v_mfma_f32_16x16x32_bf16 v[224:227], v[24:27], v[104:107], v[224:227]
    s_waitcnt lgkmcnt(6)
    ds_read_b128 v[104:107], v228 offset:10240
    v_mfma_f32_16x16x32_bf16 v[224:227], v[28:31], v[108:111], v[224:227]
    s_waitcnt lgkmcnt(6)
    ds_read_b128 v[108:111], v228 offset:11264
    buffer_load_dwordx4 a[20:23], v11, s[8:11], s62 offen offset:2048 sc1
    v_mfma_f32_16x16x32_bf16 v[224:227], v[32:35], v[112:115], v[224:227]
    s_waitcnt lgkmcnt(6)
    ds_read_b128 v[112:115], v228 offset:12288
    v_mfma_f32_16x16x32_bf16 v[224:227], v[36:39], v[116:119], v[224:227]
    s_waitcnt lgkmcnt(6)
    ds_read_b128 v[116:119], v228 offset:13312
    v_mfma_f32_16x16x32_bf16 v[224:227], v[40:43], v[120:123], v[224:227]
    s_waitcnt lgkmcnt(6)
    ds_read_b128 v[120:123], v228 offset:14336
    buffer_load_dwordx4 a[24:27], v2, s[8:11], s62 offen offset:3072 sc1
    v_mfma_f32_16x16x32_bf16 v[224:227], v[44:47], v[124:127], v[224:227]
    s_waitcnt lgkmcnt(6)
    ds_read_b128 v[124:127], v228 offset:15360
    v_mfma_f32_16x16x32_bf16 v[224:227], v[48:51], v[96:99], v[224:227]
    s_waitcnt lgkmcnt(6)
    ds_read_b128 v[96:99], v228 offset:16384
    v_mfma_f32_16x16x32_bf16 v[224:227], v[52:55], v[100:103], v[224:227]
    s_waitcnt lgkmcnt(6)
    ds_read_b128 v[100:103], v228 offset:17408
    buffer_load_dwordx4 a[28:31], v11, s[8:11], s62 offen offset:3072 sc1
    v_mfma_f32_16x16x32_bf16 v[224:227], v[56:59], v[104:107], v[224:227]
    s_waitcnt lgkmcnt(6)
    ds_read_b128 v[104:107], v228 offset:18432
    v_mfma_f32_16x16x32_bf16 v[224:227], v[60:63], v[108:111], v[224:227]
    s_waitcnt lgkmcnt(6)
    ds_read_b128 v[108:111], v228 offset:19456
    v_mfma_f32_16x16x32_bf16 v[224:227], v[64:67], v[112:115], v[224:227]
    s_waitcnt lgkmcnt(6)
    s_add_u32 s62, s62, 4096
    buffer_load_dwordx4 a[32:35], v2, s[8:11], s62 offen offset:0 sc1
    v_mfma_f32_16x16x32_bf16 v[224:227], v[68:71], v[116:119], v[224:227]
    s_waitcnt lgkmcnt(5)
    v_mfma_f32_16x16x32_bf16 v[224:227], v[72:75], v[120:123], v[224:227]
    s_waitcnt lgkmcnt(4)
    v_mfma_f32_16x16x32_bf16 v[224:227], v[76:79], v[124:127], v[224:227]
    s_waitcnt lgkmcnt(3)
    buffer_load_dwordx4 a[36:39], v11, s[8:11], s62 offen offset:0 sc1
    v_mfma_f32_16x16x32_bf16 v[224:227], v[80:83], v[96:99], v[224:227]
    s_waitcnt lgkmcnt(2)
    v_mfma_f32_16x16x32_bf16 v[224:227], v[84:87], v[100:103], v[224:227]
    s_waitcnt lgkmcnt(1)
    v_mfma_f32_16x16x32_bf16 v[224:227], v[88:91], v[104:107], v[224:227]
    s_waitcnt lgkmcnt(0)
    buffer_load_dwordx4 a[40:43], v2, s[8:11], s62 offen offset:1024 sc1
    v_mfma_f32_16x16x32_bf16 v[224:227], v[92:95], v[108:111], v[224:227]
    buffer_load_dwordx4 a[44:47], v11, s[8:11], s62 offen offset:1024 sc1
    v_add_u32 v12, 64512, v2
    v_add_u32 v135, 129024, v2
    ds_read_b128 v[72:75], v2 offset:0
    ds_read_b128 v[76:79], v2 offset:21504
    ds_read_b128 v[80:83], v2 offset:43008
    ds_read_b128 v[84:87], v12 offset:0
    ds_read_b128 v[88:91], v12 offset:21504
    ds_read_b128 v[92:95], v12 offset:43008
    ds_read_b128 v[96:99], v2 offset:1024
    ds_read_b128 v[100:103], v2 offset:22528
    s_waitcnt vmcnt(10) lgkmcnt(7)
    v_mfma_f32_16x16x32_bf16 v[16:19], v[72:75], a[0:3], 0
    buffer_load_dwordx4 a[48:51], v2, s[8:11], s62 offen offset:2048 sc1
    v_cmp_eq_u32 vcc, 0, v5
    v_mfma_f32_16x16x32_bf16 v[20:23], v[72:75], a[4:7], 0
    s_waitcnt lgkmcnt(6)
    ds_read_b128 v[72:75], v2 offset:44032
    v_cmp_gt_u32 s[56:57], 2, v5
    v_mfma_f32_16x16x32_bf16 v[24:27], v[76:79], a[0:3], 0
    v_cvt_pk_bf16_f32 v232, v224, v225
    v_cvt_pk_bf16_f32 v233, v226, v217
    v_mfma_f32_16x16x32_bf16 v[28:31], v[76:79], a[4:7], 0
    s_waitcnt lgkmcnt(6)
    ds_read_b128 v[76:79], v12 offset:1024
    v_lshlrev_b32 v236, 16, v232
    v_mfma_f32_16x16x32_bf16 v[32:35], v[80:83], a[0:3], 0
    buffer_load_dwordx4 a[52:55], v11, s[8:11], s62 offen offset:2048 sc1
    v_and_b32 v237, 0xffff0000, v232
    v_mfma_f32_16x16x32_bf16 v[36:39], v[80:83], a[4:7], 0
    s_waitcnt lgkmcnt(6)
    ds_read_b128 v[80:83], v12 offset:22528
    v_lshlrev_b32 v238, 16, v233
    v_mfma_f32_16x16x32_bf16 v[40:43], v[84:87], a[0:3], 0
    v_sub_f32 v236, v224, v236
    v_sub_f32 v237, v225, v237
    v_mfma_f32_16x16x32_bf16 v[44:47], v[84:87], a[4:7], 0
    s_waitcnt lgkmcnt(6)
    ds_read_b128 v[84:87], v12 offset:44032
    v_sub_f32 v238, v226, v238
    v_mfma_f32_16x16x32_bf16 v[48:51], v[88:91], a[0:3], 0
    buffer_load_dwordx4 v[160:163], v242, s[8:11], s0 offen offset:0 sc1
    v_cvt_pk_bf16_f32 v234, v236, v237
    v_mfma_f32_16x16x32_bf16 v[52:55], v[88:91], a[4:7], 0
    s_waitcnt lgkmcnt(6)
    ds_read_b128 v[88:91], v2 offset:2048
    v_cvt_pk_bf16_f32 v235, v238, 0
    v_mfma_f32_16x16x32_bf16 v[56:59], v[92:95], a[0:3], 0
    v_cndmask_b32 v232, 0, v232, s[56:57]
    v_cndmask_b32 v233, 0, v233, s[56:57]
    v_mfma_f32_16x16x32_bf16 v[60:63], v[92:95], a[4:7], 0
    s_waitcnt vmcnt(11) lgkmcnt(6)
    ds_read_b128 v[92:95], v2 offset:23552
    buffer_load_dwordx2 v[176:177], v243, s[8:11], s0 offen offset:256 sc1
    v_mfma_f32_16x16x32_bf16 v[16:19], v[96:99], a[8:11], v[16:19]
    v_cndmask_b32 v234, 0, v234, vcc
    v_cndmask_b32 v235, 0, v235, vcc
    v_mfma_f32_16x16x32_bf16 v[20:23], v[96:99], a[12:15], v[20:23]
    s_waitcnt lgkmcnt(6)
    ds_read_b128 v[96:99], v2 offset:45056
    ds_write_b128 v228, v[232:235] offset:20480
    v_mfma_f32_16x16x32_bf16 v[24:27], v[100:103], a[8:11], v[24:27]
    s_lshr_b32 s54, s25, 1
    buffer_load_dwordx4 a[56:59], v2, s[8:11], s62 offen offset:3072 sc1
    s_mul_i32 s54, s54, 7168
    v_mfma_f32_16x16x32_bf16 v[28:31], v[100:103], a[12:15], v[28:31]
    s_waitcnt lgkmcnt(7)
    ds_read_b128 v[100:103], v12 offset:2048
    s_mul_i32 s55, s63, 57344
    v_mfma_f32_16x16x32_bf16 v[32:35], v[72:75], a[8:11], v[32:35]
    s_add_u32 s54, s54, s55
    s_add_u32 s54, s54, 0x880000
    s_and_b32 s55, s25, 1
    v_mfma_f32_16x16x32_bf16 v[36:39], v[72:75], a[12:15], v[36:39]
    s_waitcnt lgkmcnt(7)
    ds_read_b128 v[72:75], v12 offset:23552
    s_lshl_b32 s56, s55, 12
    v_mfma_f32_16x16x32_bf16 v[40:43], v[76:79], a[8:11], v[40:43]
    s_add_u32 s28, s54, s56
    buffer_load_dwordx4 a[60:63], v11, s[8:11], s62 offen offset:3072 sc1
    s_lshl_b32 s55, s55, 9
    v_mfma_f32_16x16x32_bf16 v[44:47], v[76:79], a[12:15], v[44:47]
    s_waitcnt lgkmcnt(7)
    ds_read_b128 v[76:79], v12 offset:45056
    s_add_u32 s54, s54, s55
    v_mfma_f32_16x16x32_bf16 v[48:51], v[80:83], a[8:11], v[48:51]
    s_add_u32 s54, s54, 3072
    s_cmp_lt_u32 s25, 12
    s_cselect_b32 s29, s54, 0x7feffff0
    v_mfma_f32_16x16x32_bf16 v[52:55], v[80:83], a[12:15], v[52:55]
    s_waitcnt lgkmcnt(7)
    ds_read_b128 v[80:83], v2 offset:3072
    v_and_b32 v13, 0x3ff, v13
    v_mfma_f32_16x16x32_bf16 v[56:59], v[84:87], a[8:11], v[56:59]
    v_and_b32 v246, 1, v5
    v_mul_u32_u24 v246, 57232, v246
    v_mfma_f32_16x16x32_bf16 v[60:63], v[84:87], a[12:15], v[60:63]
    s_waitcnt vmcnt(12) lgkmcnt(7)
    ds_read_b128 v[84:87], v2 offset:24576
    buffer_load_dwordx4 v[164:167], v242, s[8:11], s0 offen offset:512 sc1
    v_mfma_f32_16x16x32_bf16 v[16:19], v[88:91], a[16:19], v[16:19]
    v_add_u32 v13, v246, v13
    s_add_u32 s54, s1, 0x10010
    v_mfma_f32_16x16x32_bf16 v[20:23], v[88:91], a[20:23], v[20:23]
    s_waitcnt lgkmcnt(7)
    s_cmp_eq_u32 s3, 0
    s_cselect_b32 s36, s54, 0x7feffff0
    v_mfma_f32_16x16x32_bf16 v[24:27], v[92:95], a[16:19], v[24:27]
    ds_read_b128 v[88:91], v2 offset:46080
    buffer_load_dwordx2 v[178:179], v243, s[8:11], s0 offen offset:768 sc1
    v_mfma_f32_16x16x32_bf16 v[28:31], v[92:95], a[20:23], v[28:31]
    s_waitcnt lgkmcnt(7)
    s_add_u32 s62, s62, 4096
    ds_read_b128 v[92:95], v12 offset:3072
    v_mfma_f32_16x16x32_bf16 v[32:35], v[96:99], a[16:19], v[32:35]
    v_add_u32 v134, 57344, v2
    v_mfma_f32_16x16x32_bf16 v[36:39], v[96:99], a[20:23], v[36:39]
    s_waitcnt lgkmcnt(6)
    ds_read_b128 v[96:99], v12 offset:24576
    buffer_load_dwordx4 a[64:67], v2, s[8:11], s62 offen offset:0 sc1
    v_mfma_f32_16x16x32_bf16 v[40:43], v[100:103], a[16:19], v[40:43]
    v_mfma_f32_16x16x32_bf16 v[44:47], v[100:103], a[20:23], v[44:47]
    s_waitcnt lgkmcnt(6)
    ds_read_b128 v[100:103], v12 offset:46080
    v_mfma_f32_16x16x32_bf16 v[48:51], v[72:75], a[16:19], v[48:51]
    v_mfma_f32_16x16x32_bf16 v[52:55], v[72:75], a[20:23], v[52:55]
    s_waitcnt lgkmcnt(6)
    ds_read_b128 v[72:75], v2 offset:4096
    buffer_load_dwordx4 a[68:71], v11, s[8:11], s62 offen offset:0 sc1
    v_mfma_f32_16x16x32_bf16 v[56:59], v[76:79], a[16:19], v[56:59]
    v_mfma_f32_16x16x32_bf16 v[60:63], v[76:79], a[20:23], v[60:63]
    s_waitcnt vmcnt(14) lgkmcnt(6)
    ds_read_b128 v[76:79], v2 offset:25600
    v_mfma_f32_16x16x32_bf16 v[16:19], v[80:83], a[24:27], v[16:19]
    v_mfma_f32_16x16x32_bf16 v[20:23], v[80:83], a[28:31], v[20:23]
    s_waitcnt lgkmcnt(6)
    ds_read_b128 v[80:83], v2 offset:47104
    buffer_load_dwordx4 v[168:171], v242, s[8:11], s0 offen offset:1024 sc1
    v_mfma_f32_16x16x32_bf16 v[24:27], v[84:87], a[24:27], v[24:27]
    v_mfma_f32_16x16x32_bf16 v[28:31], v[84:87], a[28:31], v[28:31]
    s_waitcnt lgkmcnt(6)
    ds_read_b128 v[84:87], v12 offset:4096
    v_mfma_f32_16x16x32_bf16 v[32:35], v[88:91], a[24:27], v[32:35]
    buffer_load_dwordx2 v[180:181], v243, s[8:11], s0 offen offset:1280 sc1
    v_mfma_f32_16x16x32_bf16 v[36:39], v[88:91], a[28:31], v[36:39]
    s_waitcnt lgkmcnt(6)
    ds_read_b128 v[88:91], v12 offset:25600
    v_mfma_f32_16x16x32_bf16 v[40:43], v[92:95], a[24:27], v[40:43]
    v_mfma_f32_16x16x32_bf16 v[44:47], v[92:95], a[28:31], v[44:47]
    s_waitcnt lgkmcnt(6)
    ds_read_b128 v[92:95], v2 offset:5120
    buffer_load_dwordx4 a[72:75], v2, s[8:11], s62 offen offset:1024 sc1
    v_mfma_f32_16x16x32_bf16 v[48:51], v[96:99], a[24:27], v[48:51]
    v_mfma_f32_16x16x32_bf16 v[52:55], v[96:99], a[28:31], v[52:55]
    s_waitcnt lgkmcnt(6)
    ds_read_b128 v[96:99], v2 offset:26624
    v_mfma_f32_16x16x32_bf16 v[56:59], v[100:103], a[24:27], v[56:59]
    v_mfma_f32_16x16x32_bf16 v[60:63], v[100:103], a[28:31], v[60:63]
    s_waitcnt vmcnt(15) lgkmcnt(6)
    ds_read_b128 v[100:103], v2 offset:48128
    v_mfma_f32_16x16x32_bf16 v[16:19], v[72:75], a[32:35], v[16:19]
    buffer_load_dwordx4 a[76:79], v11, s[8:11], s62 offen offset:1024 sc1
    v_mfma_f32_16x16x32_bf16 v[20:23], v[72:75], a[36:39], v[20:23]
    s_waitcnt lgkmcnt(6)
    ds_read_b128 v[72:75], v12 offset:5120
    v_mfma_f32_16x16x32_bf16 v[24:27], v[76:79], a[32:35], v[24:27]
    v_mfma_f32_16x16x32_bf16 v[28:31], v[76:79], a[36:39], v[28:31]
    s_waitcnt lgkmcnt(6)
    ds_read_b128 v[76:79], v12 offset:26624
    v_mfma_f32_16x16x32_bf16 v[32:35], v[80:83], a[32:35], v[32:35]
    buffer_load_dwordx4 v[172:175], v242, s[8:11], s0 offen offset:1536 sc1
    v_mfma_f32_16x16x32_bf16 v[36:39], v[80:83], a[36:39], v[36:39]
    s_waitcnt lgkmcnt(6)
    ds_read_b128 v[80:83], v2 offset:6144
    v_mfma_f32_16x16x32_bf16 v[40:43], v[84:87], a[32:35], v[40:43]
    v_mfma_f32_16x16x32_bf16 v[44:47], v[84:87], a[36:39], v[44:47]
    s_waitcnt lgkmcnt(6)
    ds_read_b128 v[84:87], v2 offset:27648
    buffer_load_dwordx2 v[182:183], v243, s[8:11], s0 offen offset:1792 sc1
    v_mfma_f32_16x16x32_bf16 v[48:51], v[88:91], a[32:35], v[48:51]
    v_mfma_f32_16x16x32_bf16 v[52:55], v[88:91], a[36:39], v[52:55]
    s_waitcnt vmcnt(16) lgkmcnt(6)
    ds_read_b128 v[88:91], v2 offset:49152
    v_mfma_f32_16x16x32_bf16 v[16:19], v[92:95], a[40:43], v[16:19]
    buffer_load_dwordx4 a[80:83], v2, s[8:11], s62 offen offset:2048 sc1
    v_mfma_f32_16x16x32_bf16 v[20:23], v[92:95], a[44:47], v[20:23]
    s_waitcnt lgkmcnt(6)
    ds_read_b128 v[92:95], v12 offset:6144
    v_mfma_f32_16x16x32_bf16 v[24:27], v[96:99], a[40:43], v[24:27]
    v_mfma_f32_16x16x32_bf16 v[28:31], v[96:99], a[44:47], v[28:31]
    s_waitcnt lgkmcnt(6)
    ds_read_b128 v[96:99], v12 offset:27648
    v_mfma_f32_16x16x32_bf16 v[32:35], v[100:103], a[40:43], v[32:35]
    buffer_load_dwordx4 a[84:87], v11, s[8:11], s62 offen offset:2048 sc1
    v_mfma_f32_16x16x32_bf16 v[36:39], v[100:103], a[44:47], v[36:39]
    s_waitcnt lgkmcnt(6)
    ds_read_b128 v[100:103], v2 offset:7168
    v_mfma_f32_16x16x32_bf16 v[40:43], v[72:75], a[40:43], v[40:43]
    v_mfma_f32_16x16x32_bf16 v[44:47], v[72:75], a[44:47], v[44:47]
    s_waitcnt lgkmcnt(6)
    ds_read_b128 v[72:75], v2 offset:28672
    v_mfma_f32_16x16x32_bf16 v[48:51], v[76:79], a[40:43], v[48:51]
    v_mfma_f32_16x16x32_bf16 v[52:55], v[76:79], a[44:47], v[52:55]
    s_waitcnt vmcnt(16) lgkmcnt(6)
    ds_read_b128 v[76:79], v2 offset:50176
    buffer_load_dwordx4 a[88:91], v2, s[8:11], s62 offen offset:3072 sc1
    v_mfma_f32_16x16x32_bf16 v[16:19], v[80:83], a[48:51], v[16:19]
    v_mfma_f32_16x16x32_bf16 v[20:23], v[80:83], a[52:55], v[20:23]
    s_waitcnt lgkmcnt(6)
    ds_read_b128 v[80:83], v12 offset:7168
    v_mfma_f32_16x16x32_bf16 v[24:27], v[84:87], a[48:51], v[24:27]
    v_mfma_f32_16x16x32_bf16 v[28:31], v[84:87], a[52:55], v[28:31]
    s_waitcnt lgkmcnt(6)
    ds_read_b128 v[84:87], v12 offset:28672
    buffer_load_dwordx4 a[92:95], v11, s[8:11], s62 offen offset:3072 sc1
    v_mfma_f32_16x16x32_bf16 v[32:35], v[88:91], a[48:51], v[32:35]
    s_add_u32 s62, s62, 4096
    v_mfma_f32_16x16x32_bf16 v[36:39], v[88:91], a[52:55], v[36:39]
    s_waitcnt lgkmcnt(6)
    ds_read_b128 v[88:91], v2 offset:8192
    v_mfma_f32_16x16x32_bf16 v[40:43], v[92:95], a[48:51], v[40:43]
    v_mfma_f32_16x16x32_bf16 v[44:47], v[92:95], a[52:55], v[44:47]
    s_waitcnt lgkmcnt(6)
    ds_read_b128 v[92:95], v2 offset:29696
    buffer_load_dwordx4 a[96:99], v2, s[8:11], s62 offen offset:0 sc1
    v_mfma_f32_16x16x32_bf16 v[48:51], v[96:99], a[48:51], v[48:51]
    v_mfma_f32_16x16x32_bf16 v[52:55], v[96:99], a[52:55], v[52:55]
    s_waitcnt vmcnt(15) lgkmcnt(6)
    ds_read_b128 v[96:99], v2 offset:51200
    v_mfma_f32_16x16x32_bf16 v[16:19], v[100:103], a[56:59], v[16:19]
    v_mfma_f32_16x16x32_bf16 v[20:23], v[100:103], a[60:63], v[20:23]
    s_waitcnt lgkmcnt(6)
    ds_read_b128 v[100:103], v12 offset:8192
    buffer_load_dwordx4 a[100:103], v11, s[8:11], s62 offen offset:0 sc1
    v_mfma_f32_16x16x32_bf16 v[24:27], v[72:75], a[56:59], v[24:27]
    v_mfma_f32_16x16x32_bf16 v[28:31], v[72:75], a[60:63], v[28:31]
    s_waitcnt lgkmcnt(6)
    ds_read_b128 v[72:75], v12 offset:29696
    v_mfma_f32_16x16x32_bf16 v[32:35], v[76:79], a[56:59], v[32:35]
    v_mfma_f32_16x16x32_bf16 v[36:39], v[76:79], a[60:63], v[36:39]
    s_waitcnt lgkmcnt(6)
    ds_read_b128 v[76:79], v2 offset:9216
    v_mfma_f32_16x16x32_bf16 v[40:43], v[80:83], a[56:59], v[40:43]
    buffer_load_dwordx4 a[104:107], v2, s[8:11], s62 offen offset:1024 sc1
    v_mfma_f32_16x16x32_bf16 v[44:47], v[80:83], a[60:63], v[44:47]
    s_waitcnt lgkmcnt(6)
    ds_read_b128 v[80:83], v2 offset:30720
    v_mfma_f32_16x16x32_bf16 v[48:51], v[84:87], a[56:59], v[48:51]
    v_mfma_f32_16x16x32_bf16 v[52:55], v[84:87], a[60:63], v[52:55]
    s_waitcnt vmcnt(13) lgkmcnt(6)
    ds_read_b128 v[84:87], v2 offset:52224
    v_mfma_f32_16x16x32_bf16 v[16:19], v[88:91], a[64:67], v[16:19]
    buffer_load_dwordx4 a[108:111], v11, s[8:11], s62 offen offset:1024 sc1
    v_mfma_f32_16x16x32_bf16 v[20:23], v[88:91], a[68:71], v[20:23]
    s_waitcnt lgkmcnt(6)
    ds_read_b128 v[88:91], v12 offset:9216
    v_mfma_f32_16x16x32_bf16 v[24:27], v[92:95], a[64:67], v[24:27]
    v_mfma_f32_16x16x32_bf16 v[28:31], v[92:95], a[68:71], v[28:31]
    s_waitcnt lgkmcnt(6)
    ds_read_b128 v[92:95], v12 offset:30720
    v_mfma_f32_16x16x32_bf16 v[32:35], v[96:99], a[64:67], v[32:35]
    buffer_load_dwordx4 a[112:115], v2, s[8:11], s62 offen offset:2048 sc1
    v_mfma_f32_16x16x32_bf16 v[36:39], v[96:99], a[68:71], v[36:39]
    s_waitcnt lgkmcnt(6)
    ds_read_b128 v[96:99], v2 offset:10240
    v_mfma_f32_16x16x32_bf16 v[40:43], v[100:103], a[64:67], v[40:43]
    v_mfma_f32_16x16x32_bf16 v[44:47], v[100:103], a[68:71], v[44:47]
    s_waitcnt lgkmcnt(6)
    ds_read_b128 v[100:103], v2 offset:31744
    v_mfma_f32_16x16x32_bf16 v[48:51], v[72:75], a[64:67], v[48:51]
    v_mfma_f32_16x16x32_bf16 v[52:55], v[72:75], a[68:71], v[52:55]
    s_waitcnt vmcnt(11) lgkmcnt(6)
    ds_read_b128 v[72:75], v2 offset:53248
    buffer_load_dwordx4 a[116:119], v11, s[8:11], s62 offen offset:2048 sc1
    v_mfma_f32_16x16x32_bf16 v[16:19], v[76:79], a[72:75], v[16:19]
    v_mfma_f32_16x16x32_bf16 v[20:23], v[76:79], a[76:79], v[20:23]
    s_waitcnt lgkmcnt(6)
    ds_read_b128 v[76:79], v12 offset:10240
    v_mfma_f32_16x16x32_bf16 v[24:27], v[80:83], a[72:75], v[24:27]
    v_mfma_f32_16x16x32_bf16 v[28:31], v[80:83], a[76:79], v[28:31]
    s_waitcnt lgkmcnt(6)
    ds_read_b128 v[80:83], v12 offset:31744
    buffer_load_dwordx4 a[120:123], v2, s[8:11], s62 offen offset:3072 sc1
    v_mfma_f32_16x16x32_bf16 v[32:35], v[84:87], a[72:75], v[32:35]
    v_mfma_f32_16x16x32_bf16 v[36:39], v[84:87], a[76:79], v[36:39]
    s_waitcnt lgkmcnt(6)
    ds_read_b128 v[84:87], v2 offset:11264
    v_mfma_f32_16x16x32_bf16 v[40:43], v[88:91], a[72:75], v[40:43]
    s_waitcnt vmcnt(11)
    v_add_f32 v160, v160, v164
    v_add_f32 v161, v161, v165
    v_mfma_f32_16x16x32_bf16 v[44:47], v[88:91], a[76:79], v[44:47]
    s_waitcnt lgkmcnt(6)
    s_barrier
    ds_read_b128 v[88:91], v2 offset:32768
    v_mfma_f32_16x16x32_bf16 v[48:51], v[92:95], a[72:75], v[48:51]
    buffer_load_dwordx4 a[124:127], v11, s[8:11], s62 offen offset:3072 sc1
    s_add_u32 s62, s62, 4096
    v_mfma_f32_16x16x32_bf16 v[52:55], v[92:95], a[76:79], v[52:55]
    s_waitcnt vmcnt(10) lgkmcnt(6)
    ds_read_b128 v[92:95], v2 offset:54272
    v_add_f32 v162, v162, v166
    v_mfma_f32_16x16x32_bf16 v[16:19], v[96:99], a[80:83], v[16:19]
    v_add_f32 v163, v163, v167
    v_add_f32 v168, v168, v172
    v_mfma_f32_16x16x32_bf16 v[20:23], v[96:99], a[84:87], v[20:23]
    s_waitcnt lgkmcnt(6)
    ds_read_b128 v[96:99], v12 offset:11264
    v_add_f32 v169, v169, v173
    v_mfma_f32_16x16x32_bf16 v[24:27], v[100:103], a[80:83], v[24:27]
    buffer_load_dwordx4 a[128:131], v2, s[8:11], s62 offen offset:0 sc1
    v_add_f32 v170, v170, v174
    v_mfma_f32_16x16x32_bf16 v[28:31], v[100:103], a[84:87], v[28:31]
    s_waitcnt lgkmcnt(6)
    ds_read_b128 v[100:103], v12 offset:32768
    v_add_f32 v171, v171, v175
    v_mfma_f32_16x16x32_bf16 v[32:35], v[72:75], a[80:83], v[32:35]
    v_add_f32 v160, v160, v168
    v_add_f32 v161, v161, v169
    v_mfma_f32_16x16x32_bf16 v[36:39], v[72:75], a[84:87], v[36:39]
    s_waitcnt lgkmcnt(6)
    ds_read_b128 v[72:75], v2 offset:12288
    v_add_f32 v162, v162, v170
    v_mfma_f32_16x16x32_bf16 v[40:43], v[76:79], a[80:83], v[40:43]
    buffer_load_dwordx4 a[132:135], v11, s[8:11], s62 offen offset:0 sc1
    v_add_f32 v163, v163, v171
    v_mfma_f32_16x16x32_bf16 v[44:47], v[76:79], a[84:87], v[44:47]
    s_waitcnt lgkmcnt(6)
    ds_read_b128 v[76:79], v2 offset:33792
    v_add_f32 v176, v176, v178
    v_mfma_f32_16x16x32_bf16 v[48:51], v[80:83], a[80:83], v[48:51]
    v_add_f32 v180, v180, v182
    v_add_f32 v177, v177, v179
    v_mfma_f32_16x16x32_bf16 v[52:55], v[80:83], a[84:87], v[52:55]
    s_waitcnt vmcnt(10) lgkmcnt(6)
    ds_read_b128 v[80:83], v2 offset:55296
    v_add_f32 v181, v181, v183
    v_mfma_f32_16x16x32_bf16 v[16:19], v[84:87], a[88:91], v[16:19]
    buffer_load_dwordx4 a[136:139], v2, s[8:11], s62 offen offset:1024 sc1
    v_add_f32 v164, v176, v180
    v_mfma_f32_16x16x32_bf16 v[20:23], v[84:87], a[92:95], v[20:23]
    s_waitcnt lgkmcnt(6)
    ds_read_b128 v[84:87], v12 offset:12288
    v_add_f32 v165, v177, v181
    v_mfma_f32_16x16x32_bf16 v[24:27], v[88:91], a[88:91], v[24:27]
    v_mov_b32 v166, v160
    v_mov_b32 v167, v161
    v_mfma_f32_16x16x32_bf16 v[28:31], v[88:91], a[92:95], v[28:31]
    s_waitcnt lgkmcnt(6)
    ds_read_b128 v[88:91], v12 offset:33792
    v_mov_b32 v168, v162
    v_mfma_f32_16x16x32_bf16 v[32:35], v[92:95], a[88:91], v[32:35]
    buffer_load_dwordx4 a[140:143], v11, s[8:11], s62 offen offset:1024 sc1
    v_mov_b32 v169, v163
    v_mfma_f32_16x16x32_bf16 v[36:39], v[92:95], a[92:95], v[36:39]
    s_waitcnt lgkmcnt(6)
    ds_read_b128 v[92:95], v2 offset:13312
    v_mov_b32 v170, v164
    v_mfma_f32_16x16x32_bf16 v[40:43], v[96:99], a[88:91], v[40:43]
    v_mov_b32 v171, v165
    v_mfma_f32_16x16x32_bf16 v[44:47], v[96:99], a[92:95], v[44:47]
    s_waitcnt lgkmcnt(6)
    v_permlane32_swap_b32 v160, v166
    v_mfma_f32_16x16x32_bf16 v[48:51], v[100:103], a[88:91], v[48:51]
    v_permlane32_swap_b32 v161, v167
    v_mfma_f32_16x16x32_bf16 v[52:55], v[100:103], a[92:95], v[52:55]
    s_waitcnt vmcnt(10) lgkmcnt(5)
    v_permlane32_swap_b32 v162, v168
    v_mfma_f32_16x16x32_bf16 v[16:19], v[72:75], a[96:99], v[16:19]
    ds_read_b128 v[96:99], v2 offset:34816
    ds_read_b128 v[100:103], v2 offset:56320
    v_mfma_f32_16x16x32_bf16 v[20:23], v[72:75], a[100:103], v[20:23]
    s_waitcnt lgkmcnt(6)
    v_permlane32_swap_b32 v163, v169
    v_mfma_f32_16x16x32_bf16 v[24:27], v[76:79], a[96:99], v[24:27]
    v_permlane32_swap_b32 v164, v170
    v_mfma_f32_16x16x32_bf16 v[28:31], v[76:79], a[100:103], v[28:31]
    s_waitcnt lgkmcnt(5)
    v_permlane32_swap_b32 v165, v171
    v_mfma_f32_16x16x32_bf16 v[32:35], v[80:83], a[96:99], v[32:35]
    ds_read_b128 v[72:75], v12 offset:13312
    ds_read_b128 v[76:79], v12 offset:34816
    v_mfma_f32_16x16x32_bf16 v[36:39], v[80:83], a[100:103], v[36:39]
    s_waitcnt lgkmcnt(6)
    buffer_load_dwordx4 a[144:147], v2, s[8:11], s62 offen offset:2048 sc1
    ds_read_b128 v[80:83], v2 offset:14336
    v_mfma_f32_16x16x32_bf16 v[40:43], v[84:87], a[96:99], v[40:43]
    buffer_load_dwordx4 a[148:151], v11, s[8:11], s62 offen offset:2048 sc1
    v_add_f32 v160, v160, v166
    v_mfma_f32_16x16x32_bf16 v[44:47], v[84:87], a[100:103], v[44:47]
    s_waitcnt lgkmcnt(6)
    ds_read_b128 v[84:87], v2 offset:35840
    buffer_load_dwordx4 a[152:155], v2, s[8:11], s62 offen offset:3072 sc1
    v_mfma_f32_16x16x32_bf16 v[48:51], v[88:91], a[96:99], v[48:51]
    v_add_f32 v161, v161, v167
    v_add_f32 v162, v162, v168
    v_mfma_f32_16x16x32_bf16 v[52:55], v[88:91], a[100:103], v[52:55]
    s_waitcnt vmcnt(11) lgkmcnt(6)
    ds_read_b128 v[88:91], v2 offset:57344
    v_add_f32 v163, v163, v169
    v_mfma_f32_16x16x32_bf16 v[16:19], v[92:95], a[104:107], v[16:19]
    v_add_f32 v164, v164, v170
    v_add_f32 v165, v165, v171
    v_mfma_f32_16x16x32_bf16 v[20:23], v[92:95], a[108:111], v[20:23]
    s_waitcnt lgkmcnt(6)
    ds_read_b128 v[92:95], v12 offset:14336
    v_mul_f32 v163, 0x3acccccd, v163
    v_mfma_f32_16x16x32_bf16 v[24:27], v[96:99], a[104:107], v[24:27]
    buffer_load_dwordx4 a[156:159], v11, s[8:11], s62 offen offset:3072 sc1
    v_add_u32 v11, 8192, v2
    v_mfma_f32_16x16x32_bf16 v[28:31], v[96:99], a[108:111], v[28:31]
    s_waitcnt lgkmcnt(6)
    ds_read_b128 v[96:99], v2 offset:15360
    v_mul_f32 v165, 0x3acccccd, v165
    v_mfma_f32_16x16x32_bf16 v[32:35], v[100:103], a[104:107], v[32:35]
    v_mul_f32 v160, 0x3acccccd, v160
    v_mul_f32 v161, 0x3acccccd, v161
    v_mfma_f32_16x16x32_bf16 v[36:39], v[100:103], a[108:111], v[36:39]
    s_waitcnt lgkmcnt(6)
    ds_read_b128 v[100:103], v2 offset:36864
    v_mul_f32 v162, 0x3acccccd, v162
    v_mfma_f32_16x16x32_bf16 v[40:43], v[72:75], a[104:107], v[40:43]
    v_mul_f32 v164, 0x3acccccd, v164
    v_fma_f32 v165, -v163, v163, v165
    v_mfma_f32_16x16x32_bf16 v[44:47], v[72:75], a[108:111], v[44:47]
    s_waitcnt lgkmcnt(6)
    ds_read_b128 v[72:75], v2 offset:58368
    v_fma_f32 v160, -v163, s101, v160
    v_mfma_f32_16x16x32_bf16 v[48:51], v[76:79], a[104:107], v[48:51]
    v_max_f32 v165, 0, v165
    v_add_f32 v161, v161, v161
    v_mfma_f32_16x16x32_bf16 v[52:55], v[76:79], a[108:111], v[52:55]
    s_waitcnt vmcnt(10) lgkmcnt(6)
    ds_read_b128 v[76:79], v12 offset:15360
    v_add_f32 v165, 0x3727c5ac, v165
    v_mfma_f32_16x16x32_bf16 v[16:19], v[80:83], a[112:115], v[16:19]
    v_fma_f32 v161, v163, s46, -v161
    v_mfma_f32_16x16x32_bf16 v[20:23], v[80:83], a[116:119], v[20:23]
    s_waitcnt lgkmcnt(6)
    v_rsq_f32 v169, v165
    v_mfma_f32_16x16x32_bf16 v[24:27], v[84:87], a[112:115], v[24:27]
    ds_read_b128 v[80:83], v2 offset:16384
    v_fma_f32 v162, -v163, s47, v162
    v_mfma_f32_16x16x32_bf16 v[28:31], v[84:87], a[116:119], v[28:31]
    s_waitcnt lgkmcnt(6)
    ds_read_b128 v[84:87], v2 offset:37888
    v_fma_f32 v164, v163, v161, v164
    v_mfma_f32_16x16x32_bf16 v[32:35], v[88:91], a[112:115], v[32:35]
    v_mul_f32 v171, v165, v169
    v_fma_f32 v160, v169, v160, s60
    v_mfma_f32_16x16x32_bf16 v[36:39], v[88:91], a[116:119], v[36:39]
    s_waitcnt lgkmcnt(6)
    ds_read_b128 v[88:91], v2 offset:59392
    v_add_f32 v162, v162, v162
    v_mfma_f32_16x16x32_bf16 v[40:43], v[92:95], a[112:115], v[40:43]
    v_fma_f32 v164, v169, v164, v162
    v_fma_f32 v164, v169, v164, s59
    v_mfma_f32_16x16x32_bf16 v[44:47], v[92:95], a[116:119], v[44:47]
    s_waitcnt vmcnt(8) lgkmcnt(6)
    ds_read_b128 v[92:95], v12 offset:16384
    v_fma_f32 v164, -v160, v160, v164
    v_mfma_f32_16x16x32_bf16 v[16:19], v[96:99], a[120:123], v[16:19]
    buffer_load_dwordx4 a[228:231], v2, s[8:11], s33 offen offset:2048 sc1
    v_max_f32 v164, 0, v164
    v_mfma_f32_16x16x32_bf16 v[20:23], v[96:99], a[124:127], v[20:23]
    s_waitcnt lgkmcnt(6)
    ds_read_b128 v[96:99], v2 offset:17408
    v_add_f32 v164, 0x3727c5ac, v164
    v_mfma_f32_16x16x32_bf16 v[24:27], v[100:103], a[120:123], v[24:27]
    v_rsq_f32 v170, v164
    v_mfma_f32_16x16x32_bf16 v[28:31], v[100:103], a[124:127], v[28:31]
    s_waitcnt lgkmcnt(6)
    ds_read_b128 v[100:103], v2 offset:38912
    v_mul_f32 v160, -v160, v171
    v_mfma_f32_16x16x32_bf16 v[32:35], v[72:75], a[120:123], v[32:35]
    buffer_load_dwordx4 a[232:235], v2, s[8:11], s33 offen offset:3072 sc1
    v_sub_f32 v163, 0, v163
    v_mfma_f32_16x16x32_bf16 v[36:39], v[72:75], a[124:127], v[36:39]
    s_waitcnt lgkmcnt(6)
    ds_read_b128 v[72:75], v2 offset:60416
    v_mul_f32 v164, v164, v170
    v_mfma_f32_16x16x32_bf16 v[40:43], v[76:79], a[120:123], v[40:43]
    v_mul_f32 v169, v169, v170
    v_mul_f32 v116, v164, v171
    v_mfma_f32_16x16x32_bf16 v[44:47], v[76:79], a[124:127], v[44:47]
    s_waitcnt vmcnt(8) lgkmcnt(6)
    ds_read_b128 v[76:79], v12 offset:17408
    v_mul_f32 v170, v169, v169
    v_mfma_f32_16x16x32_bf16 v[16:19], v[80:83], a[128:131], v[16:19]
    v_mul_f32 v112, 0xc0135761, v169
    v_mul_f32 v170, v170, v169
    v_mfma_f32_16x16x32_bf16 v[20:23], v[80:83], a[132:135], v[20:23]
    s_waitcnt lgkmcnt(6)
    ds_read_b128 v[80:83], v2 offset:18432
    buffer_load_dwordx4 a[236:239], v8, s[8:11], s33 offen offset:0 sc1
    v_mfma_f32_16x16x32_bf16 v[24:27], v[84:87], a[128:131], v[24:27]
    s_add_u32 s33, s37, 56320
    v_cvt_pk_bf16_f32 v106, v163, v171
    v_cvt_pk_bf16_f32 v107, v160, v116
    v_mfma_f32_16x16x32_bf16 v[28:31], v[84:87], a[132:135], v[28:31]
    s_waitcnt lgkmcnt(6)
    ds_read_b128 v[84:87], v2 offset:39936
    v_mul_f32 v114, 0xbdd2d3e8, v170
    v_mfma_f32_16x16x32_bf16 v[32:35], v[88:91], a[128:131], v[32:35]
    v_lshlrev_b32 v166, 16, v106
    v_and_b32 v167, 0xffff0000, v106
    v_mfma_f32_16x16x32_bf16 v[36:39], v[88:91], a[132:135], v[36:39]
    s_waitcnt lgkmcnt(6)
    ds_read_b128 v[88:91], v2 offset:61440
    buffer_load_dwordx4 a[240:243], v2, s[8:11], s33 offen offset:0 sc1
    v_mfma_f32_16x16x32_bf16 v[40:43], v[92:95], a[128:131], v[40:43]
    v_lshlrev_b32 v168, 16, v107
    v_and_b32 v170, 0xffff0000, v107
    v_mfma_f32_16x16x32_bf16 v[44:47], v[92:95], a[132:135], v[44:47]
    s_waitcnt vmcnt(8) lgkmcnt(6)
    ds_read_b128 v[92:95], v12 offset:18432
    v_sub_f32 v166, v163, v166
    v_mfma_f32_16x16x32_bf16 v[16:19], v[96:99], a[136:139], v[16:19]
    v_sub_f32 v167, v171, v167
    v_sub_f32 v168, v160, v168
    v_mfma_f32_16x16x32_bf16 v[20:23], v[96:99], a[140:143], v[20:23]
    s_waitcnt lgkmcnt(6)
    ds_read_b128 v[96:99], v2 offset:19456
    buffer_load_dwordx4 a[244:247], v2, s[8:11], s33 offen offset:1024 sc1
    v_mfma_f32_16x16x32_bf16 v[24:27], v[100:103], a[136:139], v[24:27]
    v_sub_f32 v170, v116, v170
    v_cvt_pk_bf16_f32 v104, v166, v167
    v_mfma_f32_16x16x32_bf16 v[28:31], v[100:103], a[140:143], v[28:31]
    s_waitcnt lgkmcnt(6)
    ds_read_b128 v[100:103], v2 offset:40960
    v_cvt_pk_bf16_f32 v105, v168, v170
    v_mfma_f32_16x16x32_bf16 v[32:35], v[72:75], a[136:139], v[32:35]
    v_cmp_eq_u32 vcc, 1, v5
    v_mov_b32 v108, v104
    v_mfma_f32_16x16x32_bf16 v[36:39], v[72:75], a[140:143], v[36:39]
    s_waitcnt lgkmcnt(6)
    ds_read_b128 v[72:75], v2 offset:62464
    buffer_load_dwordx4 a[248:251], v2, s[8:11], s33 offen offset:2048 sc1
    v_mfma_f32_16x16x32_bf16 v[40:43], v[76:79], a[136:139], v[40:43]
    v_mov_b32 v109, v105
    v_mov_b32 v110, v106
    v_mfma_f32_16x16x32_bf16 v[44:47], v[76:79], a[140:143], v[44:47]
    s_waitcnt vmcnt(8) lgkmcnt(6)
    ds_read_b128 v[76:79], v12 offset:19456
    v_mov_b32 v111, v107
    v_mfma_f32_16x16x32_bf16 v[16:19], v[80:83], a[144:147], v[16:19]
    v_mov_b32 v113, v112
    v_mov_b32 v115, v114
    v_mfma_f32_16x16x32_bf16 v[20:23], v[80:83], a[148:151], v[20:23]
    s_waitcnt lgkmcnt(6)
    ds_read_b128 v[80:83], v2 offset:20480
    v_mov_b32 v117, v116
    v_mfma_f32_16x16x32_bf16 v[24:27], v[84:87], a[144:147], v[24:27]
    v_permlane16_swap_b32 v104, v108
    v_mfma_f32_16x16x32_bf16 v[28:31], v[84:87], a[148:151], v[28:31]
    s_waitcnt lgkmcnt(6)
    v_permlane16_swap_b32 v105, v109
    v_mfma_f32_16x16x32_bf16 v[32:35], v[88:91], a[144:147], v[32:35]
    v_permlane16_swap_b32 v106, v110
    v_mfma_f32_16x16x32_bf16 v[36:39], v[88:91], a[148:151], v[36:39]
    s_waitcnt lgkmcnt(5)
    v_permlane16_swap_b32 v107, v111
    v_mfma_f32_16x16x32_bf16 v[40:43], v[92:95], a[144:147], v[40:43]
    ds_read_b128 v[84:87], v2 offset:41984
    ds_read_b128 v[88:91], v2 offset:63488
    v_mfma_f32_16x16x32_bf16 v[44:47], v[92:95], a[148:151], v[44:47]
    s_waitcnt vmcnt(6) lgkmcnt(6)
    v_permlane16_swap_b32 v112, v113
    v_mfma_f32_16x16x32_bf16 v[16:19], v[96:99], a[152:155], v[16:19]
    buffer_load_dwordx4 a[252:255], v2, s[8:11], s33 offen offset:3072 sc1
    ds_read_b128 v[92:95], v12 offset:20480
    v_mfma_f32_16x16x32_bf16 v[20:23], v[96:99], a[156:159], v[20:23]
    s_waitcnt lgkmcnt(6)
    v_permlane16_swap_b32 v114, v115
    v_mfma_f32_16x16x32_bf16 v[24:27], v[100:103], a[152:155], v[24:27]
    v_permlane16_swap_b32 v116, v117
    v_mfma_f32_16x16x32_bf16 v[28:31], v[100:103], a[156:159], v[28:31]
    s_waitcnt lgkmcnt(5)
    ds_read_b128 v[96:99], v135 offset:0
    ds_read_b128 v[100:103], v135 offset:1024
    v_mfma_f32_16x16x32_bf16 v[32:35], v[72:75], a[152:155], v[32:35]
    buffer_load_dwordx4 a[160:163], v8, s[8:11], s33 offen offset:0 sc1
    s_add_u32 s33, s37, 5120
    v_mfma_f32_16x16x32_bf16 v[36:39], v[72:75], a[156:159], v[36:39]
    s_waitcnt lgkmcnt(6)
    ds_read_b128 v[72:75], v135 offset:2048
    buffer_load_dwordx4 a[164:167], v2, s[8:11], s33 offen offset:0 sc1
    v_mfma_f32_16x16x32_bf16 v[40:43], v[76:79], a[152:155], v[40:43]
    v_cndmask_b32 v104, v106, v104, vcc
    v_cndmask_b32 v105, v107, v105, vcc
    v_mfma_f32_16x16x32_bf16 v[44:47], v[76:79], a[156:159], v[44:47]
    s_waitcnt lgkmcnt(6)
    ds_read_b128 v[76:79], v135 offset:3072
    buffer_load_dwordx4 a[168:171], v2, s[8:11], s33 offen offset:1024 sc1
    v_cndmask_b32 v108, v110, v108, vcc
    v_cndmask_b32 v109, v111, v109, vcc
    v_mfma_f32_16x16x32_bf16 v[16:19], v[80:83], v[104:107], v[16:19]
    s_nop 0
    v_mfma_f32_16x16x32_bf16 v[20:23], v[80:83], v[108:111], v[20:23]
    s_waitcnt lgkmcnt(6)
    ds_read_b128 v[80:83], v12 offset:47104
    v_mfma_f32_16x16x32_bf16 v[24:27], v[84:87], v[104:107], v[24:27]
    v_mfma_f32_16x16x32_bf16 v[28:31], v[84:87], v[108:111], v[28:31]
    s_waitcnt lgkmcnt(6)
    ds_read_b128 v[84:87], v135 offset:4096
    buffer_load_dwordx4 a[172:175], v2, s[8:11], s33 offen offset:2048 sc1
    v_mfma_f32_16x16x32_bf16 v[32:35], v[88:91], v[104:107], v[32:35]
    v_mfma_f32_16x16x32_bf16 v[36:39], v[88:91], v[108:111], v[36:39]
    s_waitcnt lgkmcnt(6)
    ds_read_b128 v[88:91], v12 offset:48128
    v_mfma_f32_16x16x32_bf16 v[40:43], v[92:95], v[104:107], v[40:43]
    v_mfma_f32_16x16x32_bf16 v[44:47], v[92:95], v[108:111], v[44:47]
    ds_read_b128 v[92:95], v135 offset:5120
    buffer_load_dwordx4 a[176:179], v2, s[8:11], s33 offen offset:3072 sc1
    v_pk_mul_f32 v[160:161], v[16:17], v[16:17]
    v_pk_mul_f32 v[162:163], v[18:19], v[18:19]
    v_pk_mul_f32 v[164:165], v[24:25], v[24:25]
    v_pk_mul_f32 v[166:167], v[26:27], v[26:27]
    v_pk_fma_f32 v[160:161], v[160:161], v[114:115], v[112:113] op_sel:[0,0,0] op_sel_hi:[1,0,0]
    v_pk_fma_f32 v[162:163], v[162:163], v[114:115], v[112:113] op_sel:[0,0,0] op_sel_hi:[1,0,0]
    v_pk_fma_f32 v[164:165], v[164:165], v[114:115], v[112:113] op_sel:[0,0,0] op_sel_hi:[1,0,0]
    v_pk_fma_f32 v[166:167], v[166:167], v[114:115], v[112:113] op_sel:[0,0,0] op_sel_hi:[1,0,0]
    buffer_load_dwordx4 v[184:187], v8, s[8:11], s33 offen offset:0 sc1
    s_add_u32 s33, s37, 25600
    v_pk_mul_f32 v[160:161], v[160:161], v[16:17]
    v_pk_mul_f32 v[162:163], v[162:163], v[18:19]
    v_pk_mul_f32 v[164:165], v[164:165], v[24:25]
    v_pk_mul_f32 v[166:167], v[166:167], v[26:27]
    v_exp_f32 v160, v160
    v_exp_f32 v161, v161
    v_exp_f32 v162, v162
    v_exp_f32 v163, v163
    buffer_load_dwordx4 v[188:191], v2, s[8:11], s33 offen offset:0 sc1
    v_exp_f32 v164, v164
    v_exp_f32 v165, v165
    v_exp_f32 v166, v166
    v_exp_f32 v167, v167
    v_pk_fma_f32 v[160:161], v[160:161], v[116:117], v[116:117] op_sel:[0,0,0] op_sel_hi:[1,0,0]
    v_pk_fma_f32 v[162:163], v[162:163], v[116:117], v[116:117] op_sel:[0,0,0] op_sel_hi:[1,0,0]
    v_pk_fma_f32 v[164:165], v[164:165], v[116:117], v[116:117] op_sel:[0,0,0] op_sel_hi:[1,0,0]
    v_pk_fma_f32 v[166:167], v[166:167], v[116:117], v[116:117] op_sel:[0,0,0] op_sel_hi:[1,0,0]
    buffer_load_dwordx4 v[192:195], v2, s[8:11], s33 offen offset:1024 sc1
    v_rcp_f32 v160, v160
    v_rcp_f32 v161, v161
    v_rcp_f32 v162, v162
    v_rcp_f32 v163, v163
    v_rcp_f32 v164, v164
    v_rcp_f32 v165, v165
    v_rcp_f32 v166, v166
    v_rcp_f32 v167, v167
    buffer_load_dwordx4 v[196:199], v2, s[8:11], s33 offen offset:2048 sc1
    v_pk_mul_f32 v[16:17], v[16:17], v[160:161]
    v_pk_mul_f32 v[18:19], v[18:19], v[162:163]
    v_pk_mul_f32 v[24:25], v[24:25], v[164:165]
    v_pk_mul_f32 v[26:27], v[26:27], v[166:167]
    v_cvt_pk_bf16_f32 v126, v16, v17
    v_cvt_pk_bf16_f32 v127, v18, v19
    v_cvt_pk_bf16_f32 v128, v24, v25
    v_cvt_pk_bf16_f32 v129, v26, v27
    buffer_store_dwordx4 v[126:129], v2, s[8:11], s28 offen offset:0 sc1
    v_pk_mul_f32 v[160:161], v[20:21], v[20:21]
    v_pk_mul_f32 v[162:163], v[22:23], v[22:23]
    v_pk_mul_f32 v[164:165], v[28:29], v[28:29]
    v_pk_mul_f32 v[166:167], v[30:31], v[30:31]
    v_pk_fma_f32 v[160:161], v[160:161], v[114:115], v[112:113] op_sel:[0,1,1] op_sel_hi:[1,1,1]
    v_pk_fma_f32 v[162:163], v[162:163], v[114:115], v[112:113] op_sel:[0,1,1] op_sel_hi:[1,1,1]
    v_pk_fma_f32 v[164:165], v[164:165], v[114:115], v[112:113] op_sel:[0,1,1] op_sel_hi:[1,1,1]
    v_pk_fma_f32 v[166:167], v[166:167], v[114:115], v[112:113] op_sel:[0,1,1] op_sel_hi:[1,1,1]
    v_pk_mul_f32 v[160:161], v[160:161], v[20:21]
    v_pk_mul_f32 v[162:163], v[162:163], v[22:23]
    v_pk_mul_f32 v[164:165], v[164:165], v[28:29]
    v_pk_mul_f32 v[166:167], v[166:167], v[30:31]
    v_exp_f32 v160, v160
    v_exp_f32 v161, v161
    v_exp_f32 v162, v162
    v_exp_f32 v163, v163
    buffer_load_dwordx4 v[200:203], v2, s[8:11], s33 offen offset:3072 sc1
    v_exp_f32 v164, v164
    v_exp_f32 v165, v165
    v_exp_f32 v166, v166
    v_exp_f32 v167, v167
    v_pk_fma_f32 v[160:161], v[160:161], v[116:117], v[116:117] op_sel:[0,1,1] op_sel_hi:[1,1,1]
    v_pk_fma_f32 v[162:163], v[162:163], v[116:117], v[116:117] op_sel:[0,1,1] op_sel_hi:[1,1,1]
    v_pk_fma_f32 v[164:165], v[164:165], v[116:117], v[116:117] op_sel:[0,1,1] op_sel_hi:[1,1,1]
    v_pk_fma_f32 v[166:167], v[166:167], v[116:117], v[116:117] op_sel:[0,1,1] op_sel_hi:[1,1,1]
    buffer_load_dwordx4 v[204:207], v8, s[8:11], s33 offen offset:0 sc1
    s_add_u32 s33, s37, 40960
    v_rcp_f32 v160, v160
    v_rcp_f32 v161, v161
    v_rcp_f32 v162, v162
    v_rcp_f32 v163, v163
    v_rcp_f32 v164, v164
    v_rcp_f32 v165, v165
    v_rcp_f32 v166, v166
    v_rcp_f32 v167, v167
    buffer_load_dwordx4 v[208:211], v2, s[8:11], s33 offen offset:0 sc1
    v_pk_mul_f32 v[20:21], v[20:21], v[160:161]
    v_pk_mul_f32 v[22:23], v[22:23], v[162:163]
    v_pk_mul_f32 v[28:29], v[28:29], v[164:165]
    v_pk_mul_f32 v[30:31], v[30:31], v[166:167]
    v_cvt_pk_bf16_f32 v130, v20, v21
    v_cvt_pk_bf16_f32 v131, v22, v23
    v_cvt_pk_bf16_f32 v132, v28, v29
    v_cvt_pk_bf16_f32 v133, v30, v31
    buffer_store_dwordx4 v[130:133], v134, s[8:11], s28 offen offset:0 sc1
    s_waitcnt lgkmcnt(7)
    v_mfma_f32_16x16x32_bf16 v[64:67], v[96:99], a[0:3], 0
    v_mul_f32 v118, v32, v32
    v_mul_f32 v119, v33, v33
    v_mfma_f32_16x16x32_bf16 v[68:71], v[96:99], a[4:7], 0
    s_waitcnt lgkmcnt(6)
    ds_read_b128 v[96:99], v12 offset:49152
    v_mul_f32 v120, v34, v34
    v_mfma_f32_16x16x32_bf16 v[64:67], v[100:103], a[8:11], v[64:67]
    v_mul_f32 v121, v35, v35
    v_fma_f32 v118, v118, v114, v112
    v_mfma_f32_16x16x32_bf16 v[68:71], v[100:103], a[12:15], v[68:71]
    s_waitcnt lgkmcnt(6)
    ds_read_b128 v[100:103], v135 offset:6144
    v_fma_f32 v119, v119, v114, v112
    v_mfma_f32_16x16x32_bf16 v[64:67], v[72:75], a[16:19], v[64:67]
    v_fma_f32 v120, v120, v114, v112
    v_fma_f32 v121, v121, v114, v112
    v_mfma_f32_16x16x32_bf16 v[68:71], v[72:75], a[20:23], v[68:71]
    s_waitcnt lgkmcnt(6)
    ds_read_b128 v[72:75], v12 offset:50176
    v_mul_f32 v118, v118, v32
    v_mfma_f32_16x16x32_bf16 v[64:67], v[76:79], a[24:27], v[64:67]
    v_mul_f32 v119, v119, v33
    v_mul_f32 v120, v120, v34
    v_mfma_f32_16x16x32_bf16 v[68:71], v[76:79], a[28:31], v[68:71]
    s_waitcnt lgkmcnt(6)
    ds_read_b128 v[76:79], v135 offset:7168
    v_mul_f32 v121, v121, v35
    v_mfma_f32_16x16x32_bf16 v[56:59], v[80:83], a[32:35], v[56:59]
    v_exp_f32 v118, v118
    v_mfma_f32_16x16x32_bf16 v[60:63], v[80:83], a[36:39], v[60:63]
    s_waitcnt lgkmcnt(6)
    v_exp_f32 v119, v119
    v_mfma_f32_16x16x32_bf16 v[64:67], v[84:87], a[32:35], v[64:67]
    v_exp_f32 v120, v120
    v_mfma_f32_16x16x32_bf16 v[68:71], v[84:87], a[36:39], v[68:71]
    s_waitcnt lgkmcnt(5)
    v_exp_f32 v121, v121
    v_mfma_f32_16x16x32_bf16 v[56:59], v[88:91], a[40:43], v[56:59]
    ds_read_b128 v[80:83], v12 offset:51200
    ds_read_b128 v[84:87], v135 offset:8192
    v_mfma_f32_16x16x32_bf16 v[60:63], v[88:91], a[44:47], v[60:63]
    s_waitcnt lgkmcnt(6)
    ds_read_b128 v[88:91], v12 offset:52224
    buffer_load_dwordx4 v[212:215], v2, s[8:11], s33 offen offset:1024 sc1
    v_mfma_f32_16x16x32_bf16 v[64:67], v[92:95], a[40:43], v[64:67]
    buffer_load_dwordx4 v[216:219], v2, s[8:11], s33 offen offset:2048 sc1
    v_fma_f32 v118, v118, v116, v116
    v_mfma_f32_16x16x32_bf16 v[68:71], v[92:95], a[44:47], v[68:71]
    s_waitcnt lgkmcnt(6)
    ds_read_b128 v[92:95], v135 offset:9216
    v_fma_f32 v119, v119, v116, v116
    v_mfma_f32_16x16x32_bf16 v[56:59], v[96:99], a[48:51], v[56:59]
    buffer_load_dwordx4 v[220:223], v2, s[8:11], s33 offen offset:3072 sc1
    v_fma_f32 v120, v120, v116, v116
    v_mfma_f32_16x16x32_bf16 v[60:63], v[96:99], a[52:55], v[60:63]
    s_waitcnt lgkmcnt(6)
    ds_read_b128 v[96:99], v12 offset:53248
    v_fma_f32 v121, v121, v116, v116
    v_mfma_f32_16x16x32_bf16 v[64:67], v[100:103], a[48:51], v[64:67]
    v_rcp_f32 v118, v118
    v_mfma_f32_16x16x32_bf16 v[68:71], v[100:103], a[52:55], v[68:71]
    s_waitcnt lgkmcnt(6)
    v_rcp_f32 v119, v119
    v_mfma_f32_16x16x32_bf16 v[56:59], v[72:75], a[56:59], v[56:59]
    v_rcp_f32 v120, v120
    v_mfma_f32_16x16x32_bf16 v[60:63], v[72:75], a[60:63], v[60:63]
    s_waitcnt lgkmcnt(5)
    v_rcp_f32 v121, v121
    v_mfma_f32_16x16x32_bf16 v[64:67], v[76:79], a[56:59], v[64:67]
    ds_read_b128 v[100:103], v135 offset:10240
    ds_read_b128 v[72:75], v12 offset:54272
    v_mfma_f32_16x16x32_bf16 v[68:71], v[76:79], a[60:63], v[68:71]
    s_waitcnt lgkmcnt(6)
    ds_read_b128 v[76:79], v135 offset:11264
    buffer_load_dwordx4 v[224:227], v8, s[8:11], s33 offen offset:0 sc1
    v_mfma_f32_16x16x32_bf16 v[56:59], v[80:83], a[64:67], v[56:59]
    s_add_u32 s33, s37, 61440
    v_mul_f32 v32, v32, v118
    v_mul_f32 v33, v33, v119
    v_mfma_f32_16x16x32_bf16 v[60:63], v[80:83], a[68:71], v[60:63]
    s_waitcnt lgkmcnt(6)
    ds_read_b128 v[80:83], v12 offset:55296
    buffer_load_dwordx4 v[228:231], v2, s[8:11], s33 offen offset:0 sc1
    v_mfma_f32_16x16x32_bf16 v[64:67], v[84:87], a[64:67], v[64:67]
    v_mul_f32 v34, v34, v120
    v_mul_f32 v35, v35, v121
    v_mfma_f32_16x16x32_bf16 v[68:71], v[84:87], a[68:71], v[68:71]
    s_waitcnt lgkmcnt(6)
    ds_read_b128 v[84:87], v135 offset:12288
    v_mul_f32 v122, v40, v40
    v_mfma_f32_16x16x32_bf16 v[56:59], v[88:91], a[72:75], v[56:59]
    v_mul_f32 v123, v41, v41
    v_mul_f32 v124, v42, v42
    v_mfma_f32_16x16x32_bf16 v[60:63], v[88:91], a[76:79], v[60:63]
    s_waitcnt lgkmcnt(6)
    ds_read_b128 v[88:91], v12 offset:56320
    buffer_load_dwordx4 v[232:235], v2, s[8:11], s33 offen offset:1024 sc1
    v_mfma_f32_16x16x32_bf16 v[64:67], v[92:95], a[72:75], v[64:67]
    v_mul_f32 v125, v43, v43
    v_fma_f32 v122, v122, v114, v112
    v_mfma_f32_16x16x32_bf16 v[68:71], v[92:95], a[76:79], v[68:71]
    s_waitcnt lgkmcnt(6)
    ds_read_b128 v[92:95], v135 offset:13312
    v_fma_f32 v123, v123, v114, v112
    v_mfma_f32_16x16x32_bf16 v[56:59], v[96:99], a[80:83], v[56:59]
    v_fma_f32 v124, v124, v114, v112
    v_fma_f32 v125, v125, v114, v112
    v_mfma_f32_16x16x32_bf16 v[60:63], v[96:99], a[84:87], v[60:63]
    s_waitcnt lgkmcnt(6)
    ds_read_b128 v[96:99], v12 offset:35840
    buffer_load_dwordx4 v[236:239], v2, s[8:11], s33 offen offset:2048 sc1
    v_mfma_f32_16x16x32_bf16 v[64:67], v[100:103], a[80:83], v[64:67]
    v_mul_f32 v122, v122, v40
    v_mul_f32 v123, v123, v41
    v_mfma_f32_16x16x32_bf16 v[68:71], v[100:103], a[84:87], v[68:71]
    s_waitcnt lgkmcnt(6)
    ds_read_b128 v[100:103], v12 offset:57344
    v_mul_f32 v124, v124, v42
    v_mfma_f32_16x16x32_bf16 v[56:59], v[72:75], a[88:91], v[56:59]
    v_mul_f32 v125, v125, v43
    v_mfma_f32_16x16x32_bf16 v[60:63], v[72:75], a[92:95], v[60:63]
    s_waitcnt lgkmcnt(6)
    v_exp_f32 v122, v122
    v_mfma_f32_16x16x32_bf16 v[64:67], v[76:79], a[88:91], v[64:67]
    v_exp_f32 v123, v123
    v_mfma_f32_16x16x32_bf16 v[68:71], v[76:79], a[92:95], v[68:71]
    s_waitcnt lgkmcnt(5)
    v_exp_f32 v124, v124
    v_mfma_f32_16x16x32_bf16 v[56:59], v[80:83], a[96:99], v[56:59]
    ds_read_b128 v[72:75], v135 offset:14336
    ds_read_b128 v[76:79], v12 offset:36864
    v_mfma_f32_16x16x32_bf16 v[60:63], v[80:83], a[100:103], v[60:63]
    s_waitcnt lgkmcnt(6)
    v_exp_f32 v125, v125
    v_mfma_f32_16x16x32_bf16 v[64:67], v[84:87], a[96:99], v[64:67]
    ds_read_b128 v[80:83], v12 offset:58368
    buffer_load_dwordx4 v[240:243], v2, s[8:11], s33 offen offset:3072 sc1
    v_mfma_f32_16x16x32_bf16 v[68:71], v[84:87], a[100:103], v[68:71]
    s_waitcnt lgkmcnt(6)
    ds_read_b128 v[84:87], v135 offset:15360
    buffer_load_dwordx4 v[244:247], v8, s[8:11], s33 offen offset:0 sc1
    v_mfma_f32_16x16x32_bf16 v[56:59], v[88:91], a[104:107], v[56:59]
    s_add_u32 s33, s37, 10240
    v_fma_f32 v122, v122, v116, v116
    v_fma_f32 v123, v123, v116, v116
    v_mfma_f32_16x16x32_bf16 v[60:63], v[88:91], a[108:111], v[60:63]
    s_waitcnt lgkmcnt(6)
    ds_read_b128 v[88:91], v12 offset:37888
    v_fma_f32 v124, v124, v116, v116
    v_mfma_f32_16x16x32_bf16 v[64:67], v[92:95], a[104:107], v[64:67]
    buffer_load_dwordx4 v[248:251], v2, s[8:11], s33 offen offset:0 sc1
    v_fma_f32 v125, v125, v116, v116
    v_mfma_f32_16x16x32_bf16 v[68:71], v[92:95], a[108:111], v[68:71]
    s_waitcnt lgkmcnt(6)
    v_rcp_f32 v122, v122
    v_mfma_f32_16x16x32_bf16 v[48:51], v[96:99], a[112:115], v[48:51]
    s_waitcnt vmcnt(10)
    v_rcp_f32 v123, v123
    v_mfma_f32_16x16x32_bf16 v[52:55], v[96:99], a[116:119], v[52:55]
    s_waitcnt lgkmcnt(5)
    v_rcp_f32 v124, v124
    v_mfma_f32_16x16x32_bf16 v[56:59], v[100:103], a[112:115], v[56:59]
    s_barrier
    ds_read_b128 v[92:95], v12 offset:59392
    ds_read_b128 v[96:99], v135 offset:16384
    v_mfma_f32_16x16x32_bf16 v[60:63], v[100:103], a[116:119], v[60:63]
    s_waitcnt lgkmcnt(6)
    v_rcp_f32 v125, v125
    v_mfma_f32_16x16x32_bf16 v[64:67], v[72:75], a[112:115], v[64:67]
    ds_read_b128 v[100:103], v12 offset:38912
    buffer_store_dword v14, v15, s[8:11], s36 offen sc1
    v_mfma_f32_16x16x32_bf16 v[68:71], v[72:75], a[116:119], v[68:71]
    s_waitcnt lgkmcnt(6)
    ds_read_b128 v[72:75], v12 offset:60416
    s_add_u32 s36, s36, 4
    v_mfma_f32_16x16x32_bf16 v[48:51], v[76:79], a[120:123], v[48:51]
    v_mul_f32 v40, v40, v122
    v_mul_f32 v41, v41, v123
    v_mfma_f32_16x16x32_bf16 v[52:55], v[76:79], a[124:127], v[52:55]
    s_waitcnt lgkmcnt(6)
    ds_read_b128 v[76:79], v135 offset:17408
    v_mul_f32 v42, v42, v124
    v_mfma_f32_16x16x32_bf16 v[56:59], v[80:83], a[120:123], v[56:59]
    v_mul_f32 v43, v43, v125
    v_cvt_pk_bf16_f32 v126, v32, v33
    v_mfma_f32_16x16x32_bf16 v[60:63], v[80:83], a[124:127], v[60:63]
    s_waitcnt lgkmcnt(6)
    ds_read_b128 v[80:83], v12 offset:39936
    v_cvt_pk_bf16_f32 v127, v34, v35
    v_mfma_f32_16x16x32_bf16 v[64:67], v[84:87], a[120:123], v[64:67]
    v_cvt_pk_bf16_f32 v128, v40, v41
    v_cvt_pk_bf16_f32 v129, v42, v43
    v_mfma_f32_16x16x32_bf16 v[68:71], v[84:87], a[124:127], v[68:71]
    s_waitcnt lgkmcnt(6)
    ds_read_b128 v[84:87], v12 offset:61440
    buffer_load_dwordx4 v[252:255], v2, s[8:11], s33 offen offset:1024 sc1
    v_mfma_f32_16x16x32_bf16 v[48:51], v[88:91], a[128:131], v[48:51]
    buffer_store_dwordx4 v[126:129], v2, s[8:11], s28 offen offset:1024 sc1
    v_mul_f32 v122, v36, v36
    v_mfma_f32_16x16x32_bf16 v[52:55], v[88:91], a[132:135], v[52:55]
    s_waitcnt lgkmcnt(6)
    ds_read_b128 v[88:91], v135 offset:18432
    v_mul_f32 v123, v37, v37
    v_mfma_f32_16x16x32_bf16 v[56:59], v[92:95], a[128:131], v[56:59]
    v_mul_f32 v124, v38, v38
    v_mul_f32 v125, v39, v39
    v_mfma_f32_16x16x32_bf16 v[60:63], v[92:95], a[132:135], v[60:63]
    s_waitcnt lgkmcnt(6)
    ds_read_b128 v[92:95], v12 offset:40960
    buffer_load_dwordx4 v[156:159], v2, s[8:11], s33 offen offset:2048 sc1
    v_mfma_f32_16x16x32_bf16 v[64:67], v[96:99], a[128:131], v[64:67]
    v_fma_f32 v122, v122, v115, v113
    v_fma_f32 v123, v123, v115, v113
    v_mfma_f32_16x16x32_bf16 v[68:71], v[96:99], a[132:135], v[68:71]
    s_waitcnt lgkmcnt(6)
    ds_read_b128 v[96:99], v12 offset:62464
    v_fma_f32 v124, v124, v115, v113
    v_mfma_f32_16x16x32_bf16 v[48:51], v[100:103], a[136:139], v[48:51]
    v_fma_f32 v125, v125, v115, v113
    v_mul_f32 v122, v122, v36
    v_mfma_f32_16x16x32_bf16 v[52:55], v[100:103], a[140:143], v[52:55]
    s_waitcnt lgkmcnt(6)
    ds_read_b128 v[100:103], v135 offset:19456
    buffer_load_dwordx4 v[160:163], v2, s[8:11], s33 offen offset:3072 sc1
    v_mfma_f32_16x16x32_bf16 v[56:59], v[72:75], a[136:139], v[56:59]
    v_mul_f32 v123, v123, v37
    v_mul_f32 v124, v124, v38
    v_mfma_f32_16x16x32_bf16 v[60:63], v[72:75], a[140:143], v[60:63]
    s_waitcnt lgkmcnt(6)
    ds_read_b128 v[72:75], v12 offset:41984
    v_mul_f32 v125, v125, v39
    v_mfma_f32_16x16x32_bf16 v[64:67], v[76:79], a[136:139], v[64:67]
    v_exp_f32 v122, v122
    v_mfma_f32_16x16x32_bf16 v[68:71], v[76:79], a[140:143], v[68:71]
    s_waitcnt lgkmcnt(6)
    v_exp_f32 v123, v123
    v_mfma_f32_16x16x32_bf16 v[48:51], v[80:83], a[144:147], v[48:51]
    v_exp_f32 v124, v124
    v_mfma_f32_16x16x32_bf16 v[52:55], v[80:83], a[148:151], v[52:55]
    s_waitcnt lgkmcnt(5)
    v_exp_f32 v125, v125
    v_mfma_f32_16x16x32_bf16 v[56:59], v[84:87], a[144:147], v[56:59]
    ds_read_b128 v[76:79], v12 offset:63488
    ds_read_b128 v[80:83], v135 offset:20480
    v_mfma_f32_16x16x32_bf16 v[60:63], v[84:87], a[148:151], v[60:63]
    s_waitcnt lgkmcnt(6)
    buffer_load_dwordx4 v[164:167], v8, s[8:11], s33 offen offset:0 sc1
    s_add_u32 s33, s37, 30720
    v_mfma_f32_16x16x32_bf16 v[64:67], v[88:91], a[144:147], v[64:67]
    buffer_load_dwordx4 v[168:171], v2, s[8:11], s33 offen offset:0 sc1
    v_fma_f32 v122, v122, v117, v117
    v_mfma_f32_16x16x32_bf16 v[68:71], v[88:91], a[148:151], v[68:71]
    s_waitcnt lgkmcnt(5)
    v_fma_f32 v123, v123, v117, v117
    v_fma_f32 v124, v124, v117, v117
    v_mfma_f32_16x16x32_bf16 v[48:51], v[92:95], a[152:155], v[48:51]
    v_fma_f32 v125, v125, v117, v117
    v_mfma_f32_16x16x32_bf16 v[52:55], v[92:95], a[156:159], v[52:55]
    s_waitcnt lgkmcnt(4)
    v_rcp_f32 v122, v122
    v_mfma_f32_16x16x32_bf16 v[56:59], v[96:99], a[152:155], v[56:59]
    v_rcp_f32 v123, v123
    v_mfma_f32_16x16x32_bf16 v[60:63], v[96:99], a[156:159], v[60:63]
    s_waitcnt lgkmcnt(3)
    v_rcp_f32 v124, v124
    v_mfma_f32_16x16x32_bf16 v[64:67], v[100:103], a[152:155], v[64:67]
    v_rcp_f32 v125, v125
    v_mfma_f32_16x16x32_bf16 v[68:71], v[100:103], a[156:159], v[68:71]
    s_waitcnt lgkmcnt(2)
    buffer_load_dwordx4 v[172:175], v2, s[8:11], s33 offen offset:1024 sc1
    v_mul_f32 v36, v36, v122
    v_mfma_f32_16x16x32_bf16 v[48:51], v[72:75], v[104:107], v[48:51]
    buffer_load_dwordx4 v[176:179], v2, s[8:11], s33 offen offset:2048 sc1
    v_mul_f32 v37, v37, v123
    v_mfma_f32_16x16x32_bf16 v[52:55], v[72:75], v[108:111], v[52:55]
    s_waitcnt lgkmcnt(1)
    v_mul_f32 v38, v38, v124
    v_mul_f32 v39, v39, v125
    v_mfma_f32_16x16x32_bf16 v[56:59], v[76:79], v[104:107], v[56:59]
    v_mfma_f32_16x16x32_bf16 v[60:63], v[76:79], v[108:111], v[60:63]
    s_waitcnt lgkmcnt(0)
    v_mfma_f32_16x16x32_bf16 v[64:67], v[80:83], v[104:107], v[64:67]
    v_mfma_f32_16x16x32_bf16 v[68:71], v[80:83], v[108:111], v[68:71]
    buffer_load_dwordx4 v[180:183], v2, s[8:11], s33 offen offset:3072 sc1
    v_pk_mul_f32 v[72:73], v[44:45], v[44:45]
    v_pk_mul_f32 v[74:75], v[46:47], v[46:47]
    v_pk_fma_f32 v[72:73], v[72:73], v[114:115], v[112:113] op_sel:[0,1,1] op_sel_hi:[1,1,1]
    v_pk_fma_f32 v[74:75], v[74:75], v[114:115], v[112:113] op_sel:[0,1,1] op_sel_hi:[1,1,1]
    v_pk_mul_f32 v[72:73], v[72:73], v[44:45]
    v_pk_mul_f32 v[74:75], v[74:75], v[46:47]
    buffer_load_dwordx4 a[76:79], v8, s[8:11], s33 offen offset:0 sc1
    s_add_u32 s33, s37, 46080
    v_exp_f32 v72, v72
    v_exp_f32 v73, v73
    v_exp_f32 v74, v74
    v_exp_f32 v75, v75
    v_pk_fma_f32 v[72:73], v[72:73], v[116:117], v[116:117] op_sel:[0,1,1] op_sel_hi:[1,1,1]
    v_pk_fma_f32 v[74:75], v[74:75], v[116:117], v[116:117] op_sel:[0,1,1] op_sel_hi:[1,1,1]
    v_rcp_f32 v72, v72
    v_rcp_f32 v73, v73
    buffer_load_dwordx4 a[80:83], v2, s[8:11], s33 offen offset:0 sc1
    v_rcp_f32 v74, v74
    v_rcp_f32 v75, v75
    v_pk_mul_f32 v[44:45], v[44:45], v[72:73]
    v_pk_mul_f32 v[46:47], v[46:47], v[74:75]
    v_cvt_pk_bf16_f32 v130, v36, v37
    v_cvt_pk_bf16_f32 v131, v38, v39
    v_cvt_pk_bf16_f32 v132, v44, v45
    v_cvt_pk_bf16_f32 v133, v46, v47
    buffer_store_dwordx4 v[130:133], v134, s[8:11], s28 offen offset:1024 sc1
    v_pk_mul_f32 v[72:73], v[48:49], v[48:49]
    buffer_load_dword v6, v0, s[8:11], 0 offen sc1
    v_pk_mul_f32 v[74:75], v[50:51], v[50:51]
    v_pk_mul_f32 v[76:77], v[56:57], v[56:57]
    v_pk_mul_f32 v[78:79], v[58:59], v[58:59]
    v_pk_fma_f32 v[72:73], v[72:73], v[114:115], v[112:113] op_sel:[0,0,0] op_sel_hi:[1,0,0]
    v_pk_fma_f32 v[74:75], v[74:75], v[114:115], v[112:113] op_sel:[0,0,0] op_sel_hi:[1,0,0]
    v_pk_fma_f32 v[76:77], v[76:77], v[114:115], v[112:113] op_sel:[0,0,0] op_sel_hi:[1,0,0]
    v_pk_fma_f32 v[78:79], v[78:79], v[114:115], v[112:113] op_sel:[0,0,0] op_sel_hi:[1,0,0]
    v_pk_mul_f32 v[72:73], v[72:73], v[48:49]
    v_pk_mul_f32 v[74:75], v[74:75], v[50:51]
    v_pk_mul_f32 v[76:77], v[76:77], v[56:57]
    v_pk_mul_f32 v[78:79], v[78:79], v[58:59]
    v_exp_f32 v72, v72
    v_exp_f32 v73, v73
    buffer_load_dwordx4 a[84:87], v2, s[8:11], s33 offen offset:1024 sc1
    v_exp_f32 v74, v74
    v_exp_f32 v75, v75
    v_exp_f32 v76, v76
    v_exp_f32 v77, v77
    v_exp_f32 v78, v78
    v_exp_f32 v79, v79
    v_pk_fma_f32 v[72:73], v[72:73], v[116:117], v[116:117] op_sel:[0,0,0] op_sel_hi:[1,0,0]
    v_pk_fma_f32 v[74:75], v[74:75], v[116:117], v[116:117] op_sel:[0,0,0] op_sel_hi:[1,0,0]
    buffer_load_dwordx4 a[88:91], v2, s[8:11], s33 offen offset:2048 sc1
    v_pk_fma_f32 v[76:77], v[76:77], v[116:117], v[116:117] op_sel:[0,0,0] op_sel_hi:[1,0,0]
    v_pk_fma_f32 v[78:79], v[78:79], v[116:117], v[116:117] op_sel:[0,0,0] op_sel_hi:[1,0,0]
    v_rcp_f32 v72, v72
    v_rcp_f32 v73, v73
    v_rcp_f32 v74, v74
    v_rcp_f32 v75, v75
    v_rcp_f32 v76, v76
    v_rcp_f32 v77, v77
    buffer_load_dwordx4 a[92:95], v2, s[8:11], s33 offen offset:3072 sc1
    v_rcp_f32 v78, v78
    v_rcp_f32 v79, v79
    v_pk_mul_f32 v[48:49], v[48:49], v[72:73]
    v_pk_mul_f32 v[50:51], v[50:51], v[74:75]
    v_pk_mul_f32 v[56:57], v[56:57], v[76:77]
    v_pk_mul_f32 v[58:59], v[58:59], v[78:79]
    v_cvt_pk_bf16_f32 v118, v48, v49
    v_cvt_pk_bf16_f32 v119, v50, v51
    v_cvt_pk_bf16_f32 v120, v56, v57
    v_cvt_pk_bf16_f32 v121, v58, v59
    buffer_store_dwordx4 v[118:121], v2, s[8:11], s28 offen offset:2048 sc1
    v_pk_mul_f32 v[72:73], v[52:53], v[52:53]
    v_pk_mul_f32 v[74:75], v[54:55], v[54:55]
    v_pk_mul_f32 v[76:77], v[60:61], v[60:61]
    v_pk_mul_f32 v[78:79], v[62:63], v[62:63]
    v_pk_fma_f32 v[72:73], v[72:73], v[114:115], v[112:113] op_sel:[0,1,1] op_sel_hi:[1,1,1]
    v_pk_fma_f32 v[74:75], v[74:75], v[114:115], v[112:113] op_sel:[0,1,1] op_sel_hi:[1,1,1]
    v_pk_fma_f32 v[76:77], v[76:77], v[114:115], v[112:113] op_sel:[0,1,1] op_sel_hi:[1,1,1]
    v_pk_fma_f32 v[78:79], v[78:79], v[114:115], v[112:113] op_sel:[0,1,1] op_sel_hi:[1,1,1]
    v_pk_mul_f32 v[72:73], v[72:73], v[52:53]
    v_pk_mul_f32 v[74:75], v[74:75], v[54:55]
    v_pk_mul_f32 v[76:77], v[76:77], v[60:61]
    v_pk_mul_f32 v[78:79], v[78:79], v[62:63]
    v_exp_f32 v72, v72
    v_exp_f32 v73, v73
    v_exp_f32 v74, v74
    v_exp_f32 v75, v75
    buffer_load_dwordx4 a[96:99], v8, s[8:11], s33 offen offset:0 sc1
    s_add_u32 s33, s37, 66560
    v_exp_f32 v76, v76
    v_exp_f32 v77, v77
    v_exp_f32 v78, v78
    v_exp_f32 v79, v79
    v_pk_fma_f32 v[72:73], v[72:73], v[116:117], v[116:117] op_sel:[0,1,1] op_sel_hi:[1,1,1]
    v_pk_fma_f32 v[74:75], v[74:75], v[116:117], v[116:117] op_sel:[0,1,1] op_sel_hi:[1,1,1]
    v_pk_fma_f32 v[76:77], v[76:77], v[116:117], v[116:117] op_sel:[0,1,1] op_sel_hi:[1,1,1]
    v_pk_fma_f32 v[78:79], v[78:79], v[116:117], v[116:117] op_sel:[0,1,1] op_sel_hi:[1,1,1]
    buffer_load_dwordx4 a[100:103], v2, s[8:11], s33 offen offset:0 sc1
    v_rcp_f32 v72, v72
    v_rcp_f32 v73, v73
    v_rcp_f32 v74, v74
    v_rcp_f32 v75, v75
    v_rcp_f32 v76, v76
    v_rcp_f32 v77, v77
    v_rcp_f32 v78, v78
    v_rcp_f32 v79, v79
    buffer_load_dwordx4 a[104:107], v2, s[8:11], s33 offen offset:1024 sc1
    v_pk_mul_f32 v[52:53], v[52:53], v[72:73]
    v_pk_mul_f32 v[54:55], v[54:55], v[74:75]
    v_pk_mul_f32 v[60:61], v[60:61], v[76:77]
    v_pk_mul_f32 v[62:63], v[62:63], v[78:79]
    v_cvt_pk_bf16_f32 v122, v52, v53
    v_cvt_pk_bf16_f32 v123, v54, v55
    v_cvt_pk_bf16_f32 v124, v60, v61
    v_cvt_pk_bf16_f32 v125, v62, v63
    buffer_store_dwordx4 v[122:125], v134, s[8:11], s28 offen offset:2048 sc1
    v_pk_mul_f32 v[72:73], v[64:65], v[64:65]
    v_pk_mul_f32 v[74:75], v[66:67], v[66:67]
    v_pk_mul_f32 v[76:77], v[68:69], v[68:69]
    v_pk_mul_f32 v[78:79], v[70:71], v[70:71]
    v_pk_fma_f32 v[72:73], v[72:73], v[114:115], v[112:113] op_sel:[0,0,0] op_sel_hi:[1,0,0]
    v_pk_fma_f32 v[74:75], v[74:75], v[114:115], v[112:113] op_sel:[0,0,0] op_sel_hi:[1,0,0]
    s_waitcnt vmcnt(8)
    v_cmp_ne_u32 vcc, s52, v6
    s_nop 0
    s_cmp_lg_u64 vcc, 0
    s_cbranch_scc1 L44
L45:
    v_add_u32 v0, 4, v0
    buffer_load_dwordx4 a[0:3], v2, s[8:11], s94 offen offset:0 sc1
    v_pk_fma_f32 v[76:77], v[76:77], v[114:115], v[112:113] op_sel:[0,1,1] op_sel_hi:[1,1,1]
    v_pk_fma_f32 v[78:79], v[78:79], v[114:115], v[112:113] op_sel:[0,1,1] op_sel_hi:[1,1,1]
    v_pk_mul_f32 v[72:73], v[72:73], v[64:65]
    v_pk_mul_f32 v[74:75], v[74:75], v[66:67]
    v_pk_mul_f32 v[76:77], v[76:77], v[68:69]
    v_pk_mul_f32 v[78:79], v[78:79], v[70:71]
    buffer_load_dwordx4 a[4:7], v8, s[8:11], s94 offen offset:0 sc1
    v_exp_f32 v72, v72
    v_exp_f32 v73, v73
    v_exp_f32 v74, v74
    v_exp_f32 v75, v75
    s_barrier
    buffer_store_dword v14, v15, s[8:11], s36 offen sc1
    s_add_u32 s36, s36, 4
    v_exp_f32 v76, v76
    v_exp_f32 v77, v77
    buffer_load_dwordx4 a[8:11], v8, s[8:11], s94 offen offset:3072 sc1
    v_exp_f32 v78, v78
    v_exp_f32 v79, v79
    v_pk_fma_f32 v[72:73], v[72:73], v[116:117], v[116:117] op_sel:[0,0,0] op_sel_hi:[1,0,0]
    v_pk_fma_f32 v[74:75], v[74:75], v[116:117], v[116:117] op_sel:[0,0,0] op_sel_hi:[1,0,0]
    v_pk_fma_f32 v[76:77], v[76:77], v[116:117], v[116:117] op_sel:[0,1,1] op_sel_hi:[1,1,1]
    v_pk_fma_f32 v[78:79], v[78:79], v[116:117], v[116:117] op_sel:[0,1,1] op_sel_hi:[1,1,1]
    buffer_load_dwordx4 a[12:15], v11, s[8:11], s94 offen offset:3072 sc1
    v_rcp_f32 v72, v72
    v_rcp_f32 v73, v73
    v_rcp_f32 v74, v74
    v_rcp_f32 v75, v75
    v_rcp_f32 v76, v76
    v_rcp_f32 v77, v77
    buffer_load_dwordx4 a[16:19], v2, s[8:11], s95 offen offset:0 sc1
    v_rcp_f32 v78, v78
    v_rcp_f32 v79, v79
    v_pk_mul_f32 v[64:65], v[64:65], v[72:73]
    v_pk_mul_f32 v[66:67], v[66:67], v[74:75]
    v_pk_mul_f32 v[68:69], v[68:69], v[76:77]
    v_pk_mul_f32 v[70:71], v[70:71], v[78:79]
    buffer_load_dwordx4 a[20:23], v8, s[8:11], s95 offen offset:0 sc1
    v_cvt_pk_bf16_f32 v126, v64, v65
    v_cvt_pk_bf16_f32 v127, v66, v67
    v_cvt_pk_bf16_f32 v128, v68, v69
    v_cvt_pk_bf16_f32 v129, v70, v71
    s_nop 0
    v_permlane16_swap_b32 v126, v128
    v_permlane16_swap_b32 v127, v129
    buffer_store_dwordx4 v[126:129], v13, s[8:11], s29 offen sc1
    v_add_u32 v12, 12288, v2
    v_add_u32 v135, 8192, v9
    s_waitcnt vmcnt(7)
    v_mfma_f32_16x16x32_bf16 v[16:19], a[180:183], a[0:3], 0
    v_mov_b32 v96, 155200
    v_lshl_add_u32 v97, v5, 4, v96
    v_mfma_f32_16x16x32_bf16 v[20:23], a[184:187], a[0:3], 0
    buffer_load_dwordx4 a[24:27], v8, s[8:11], s95 offen offset:3072 sc1
    v_lshl_add_u32 v98, v5, 3, v96
    v_mfma_f32_16x16x32_bf16 v[24:27], a[188:191], a[0:3], 0
    v_mul_u32_u24 v99, 40, v5
    v_add_u32 v99, 162944, v99
    v_mfma_f32_16x16x32_bf16 v[28:31], a[192:195], a[0:3], 0
    v_mfma_f32_16x16x32_bf16 v[32:35], a[196:199], a[0:3], 0
    s_waitcnt vmcnt(7)
    buffer_load_dwordx4 a[28:31], v11, s[8:11], s95 offen offset:3072 sc1
    v_mfma_f32_16x16x32_bf16 v[16:19], a[200:203], a[4:7], v[16:19]
    v_mfma_f32_16x16x32_bf16 v[20:23], a[204:207], a[4:7], v[20:23]
    v_mfma_f32_16x16x32_bf16 v[24:27], a[208:211], a[4:7], v[24:27]
    buffer_load_dwordx4 a[32:35], v2, s[8:11], s96 offen offset:0 sc1
    v_mfma_f32_16x16x32_bf16 v[28:31], a[212:215], a[4:7], v[28:31]
    ds_read_b128 v[124:127], v97 offset:1280
    ds_read_b128 v[128:131], v97 offset:1344
    v_mfma_f32_16x16x32_bf16 v[32:35], a[216:219], a[4:7], v[32:35]
    s_waitcnt vmcnt(7)
    ds_read_b64 v[132:133], v98 offset:1536
    v_mov_b32 v134, v99
    v_mfma_f32_16x16x32_bf16 v[16:19], a[220:223], a[8:11], v[16:19]
    s_mov_b32 s4, s44
    buffer_load_dwordx4 a[36:39], v8, s[8:11], s96 offen offset:0 sc1
    s_mov_b32 s5, s45
    v_mfma_f32_16x16x32_bf16 v[20:23], a[224:227], a[8:11], v[20:23]
    v_mfma_f32_16x16x32_bf16 v[24:27], a[228:231], a[8:11], v[24:27]
    v_mfma_f32_16x16x32_bf16 v[28:31], a[232:235], a[8:11], v[28:31]
    buffer_load_dwordx4 a[40:43], v8, s[8:11], s96 offen offset:3072 sc1
    v_mfma_f32_16x16x32_bf16 v[32:35], a[236:239], a[8:11], v[32:35]
    s_waitcnt vmcnt(8)
    buffer_load_dword v6, v0, s[8:11], 0 offen sc1
    v_mfma_f32_16x16x32_bf16 v[16:19], a[240:243], a[12:15], v[16:19]
    v_mfma_f32_16x16x32_bf16 v[20:23], a[244:247], a[12:15], v[20:23]
    buffer_load_dwordx4 a[44:47], v11, s[8:11], s96 offen offset:3072 sc1
    v_mfma_f32_16x16x32_bf16 v[24:27], a[248:251], a[12:15], v[24:27]
    v_mfma_f32_16x16x32_bf16 v[28:31], a[252:255], a[12:15], v[28:31]
    v_mfma_f32_16x16x32_bf16 v[32:35], a[160:163], a[12:15], v[32:35]
    s_waitcnt vmcnt(9)
    buffer_load_dwordx4 a[48:51], v2, s[8:11], s97 offen offset:0 sc1
    v_mfma_f32_16x16x32_bf16 v[36:39], a[180:183], a[16:19], 0
    s_waitcnt lgkmcnt(0)
    v_lshlrev_b32 v96, 16, v124
    v_and_b32 v97, 0xffff0000, v124
    v_mfma_f32_16x16x32_bf16 v[40:43], a[184:187], a[16:19], 0
    v_lshlrev_b32 v98, 16, v125
    v_and_b32 v99, 0xffff0000, v125
    v_mfma_f32_16x16x32_bf16 v[44:47], a[188:191], a[16:19], 0
    buffer_load_dwordx4 a[52:55], v8, s[8:11], s97 offen offset:0 sc1
    v_lshlrev_b32 v100, 16, v126
    v_mfma_f32_16x16x32_bf16 v[48:51], a[192:195], a[16:19], 0
    v_and_b32 v101, 0xffff0000, v126
    v_lshlrev_b32 v102, 16, v127
    v_mfma_f32_16x16x32_bf16 v[52:55], a[196:199], a[16:19], 0
    s_waitcnt vmcnt(10)
    v_and_b32 v103, 0xffff0000, v127
    v_lshlrev_b32 v104, 16, v128
    v_mfma_f32_16x16x32_bf16 v[36:39], a[200:203], a[20:23], v[36:39]
    buffer_load_dwordx4 a[56:59], v8, s[8:11], s97 offen offset:3072 sc1
    v_and_b32 v105, 0xffff0000, v128
    v_mfma_f32_16x16x32_bf16 v[40:43], a[204:207], a[20:23], v[40:43]
    v_lshlrev_b32 v106, 16, v129
    v_and_b32 v107, 0xffff0000, v129
    v_mfma_f32_16x16x32_bf16 v[44:47], a[208:211], a[20:23], v[44:47]
    v_lshlrev_b32 v108, 16, v130
    v_and_b32 v109, 0xffff0000, v130
    v_mfma_f32_16x16x32_bf16 v[48:51], a[212:215], a[20:23], v[48:51]
    buffer_load_dwordx4 a[60:63], v11, s[8:11], s97 offen offset:3072 sc1
    v_lshlrev_b32 v110, 16, v131
    v_mfma_f32_16x16x32_bf16 v[52:55], a[216:219], a[20:23], v[52:55]
    s_waitcnt vmcnt(10)
    v_and_b32 v111, 0xffff0000, v131
    v_lshlrev_b32 v112, 16, v132
    v_mfma_f32_16x16x32_bf16 v[36:39], a[220:223], a[24:27], v[36:39]
    v_and_b32 v113, 0xffff0000, v132
    v_lshlrev_b32 v114, 16, v133
    v_mfma_f32_16x16x32_bf16 v[40:43], a[224:227], a[24:27], v[40:43]
    v_and_b32 v115, 0xffff0000, v133
    ds_read_b64 v[116:117], v134 offset:0
    v_mfma_f32_16x16x32_bf16 v[44:47], a[228:231], a[24:27], v[44:47]
    ds_read_b64 v[118:119], v134 offset:8
    ds_read_b64 v[120:121], v134 offset:16
    v_mfma_f32_16x16x32_bf16 v[48:51], a[232:235], a[24:27], v[48:51]
    ds_read_b64 v[122:123], v134 offset:24
    ds_read_b64 v[124:125], v134 offset:32
    v_mfma_f32_16x16x32_bf16 v[52:55], a[236:239], a[24:27], v[52:55]
    s_waitcnt vmcnt(9)
    v_mfma_f32_16x16x32_bf16 v[36:39], a[240:243], a[28:31], v[36:39]
    v_mfma_f32_16x16x32_bf16 v[40:43], a[244:247], a[28:31], v[40:43]
    v_mfma_f32_16x16x32_bf16 v[44:47], a[248:251], a[28:31], v[44:47]
    v_mfma_f32_16x16x32_bf16 v[48:51], a[252:255], a[28:31], v[48:51]
    v_mfma_f32_16x16x32_bf16 v[52:55], a[160:163], a[28:31], v[52:55]
    s_waitcnt vmcnt(8)
    v_mfma_f32_16x16x32_bf16 v[56:59], a[180:183], a[32:35], 0
    v_mfma_f32_16x16x32_bf16 v[60:63], a[184:187], a[32:35], 0
    v_mfma_f32_16x16x32_bf16 v[64:67], a[188:191], a[32:35], 0
    buffer_load_dwordx4 a[108:111], v2, s[8:11], s33 offen offset:2048 sc1
    v_mfma_f32_16x16x32_bf16 v[68:71], a[192:195], a[32:35], 0
    v_mfma_f32_16x16x32_bf16 v[72:75], a[196:199], a[32:35], 0
    s_waitcnt vmcnt(8)
    s_barrier
    buffer_store_dword v14, v15, s[8:11], s36 offen sc1
    v_mfma_f32_16x16x32_bf16 v[56:59], a[200:203], a[36:39], v[56:59]
    s_add_u32 s36, s36, 4
    s_waitcnt vmcnt(7)
    v_mfma_f32_16x16x32_bf16 v[60:63], a[204:207], a[36:39], v[60:63]
    v_cmp_ne_u32 vcc, s52, v6
    s_nop 0
    s_cmp_lg_u64 vcc, 0
    s_cbranch_scc1 L46
L47:
    v_mfma_f32_16x16x32_bf16 v[64:67], a[208:211], a[36:39], v[64:67]
    v_add_u32 v0, 4, v0
    buffer_load_dwordx4 a[64:67], v2, s[8:11], s94 offen offset:1024 sc1
    v_mfma_f32_16x16x32_bf16 v[68:71], a[212:215], a[36:39], v[68:71]
    buffer_load_dwordx4 a[68:71], v8, s[8:11], s94 offen offset:1024 sc1
    v_mfma_f32_16x16x32_bf16 v[72:75], a[216:219], a[36:39], v[72:75]
    v_mfma_f32_16x16x32_bf16 v[56:59], a[220:223], a[40:43], v[56:59]
    s_waitcnt lgkmcnt(0)
    buffer_load_dwordx4 a[72:75], v11, s[8:11], s94 offen offset:0 sc1
    v_lshlrev_b32 v126, 16, v116
    v_mfma_f32_16x16x32_bf16 v[60:63], a[224:227], a[40:43], v[60:63]
    v_and_b32 v127, 0xffff0000, v116
    v_fmac_f32 v136, v126, v96
    v_mfma_f32_16x16x32_bf16 v[64:67], a[228:231], a[40:43], v[64:67]
    v_fmac_f32 v137, v127, v97
    v_lshlrev_b32 v126, 16, v117
    v_mfma_f32_16x16x32_bf16 v[68:71], a[232:235], a[40:43], v[68:71]
    buffer_load_dwordx4 a[0:3], v12, s[8:11], s94 offen offset:0 sc1
    v_and_b32 v127, 0xffff0000, v117
    v_mfma_f32_16x16x32_bf16 v[72:75], a[236:239], a[40:43], v[72:75]
    s_waitcnt vmcnt(10)
    v_fmac_f32 v138, v126, v98
    v_fmac_f32 v139, v127, v99
    v_mfma_f32_16x16x32_bf16 v[56:59], a[240:243], a[44:47], v[56:59]
    v_lshlrev_b32 v126, 16, v118
    v_and_b32 v127, 0xffff0000, v118
    v_mfma_f32_16x16x32_bf16 v[60:63], a[244:247], a[44:47], v[60:63]
    buffer_load_dwordx4 a[4:7], v2, s[8:11], s95 offen offset:1024 sc1
    v_fmac_f32 v140, v126, v100
    v_mfma_f32_16x16x32_bf16 v[64:67], a[248:251], a[44:47], v[64:67]
    v_fmac_f32 v141, v127, v101
    v_lshlrev_b32 v126, 16, v119
    v_mfma_f32_16x16x32_bf16 v[68:71], a[252:255], a[44:47], v[68:71]
    v_and_b32 v127, 0xffff0000, v119
    v_fmac_f32 v142, v126, v102
    v_mfma_f32_16x16x32_bf16 v[72:75], a[160:163], a[44:47], v[72:75]
    s_waitcnt vmcnt(10)
    buffer_load_dwordx4 a[8:11], v8, s[8:11], s95 offen offset:1024 sc1
    v_fmac_f32 v143, v127, v103
    v_mfma_f32_16x16x32_bf16 v[76:79], a[180:183], a[48:51], 0
    v_lshlrev_b32 v126, 16, v120
    v_and_b32 v127, 0xffff0000, v120
    v_mfma_f32_16x16x32_bf16 v[80:83], a[184:187], a[48:51], 0
    v_fmac_f32 v144, v126, v104
    v_fmac_f32 v145, v127, v105
    v_mfma_f32_16x16x32_bf16 v[84:87], a[188:191], a[48:51], 0
    buffer_load_dwordx4 a[12:15], v11, s[8:11], s95 offen offset:0 sc1
    v_lshlrev_b32 v126, 16, v121
    v_mfma_f32_16x16x32_bf16 v[88:91], a[192:195], a[48:51], 0
    v_and_b32 v127, 0xffff0000, v121
    v_fmac_f32 v146, v126, v106
    v_mfma_f32_16x16x32_bf16 v[92:95], a[196:199], a[48:51], 0
    s_waitcnt vmcnt(11)
    v_fmac_f32 v147, v127, v107
    v_lshlrev_b32 v126, 16, v122
    v_mfma_f32_16x16x32_bf16 v[76:79], a[200:203], a[52:55], v[76:79]
    buffer_load_dwordx4 a[16:19], v12, s[8:11], s95 offen offset:0 sc1
    v_and_b32 v127, 0xffff0000, v122
    v_mfma_f32_16x16x32_bf16 v[80:83], a[204:207], a[52:55], v[80:83]
    v_fmac_f32 v148, v126, v108
    v_fmac_f32 v149, v127, v109
    v_mfma_f32_16x16x32_bf16 v[84:87], a[208:211], a[52:55], v[84:87]
    v_lshlrev_b32 v126, 16, v123
    v_and_b32 v127, 0xffff0000, v123
    v_mfma_f32_16x16x32_bf16 v[88:91], a[212:215], a[52:55], v[88:91]
    buffer_load_dwordx4 a[20:23], v2, s[8:11], s96 offen offset:1024 sc1
    v_fmac_f32 v150, v126, v110
    v_mfma_f32_16x16x32_bf16 v[92:95], a[216:219], a[52:55], v[92:95]
    s_waitcnt vmcnt(12)
    v_fmac_f32 v151, v127, v111
    v_lshlrev_b32 v126, 16, v124
    v_mfma_f32_16x16x32_bf16 v[76:79], a[220:223], a[56:59], v[76:79]
    v_and_b32 v127, 0xffff0000, v124
    v_fmac_f32 v152, v126, v112
    v_mfma_f32_16x16x32_bf16 v[80:83], a[224:227], a[56:59], v[80:83]
    buffer_load_dwordx4 a[24:27], v8, s[8:11], s96 offen offset:1024 sc1
    v_fmac_f32 v153, v127, v113
    v_mfma_f32_16x16x32_bf16 v[84:87], a[228:231], a[56:59], v[84:87]
    v_lshlrev_b32 v126, 16, v125
    v_and_b32 v127, 0xffff0000, v125
    v_mfma_f32_16x16x32_bf16 v[88:91], a[232:235], a[56:59], v[88:91]
    v_fmac_f32 v154, v126, v114
    v_fmac_f32 v155, v127, v115
    v_mfma_f32_16x16x32_bf16 v[92:95], a[236:239], a[56:59], v[92:95]
    s_waitcnt vmcnt(12)
    buffer_load_dwordx4 a[28:31], v11, s[8:11], s96 offen offset:0 sc1
    v_readfirstlane_b32 s54, v3
    v_mfma_f32_16x16x32_bf16 v[76:79], a[240:243], a[60:63], v[76:79]
    v_readfirstlane_b32 s56, v7
    v_mul_u32_u24 v116, 176, v4
    v_mfma_f32_16x16x32_bf16 v[80:83], a[244:247], a[60:63], v[80:83]
    v_mad_u32_u24 v116, v5, 40, v116
    s_and_b32 s55, s54, 32
    v_mfma_f32_16x16x32_bf16 v[84:87], a[248:251], a[60:63], v[84:87]
    s_sub_u32 s54, s54, s55
    buffer_load_dwordx4 a[32:35], v12, s[8:11], s96 offen offset:0 sc1
    s_add_u32 s56, s56, 32
    v_mfma_f32_16x16x32_bf16 v[88:91], a[252:255], a[60:63], v[88:91]
    v_add_u32 v116, s56, v116
    s_sub_u32 s56, s56, s55
    v_mfma_f32_16x16x32_bf16 v[92:95], a[160:163], a[60:63], v[92:95]
    s_waitcnt vmcnt(11)
    v_bfe_u32 v121, v1, 2, 3
    v_bcnt_u32_b32 v122, v121, 0
    v_mfma_f32_16x16x32_bf16 v[16:19], a[164:167], a[64:67], v[16:19]
    buffer_load_dwordx4 a[36:39], v2, s[8:11], s97 offen offset:1024 sc1
    v_and_b32 v121, 6, v121
    v_mfma_f32_16x16x32_bf16 v[20:23], a[168:171], a[64:67], v[20:23]
    v_and_b32 v122, 1, v122
    v_lshl_add_u32 v121, v121, 1, v122
    v_mfma_f32_16x16x32_bf16 v[24:27], a[172:175], a[64:67], v[24:27]
    v_and_b32 v122, 2, v5
    v_add_u32 v121, v121, v122
    v_mfma_f32_16x16x32_bf16 v[28:31], a[176:179], a[64:67], v[28:31]
    buffer_load_dwordx4 a[40:43], v8, s[8:11], s97 offen offset:1024 sc1
    v_and_b32 v122, 48, v2
    v_mfma_f32_16x16x32_bf16 v[32:35], v[184:187], a[64:67], v[32:35]
    s_waitcnt vmcnt(12)
    v_mul_u32_u24 v117, 176, v121
    v_add3_u32 v117, v117, v122, s56
    v_mfma_f32_16x16x32_bf16 v[16:19], v[188:191], a[68:71], v[16:19]
    v_mul_u32_u24 v118, 2560, v121
    v_add3_u32 v118, v118, v122, s54
    v_mfma_f32_16x16x32_bf16 v[20:23], v[192:195], a[68:71], v[20:23]
    buffer_load_dword v6, v0, s[8:11], 0 offen sc1
    buffer_load_dwordx4 a[44:47], v11, s[8:11], s97 offen offset:0 sc1
    v_mfma_f32_16x16x32_bf16 v[24:27], v[196:199], a[68:71], v[24:27]
    v_mov_b32 v123, 0x40000000
    v_cmp_le_u32 s[56:57], s55, v122
    v_mfma_f32_16x16x32_bf16 v[28:31], v[200:203], a[68:71], v[28:31]
    s_add_u32 s55, s55, 32
    v_cndmask_b32 v119, v123, v118, s[56:57]
    v_cmp_gt_u32 s[56:57], s55, v122
    v_mfma_f32_16x16x32_bf16 v[32:35], v[204:207], a[68:71], v[32:35]
    s_waitcnt vmcnt(13)
    buffer_load_dwordx4 a[48:51], v12, s[8:11], s97 offen offset:0 sc1
    v_cndmask_b32 v120, v123, v118, s[56:57]
    v_mfma_f32_16x16x32_bf16 v[16:19], v[208:211], a[72:75], v[16:19]
    v_mfma_f32_16x16x32_bf16 v[20:23], v[212:215], a[72:75], v[20:23]
    v_mfma_f32_16x16x32_bf16 v[24:27], v[216:219], a[72:75], v[24:27]
    v_mfma_f32_16x16x32_bf16 v[28:31], v[220:223], a[72:75], v[28:31]
    v_mfma_f32_16x16x32_bf16 v[32:35], v[224:227], a[72:75], v[32:35]
    s_waitcnt vmcnt(13)
    v_mfma_f32_16x16x32_bf16 v[16:19], v[228:231], a[0:3], v[16:19]
    v_mfma_f32_16x16x32_bf16 v[20:23], v[232:235], a[0:3], v[20:23]
    buffer_load_dwordx4 a[112:115], v2, s[8:11], s33 offen offset:3072 sc1
    v_mfma_f32_16x16x32_bf16 v[24:27], v[236:239], a[0:3], v[24:27]
    v_mfma_f32_16x16x32_bf16 v[28:31], v[240:243], a[0:3], v[28:31]
    v_mfma_f32_16x16x32_bf16 v[32:35], v[244:247], a[0:3], v[32:35]
    s_waitcnt vmcnt(13)
    v_mfma_f32_16x16x32_bf16 v[36:39], a[164:167], a[4:7], v[36:39]
    buffer_load_dwordx4 a[116:119], v8, s[8:11], s33 offen offset:0 sc1
    s_add_u32 s33, s37, 15360
    v_mfma_f32_16x16x32_bf16 v[40:43], a[168:171], a[4:7], v[40:43]
    v_mfma_f32_16x16x32_bf16 v[44:47], a[172:175], a[4:7], v[44:47]
    v_mfma_f32_16x16x32_bf16 v[48:51], a[176:179], a[4:7], v[48:51]
    v_mfma_f32_16x16x32_bf16 v[52:55], v[184:187], a[4:7], v[52:55]
    s_waitcnt vmcnt(13)
    buffer_load_dwordx4 a[120:123], v9, s[8:11], s33 offen offset:0 sc1
    v_mfma_f32_16x16x32_bf16 v[36:39], v[188:191], a[8:11], v[36:39]
    v_mfma_f32_16x16x32_bf16 v[40:43], v[192:195], a[8:11], v[40:43]
    v_mfma_f32_16x16x32_bf16 v[44:47], v[196:199], a[8:11], v[44:47]
    v_mfma_f32_16x16x32_bf16 v[48:51], v[200:203], a[8:11], v[48:51]
    buffer_load_dwordx4 a[124:127], v9, s[8:11], s33 offen offset:1024 sc1
    v_mfma_f32_16x16x32_bf16 v[52:55], v[204:207], a[8:11], v[52:55]
    s_waitcnt vmcnt(14)
    v_mfma_f32_16x16x32_bf16 v[36:39], v[208:211], a[12:15], v[36:39]
    v_mfma_f32_16x16x32_bf16 v[40:43], v[212:215], a[12:15], v[40:43]
    v_mfma_f32_16x16x32_bf16 v[44:47], v[216:219], a[12:15], v[44:47]
    buffer_load_dwordx4 a[128:131], v9, s[8:11], s33 offen offset:2048 sc1
    v_mfma_f32_16x16x32_bf16 v[48:51], v[220:223], a[12:15], v[48:51]
    v_mfma_f32_16x16x32_bf16 v[52:55], v[224:227], a[12:15], v[52:55]
    s_waitcnt vmcnt(14)
    v_mfma_f32_16x16x32_bf16 v[36:39], v[228:231], a[16:19], v[36:39]
    v_mfma_f32_16x16x32_bf16 v[40:43], v[232:235], a[16:19], v[40:43]
    buffer_load_dwordx4 a[132:135], v9, s[8:11], s33 offen offset:3072 sc1
    v_mfma_f32_16x16x32_bf16 v[44:47], v[236:239], a[16:19], v[44:47]
    v_mfma_f32_16x16x32_bf16 v[48:51], v[240:243], a[16:19], v[48:51]
    v_mfma_f32_16x16x32_bf16 v[52:55], v[244:247], a[16:19], v[52:55]
    s_waitcnt vmcnt(14)
    v_mfma_f32_16x16x32_bf16 v[56:59], a[164:167], a[20:23], v[56:59]
    buffer_load_dwordx4 a[136:139], v10, s[8:11], s33 offen offset:0 sc1
    s_add_u32 s33, s37, 51200
    v_mfma_f32_16x16x32_bf16 v[60:63], a[168:171], a[20:23], v[60:63]
    v_mfma_f32_16x16x32_bf16 v[64:67], a[172:175], a[20:23], v[64:67]
    v_mfma_f32_16x16x32_bf16 v[68:71], a[176:179], a[20:23], v[68:71]
    v_mfma_f32_16x16x32_bf16 v[72:75], v[184:187], a[20:23], v[72:75]
    s_waitcnt vmcnt(14)
    buffer_load_dwordx4 a[140:143], v9, s[8:11], s33 offen offset:0 sc1
    v_mfma_f32_16x16x32_bf16 v[56:59], v[188:191], a[24:27], v[56:59]
    v_mfma_f32_16x16x32_bf16 v[60:63], v[192:195], a[24:27], v[60:63]
    s_waitcnt vmcnt(10)
    v_cmp_ne_u32 vcc, s52, v6
    s_nop 0
    s_cmp_lg_u64 vcc, 0
    s_cbranch_scc1 L48
L49:
    v_mfma_f32_16x16x32_bf16 v[64:67], v[196:199], a[24:27], v[64:67]
    buffer_load_dwordx4 a[52:55], v2, s[8:11], s94 offen offset:2048 sc1
    v_mfma_f32_16x16x32_bf16 v[68:71], v[200:203], a[24:27], v[68:71]
    v_mfma_f32_16x16x32_bf16 v[72:75], v[204:207], a[24:27], v[72:75]
    buffer_load_dwordx4 a[56:59], v2, s[8:11], s95 offen offset:2048 sc1
    v_mfma_f32_16x16x32_bf16 v[56:59], v[208:211], a[28:31], v[56:59]
    v_mfma_f32_16x16x32_bf16 v[60:63], v[212:215], a[28:31], v[60:63]
    v_mfma_f32_16x16x32_bf16 v[64:67], v[216:219], a[28:31], v[64:67]
    buffer_load_dwordx4 a[60:63], v2, s[8:11], s96 offen offset:2048 sc1
    v_mfma_f32_16x16x32_bf16 v[68:71], v[220:223], a[28:31], v[68:71]
    v_mfma_f32_16x16x32_bf16 v[72:75], v[224:227], a[28:31], v[72:75]
    v_mfma_f32_16x16x32_bf16 v[56:59], v[228:231], a[32:35], v[56:59]
    buffer_load_dwordx4 a[64:67], v2, s[8:11], s97 offen offset:2048 sc1
    v_mfma_f32_16x16x32_bf16 v[60:63], v[232:235], a[32:35], v[60:63]
    v_mfma_f32_16x16x32_bf16 v[64:67], v[236:239], a[32:35], v[64:67]
    v_mfma_f32_16x16x32_bf16 v[68:71], v[240:243], a[32:35], v[68:71]
    buffer_load_dwordx4 a[68:71], v8, s[8:11], s94 offen offset:2048 sc1
    v_mfma_f32_16x16x32_bf16 v[72:75], v[244:247], a[32:35], v[72:75]
    v_mfma_f32_16x16x32_bf16 v[76:79], a[164:167], a[36:39], v[76:79]
    v_mfma_f32_16x16x32_bf16 v[80:83], a[168:171], a[36:39], v[80:83]
    buffer_load_dwordx4 a[72:75], v11, s[8:11], s94 offen offset:1024 sc1
    v_mfma_f32_16x16x32_bf16 v[84:87], a[172:175], a[36:39], v[84:87]
    v_mfma_f32_16x16x32_bf16 v[88:91], a[176:179], a[36:39], v[88:91]
    v_mfma_f32_16x16x32_bf16 v[92:95], v[184:187], a[36:39], v[92:95]
    buffer_load_dwordx4 a[0:3], v12, s[8:11], s94 offen offset:1024 sc1
    v_mfma_f32_16x16x32_bf16 v[76:79], v[188:191], a[40:43], v[76:79]
    v_mfma_f32_16x16x32_bf16 v[80:83], v[192:195], a[40:43], v[80:83]
    v_mfma_f32_16x16x32_bf16 v[84:87], v[196:199], a[40:43], v[84:87]
    buffer_load_dwordx4 a[4:7], v9, s[8:11], s94 offen offset:3072 sc1
    v_mfma_f32_16x16x32_bf16 v[88:91], v[200:203], a[40:43], v[88:91]
    v_mfma_f32_16x16x32_bf16 v[92:95], v[204:207], a[40:43], v[92:95]
    s_waitcnt vmcnt(17)
    v_mfma_f32_16x16x32_bf16 v[76:79], v[208:211], a[44:47], v[76:79]
    buffer_load_dwordx4 a[144:147], v9, s[8:11], s33 offen offset:1024 sc1
    v_mfma_f32_16x16x32_bf16 v[80:83], v[212:215], a[44:47], v[80:83]
    v_mfma_f32_16x16x32_bf16 v[84:87], v[216:219], a[44:47], v[84:87]
    v_mfma_f32_16x16x32_bf16 v[88:91], v[220:223], a[44:47], v[88:91]
    buffer_load_dwordx4 a[148:151], v9, s[8:11], s33 offen offset:2048 sc1
    v_mfma_f32_16x16x32_bf16 v[92:95], v[224:227], a[44:47], v[92:95]
    s_waitcnt vmcnt(18)
    v_mfma_f32_16x16x32_bf16 v[76:79], v[228:231], a[48:51], v[76:79]
    v_mfma_f32_16x16x32_bf16 v[80:83], v[232:235], a[48:51], v[80:83]
    buffer_load_dwordx4 a[152:155], v9, s[8:11], s33 offen offset:3072 sc1
    v_mfma_f32_16x16x32_bf16 v[84:87], v[236:239], a[48:51], v[84:87]
    v_mfma_f32_16x16x32_bf16 v[88:91], v[240:243], a[48:51], v[88:91]
    v_mfma_f32_16x16x32_bf16 v[92:95], v[244:247], a[48:51], v[92:95]
    s_waitcnt vmcnt(10)
    buffer_load_dwordx4 a[156:159], v10, s[8:11], s33 offen offset:0 sc1
    v_mfma_f32_16x16x32_bf16 v[16:19], v[248:251], a[52:55], v[16:19]
    v_mfma_f32_16x16x32_bf16 v[20:23], v[252:255], a[52:55], v[20:23]
    v_mfma_f32_16x16x32_bf16 v[24:27], v[156:159], a[52:55], v[24:27]
    buffer_load_dwordx4 a[8:11], v135, s[8:11], s94 offen offset:2048 sc1
    v_mfma_f32_16x16x32_bf16 v[28:31], v[160:163], a[52:55], v[28:31]
    v_mfma_f32_16x16x32_bf16 v[32:35], v[164:167], a[52:55], v[32:35]
    s_waitcnt vmcnt(11)
    v_mfma_f32_16x16x32_bf16 v[36:39], v[248:251], a[56:59], v[36:39]
    buffer_load_dwordx4 a[12:15], v8, s[8:11], s95 offen offset:2048 sc1
    v_mfma_f32_16x16x32_bf16 v[40:43], v[252:255], a[56:59], v[40:43]
    v_mfma_f32_16x16x32_bf16 v[44:47], v[156:159], a[56:59], v[44:47]
    v_mfma_f32_16x16x32_bf16 v[48:51], v[160:163], a[56:59], v[48:51]
    buffer_load_dwordx4 a[16:19], v11, s[8:11], s95 offen offset:1024 sc1
    v_mfma_f32_16x16x32_bf16 v[52:55], v[164:167], a[56:59], v[52:55]
    s_waitcnt vmcnt(12)
    v_mfma_f32_16x16x32_bf16 v[56:59], v[248:251], a[60:63], v[56:59]
    v_mfma_f32_16x16x32_bf16 v[60:63], v[252:255], a[60:63], v[60:63]
    buffer_load_dwordx4 a[20:23], v12, s[8:11], s95 offen offset:1024 sc1
    v_mfma_f32_16x16x32_bf16 v[64:67], v[156:159], a[60:63], v[64:67]
    v_mfma_f32_16x16x32_bf16 v[68:71], v[160:163], a[60:63], v[68:71]
    v_mfma_f32_16x16x32_bf16 v[72:75], v[164:167], a[60:63], v[72:75]
    s_waitcnt vmcnt(12)
    buffer_load_dwordx4 a[24:27], v9, s[8:11], s95 offen offset:3072 sc1
    v_mfma_f32_16x16x32_bf16 v[76:79], v[248:251], a[64:67], v[76:79]
    v_mfma_f32_16x16x32_bf16 v[80:83], v[252:255], a[64:67], v[80:83]
    v_mfma_f32_16x16x32_bf16 v[84:87], v[156:159], a[64:67], v[84:87]
    buffer_load_dwordx4 a[28:31], v135, s[8:11], s95 offen offset:2048 sc1
    v_mfma_f32_16x16x32_bf16 v[88:91], v[160:163], a[64:67], v[88:91]
    v_mfma_f32_16x16x32_bf16 v[92:95], v[164:167], a[64:67], v[92:95]
    s_waitcnt vmcnt(13)
    v_mfma_f32_16x16x32_bf16 v[16:19], v[168:171], a[68:71], v[16:19]
    buffer_load_dwordx4 a[32:35], v8, s[8:11], s96 offen offset:2048 sc1
    v_mfma_f32_16x16x32_bf16 v[20:23], v[172:175], a[68:71], v[20:23]
    v_mfma_f32_16x16x32_bf16 v[24:27], v[176:179], a[68:71], v[24:27]
    v_mfma_f32_16x16x32_bf16 v[28:31], v[180:183], a[68:71], v[28:31]
    buffer_load_dwordx4 a[36:39], v11, s[8:11], s96 offen offset:1024 sc1
    v_mfma_f32_16x16x32_bf16 v[32:35], a[76:79], a[68:71], v[32:35]
    s_waitcnt vmcnt(14)
    v_mfma_f32_16x16x32_bf16 v[16:19], a[80:83], a[72:75], v[16:19]
    v_mfma_f32_16x16x32_bf16 v[20:23], a[84:87], a[72:75], v[20:23]
    buffer_load_dwordx4 a[40:43], v12, s[8:11], s96 offen offset:1024 sc1
    v_mfma_f32_16x16x32_bf16 v[24:27], a[88:91], a[72:75], v[24:27]
    v_mfma_f32_16x16x32_bf16 v[28:31], a[92:95], a[72:75], v[28:31]
    v_mfma_f32_16x16x32_bf16 v[32:35], a[96:99], a[72:75], v[32:35]
    s_waitcnt vmcnt(14)
    buffer_load_dwordx4 a[44:47], v9, s[8:11], s96 offen offset:3072 sc1
    v_mfma_f32_16x16x32_bf16 v[16:19], a[100:103], a[0:3], v[16:19]
    v_mfma_f32_16x16x32_bf16 v[20:23], a[104:107], a[0:3], v[20:23]
    v_mfma_f32_16x16x32_bf16 v[24:27], a[108:111], a[0:3], v[24:27]
    buffer_load_dwordx4 a[48:51], v135, s[8:11], s96 offen offset:2048 sc1
    v_mfma_f32_16x16x32_bf16 v[28:31], a[112:115], a[0:3], v[28:31]
    v_mfma_f32_16x16x32_bf16 v[32:35], a[116:119], a[0:3], v[32:35]
    s_waitcnt vmcnt(15)
    v_mfma_f32_16x16x32_bf16 v[16:19], a[120:123], a[4:7], v[16:19]
    buffer_load_dwordx4 a[52:55], v8, s[8:11], s97 offen offset:2048 sc1
    v_mfma_f32_16x16x32_bf16 v[20:23], a[124:127], a[4:7], v[20:23]
    v_mfma_f32_16x16x32_bf16 v[24:27], a[128:131], a[4:7], v[24:27]
    v_mfma_f32_16x16x32_bf16 v[28:31], a[132:135], a[4:7], v[28:31]
    buffer_load_dwordx4 a[56:59], v11, s[8:11], s97 offen offset:1024 sc1
    v_mfma_f32_16x16x32_bf16 v[32:35], a[136:139], a[4:7], v[32:35]
    s_waitcnt vmcnt(12)
    v_mfma_f32_16x16x32_bf16 v[16:19], a[140:143], a[8:11], v[16:19]
    v_mfma_f32_16x16x32_bf16 v[20:23], a[144:147], a[8:11], v[20:23]
    buffer_load_dwordx4 a[60:63], v12, s[8:11], s97 offen offset:1024 sc1
    v_mfma_f32_16x16x32_bf16 v[24:27], a[148:151], a[8:11], v[24:27]
    v_mfma_f32_16x16x32_bf16 v[28:31], a[152:155], a[8:11], v[28:31]
    v_mfma_f32_16x16x32_bf16 v[32:35], a[156:159], a[8:11], v[32:35]
    s_waitcnt vmcnt(12)
    buffer_load_dwordx4 a[64:67], v9, s[8:11], s97 offen offset:3072 sc1
    v_mfma_f32_16x16x32_bf16 v[36:39], v[168:171], a[12:15], v[36:39]
    v_add_u32 v6, s98, v2
    v_mfma_f32_16x16x32_bf16 v[40:43], v[172:175], a[12:15], v[40:43]
    ds_write_b128 v6, v[16:19] offset:0
    v_mfma_f32_16x16x32_bf16 v[44:47], v[176:179], a[12:15], v[44:47]
    buffer_load_dwordx4 a[68:71], v135, s[8:11], s97 offen offset:2048 sc1
    ds_write_b128 v6, v[20:23] offset:1024
    v_mfma_f32_16x16x32_bf16 v[48:51], v[180:183], a[12:15], v[48:51]
    ds_write_b128 v6, v[24:27] offset:2048
    v_mfma_f32_16x16x32_bf16 v[52:55], a[76:79], a[12:15], v[52:55]
    s_waitcnt vmcnt(13)
    ds_write_b128 v6, v[28:31] offset:3072
    v_mfma_f32_16x16x32_bf16 v[36:39], a[80:83], a[16:19], v[36:39]
    ds_write_b128 v6, v[32:35] offset:4096
    v_mfma_f32_16x16x32_bf16 v[40:43], a[84:87], a[16:19], v[40:43]
    v_mfma_f32_16x16x32_bf16 v[44:47], a[88:91], a[16:19], v[44:47]
    v_mfma_f32_16x16x32_bf16 v[48:51], a[92:95], a[16:19], v[48:51]
    s_waitcnt lgkmcnt(0)
    s_barrier
    ds_read_b128 v[16:19], v7 offset:0
    v_mfma_f32_16x16x32_bf16 v[52:55], a[96:99], a[16:19], v[52:55]
    s_waitcnt vmcnt(12)
    ds_read_b128 v[20:23], v7 offset:1024
    ds_read_b128 v[24:27], v7 offset:2048
    v_mfma_f32_16x16x32_bf16 v[36:39], a[100:103], a[20:23], v[36:39]
    ds_read_b128 v[28:31], v7 offset:3072
    ds_read_b128 v[32:35], v7 offset:4096
    v_mfma_f32_16x16x32_bf16 v[40:43], a[104:107], a[20:23], v[40:43]
    v_mfma_f32_16x16x32_bf16 v[44:47], a[108:111], a[20:23], v[44:47]
    v_mfma_f32_16x16x32_bf16 v[48:51], a[112:115], a[20:23], v[48:51]
    v_mfma_f32_16x16x32_bf16 v[52:55], a[116:119], a[20:23], v[52:55]
    s_waitcnt vmcnt(11)
    s_waitcnt lgkmcnt(4)
    v_fmac_f32 v136, v16, v96
    v_mfma_f32_16x16x32_bf16 v[36:39], a[120:123], a[24:27], v[36:39]
    v_fmac_f32 v137, v17, v97
    v_fmac_f32 v138, v18, v98
    v_mfma_f32_16x16x32_bf16 v[40:43], a[124:127], a[24:27], v[40:43]
    v_fmac_f32 v139, v19, v99
    s_waitcnt lgkmcnt(3)
    v_mfma_f32_16x16x32_bf16 v[44:47], a[128:131], a[24:27], v[44:47]
    v_fmac_f32 v140, v20, v100
    v_fmac_f32 v141, v21, v101
    v_mfma_f32_16x16x32_bf16 v[48:51], a[132:135], a[24:27], v[48:51]
    v_fmac_f32 v142, v22, v102
    v_fmac_f32 v143, v23, v103
    v_mfma_f32_16x16x32_bf16 v[52:55], a[136:139], a[24:27], v[52:55]
    s_waitcnt vmcnt(10)
    s_waitcnt lgkmcnt(2)
    v_fmac_f32 v144, v24, v104
    v_mfma_f32_16x16x32_bf16 v[36:39], a[140:143], a[28:31], v[36:39]
    v_fmac_f32 v145, v25, v105
    v_fmac_f32 v146, v26, v106
    v_mfma_f32_16x16x32_bf16 v[40:43], a[144:147], a[28:31], v[40:43]
    v_fmac_f32 v147, v27, v107
    s_waitcnt lgkmcnt(1)
    v_mfma_f32_16x16x32_bf16 v[44:47], a[148:151], a[28:31], v[44:47]
    v_fmac_f32 v148, v28, v108
    v_fmac_f32 v149, v29, v109
    v_mfma_f32_16x16x32_bf16 v[48:51], a[152:155], a[28:31], v[48:51]
    v_fmac_f32 v150, v30, v110
    v_fmac_f32 v151, v31, v111
    v_mfma_f32_16x16x32_bf16 v[52:55], a[156:159], a[28:31], v[52:55]
    s_waitcnt vmcnt(9)
    s_waitcnt lgkmcnt(0)
    v_fmac_f32 v152, v32, v112
    v_mfma_f32_16x16x32_bf16 v[56:59], v[168:171], a[32:35], v[56:59]
    v_fmac_f32 v153, v33, v113
    v_fmac_f32 v154, v34, v114
    v_mfma_f32_16x16x32_bf16 v[60:63], v[172:175], a[32:35], v[60:63]
    v_fmac_f32 v155, v35, v115
    v_add_u32 v6, s99, v2
    v_mfma_f32_16x16x32_bf16 v[64:67], v[176:179], a[32:35], v[64:67]
    ds_write_b128 v6, v[36:39] offset:0
    ds_write_b128 v6, v[40:43] offset:1024
    v_mfma_f32_16x16x32_bf16 v[68:71], v[180:183], a[32:35], v[68:71]
    ds_write_b128 v6, v[44:47] offset:2048
    v_mfma_f32_16x16x32_bf16 v[72:75], a[76:79], a[32:35], v[72:75]
    s_waitcnt vmcnt(8)
    ds_write_b128 v6, v[48:51] offset:3072
    v_mfma_f32_16x16x32_bf16 v[56:59], a[80:83], a[36:39], v[56:59]
    ds_write_b128 v6, v[52:55] offset:4096
    v_mfma_f32_16x16x32_bf16 v[60:63], a[84:87], a[36:39], v[60:63]
    v_mfma_f32_16x16x32_bf16 v[64:67], a[88:91], a[36:39], v[64:67]
    v_mfma_f32_16x16x32_bf16 v[68:71], a[92:95], a[36:39], v[68:71]
    s_waitcnt lgkmcnt(0)
    s_barrier
    ds_read_b128 v[36:39], v7 offset:5120
    v_mfma_f32_16x16x32_bf16 v[72:75], a[96:99], a[36:39], v[72:75]
    s_waitcnt vmcnt(7)
    ds_read_b128 v[40:43], v7 offset:6144
    ds_read_b128 v[44:47], v7 offset:7168
    v_mfma_f32_16x16x32_bf16 v[56:59], a[100:103], a[40:43], v[56:59]
    ds_read_b128 v[48:51], v7 offset:8192
    ds_read_b128 v[52:55], v7 offset:9216
    v_mfma_f32_16x16x32_bf16 v[60:63], a[104:107], a[40:43], v[60:63]
    v_mfma_f32_16x16x32_bf16 v[64:67], a[108:111], a[40:43], v[64:67]
    v_mfma_f32_16x16x32_bf16 v[68:71], a[112:115], a[40:43], v[68:71]
    v_mfma_f32_16x16x32_bf16 v[72:75], a[116:119], a[40:43], v[72:75]
    s_waitcnt vmcnt(6)
    s_waitcnt lgkmcnt(4)
    v_fmac_f32 v136, v36, v96
    v_mfma_f32_16x16x32_bf16 v[56:59], a[120:123], a[44:47], v[56:59]
    v_fmac_f32 v137, v37, v97
    v_fmac_f32 v138, v38, v98
    v_mfma_f32_16x16x32_bf16 v[60:63], a[124:127], a[44:47], v[60:63]
    v_fmac_f32 v139, v39, v99
    s_waitcnt lgkmcnt(3)
    v_mfma_f32_16x16x32_bf16 v[64:67], a[128:131], a[44:47], v[64:67]
    v_fmac_f32 v140, v40, v100
    v_fmac_f32 v141, v41, v101
    v_mfma_f32_16x16x32_bf16 v[68:71], a[132:135], a[44:47], v[68:71]
    v_fmac_f32 v142, v42, v102
    v_fmac_f32 v143, v43, v103
    v_mfma_f32_16x16x32_bf16 v[72:75], a[136:139], a[44:47], v[72:75]
    s_waitcnt vmcnt(5)
    s_waitcnt lgkmcnt(2)
    v_fmac_f32 v144, v44, v104
    v_mfma_f32_16x16x32_bf16 v[56:59], a[140:143], a[48:51], v[56:59]
    v_fmac_f32 v145, v45, v105
    v_fmac_f32 v146, v46, v106
    v_mfma_f32_16x16x32_bf16 v[60:63], a[144:147], a[48:51], v[60:63]
    v_fmac_f32 v147, v47, v107
    s_waitcnt lgkmcnt(1)
    v_mfma_f32_16x16x32_bf16 v[64:67], a[148:151], a[48:51], v[64:67]
    v_fmac_f32 v148, v48, v108
    v_fmac_f32 v149, v49, v109
    v_mfma_f32_16x16x32_bf16 v[68:71], a[152:155], a[48:51], v[68:71]
    v_fmac_f32 v150, v50, v110
    v_fmac_f32 v151, v51, v111
    v_mfma_f32_16x16x32_bf16 v[72:75], a[156:159], a[48:51], v[72:75]
    s_waitcnt vmcnt(4)
    s_waitcnt lgkmcnt(0)
    v_fmac_f32 v152, v52, v112
    v_mfma_f32_16x16x32_bf16 v[76:79], v[168:171], a[52:55], v[76:79]
    v_fmac_f32 v153, v53, v113
    v_fmac_f32 v154, v54, v114
    v_mfma_f32_16x16x32_bf16 v[80:83], v[172:175], a[52:55], v[80:83]
    v_fmac_f32 v155, v55, v115
    v_add_u32 v6, s100, v2
    v_mfma_f32_16x16x32_bf16 v[84:87], v[176:179], a[52:55], v[84:87]
    ds_write_b128 v6, v[56:59] offset:0
    ds_write_b128 v6, v[60:63] offset:1024
    v_mfma_f32_16x16x32_bf16 v[88:91], v[180:183], a[52:55], v[88:91]
    ds_write_b128 v6, v[64:67] offset:2048
    v_mfma_f32_16x16x32_bf16 v[92:95], a[76:79], a[52:55], v[92:95]
    s_waitcnt vmcnt(3)
    ds_write_b128 v6, v[68:71] offset:3072
    v_mfma_f32_16x16x32_bf16 v[76:79], a[80:83], a[56:59], v[76:79]
    ds_write_b128 v6, v[72:75] offset:4096
    v_mfma_f32_16x16x32_bf16 v[80:83], a[84:87], a[56:59], v[80:83]
    v_mfma_f32_16x16x32_bf16 v[84:87], a[88:91], a[56:59], v[84:87]
    v_mfma_f32_16x16x32_bf16 v[88:91], a[92:95], a[56:59], v[88:91]
    s_waitcnt lgkmcnt(0)
    s_barrier
    ds_read_b128 v[56:59], v7 offset:10240
    v_mfma_f32_16x16x32_bf16 v[92:95], a[96:99], a[56:59], v[92:95]
    s_waitcnt vmcnt(2)
    ds_read_b128 v[60:63], v7 offset:11264
    ds_read_b128 v[64:67], v7 offset:12288
    v_mfma_f32_16x16x32_bf16 v[76:79], a[100:103], a[60:63], v[76:79]
    ds_read_b128 v[68:71], v7 offset:13312
    ds_read_b128 v[72:75], v7 offset:14336
    v_mfma_f32_16x16x32_bf16 v[80:83], a[104:107], a[60:63], v[80:83]
    v_mfma_f32_16x16x32_bf16 v[84:87], a[108:111], a[60:63], v[84:87]
    v_mfma_f32_16x16x32_bf16 v[88:91], a[112:115], a[60:63], v[88:91]
    v_mfma_f32_16x16x32_bf16 v[92:95], a[116:119], a[60:63], v[92:95]
    s_waitcnt vmcnt(1)
    s_waitcnt lgkmcnt(4)
    v_fmac_f32 v136, v56, v96
    v_mfma_f32_16x16x32_bf16 v[76:79], a[120:123], a[64:67], v[76:79]
    v_fmac_f32 v137, v57, v97
    v_fmac_f32 v138, v58, v98
    v_mfma_f32_16x16x32_bf16 v[80:83], a[124:127], a[64:67], v[80:83]
    v_fmac_f32 v139, v59, v99
    s_waitcnt lgkmcnt(3)
    v_mfma_f32_16x16x32_bf16 v[84:87], a[128:131], a[64:67], v[84:87]
    v_fmac_f32 v140, v60, v100
    v_fmac_f32 v141, v61, v101
    v_mfma_f32_16x16x32_bf16 v[88:91], a[132:135], a[64:67], v[88:91]
    v_fmac_f32 v142, v62, v102
    v_fmac_f32 v143, v63, v103
    v_mfma_f32_16x16x32_bf16 v[92:95], a[136:139], a[64:67], v[92:95]
    s_waitcnt vmcnt(0)
    s_waitcnt lgkmcnt(2)
    v_fmac_f32 v144, v64, v104
    v_mfma_f32_16x16x32_bf16 v[76:79], a[140:143], a[68:71], v[76:79]
    v_fmac_f32 v145, v65, v105
    v_fmac_f32 v146, v66, v106
    v_mfma_f32_16x16x32_bf16 v[80:83], a[144:147], a[68:71], v[80:83]
    v_fmac_f32 v147, v67, v107
    s_waitcnt lgkmcnt(1)
    v_mfma_f32_16x16x32_bf16 v[84:87], a[148:151], a[68:71], v[84:87]
    v_fmac_f32 v148, v68, v108
    v_fmac_f32 v149, v69, v109
    v_mfma_f32_16x16x32_bf16 v[88:91], a[152:155], a[68:71], v[88:91]
    v_fmac_f32 v150, v70, v110
    v_fmac_f32 v151, v71, v111
    v_mfma_f32_16x16x32_bf16 v[92:95], a[156:159], a[68:71], v[92:95]
    s_waitcnt lgkmcnt(0)
    v_fmac_f32 v152, v72, v112
    v_fmac_f32 v153, v73, v113
    v_fmac_f32 v154, v74, v114
    v_fmac_f32 v155, v75, v115
    v_pk_fma_f32 v[136:137], v[76:77], v[96:97], v[136:137]
    v_pk_fma_f32 v[138:139], v[78:79], v[98:99], v[138:139]
    v_pk_fma_f32 v[140:141], v[80:81], v[100:101], v[140:141]
    v_pk_fma_f32 v[142:143], v[82:83], v[102:103], v[142:143]
    v_pk_fma_f32 v[144:145], v[84:85], v[104:105], v[144:145]
    v_pk_fma_f32 v[146:147], v[86:87], v[106:107], v[146:147]
    v_pk_fma_f32 v[148:149], v[88:89], v[108:109], v[148:149]
    v_pk_fma_f32 v[150:151], v[90:91], v[110:111], v[150:151]
    v_pk_fma_f32 v[152:153], v[92:93], v[112:113], v[152:153]
    v_pk_fma_f32 v[154:155], v[94:95], v[114:115], v[154:155]
    v_cvt_pk_bf16_f32 v16, v136, v137
    v_cvt_pk_bf16_f32 v17, v138, v139
    ds_write_b64 v116, v[16:17] offset:0
    v_cvt_pk_bf16_f32 v18, v140, v141
    v_cvt_pk_bf16_f32 v19, v142, v143
    ds_write_b64 v116, v[18:19] offset:8
    v_cvt_pk_bf16_f32 v20, v144, v145
    v_cvt_pk_bf16_f32 v21, v146, v147
    ds_write_b64 v116, v[20:21] offset:16
    v_cvt_pk_bf16_f32 v22, v148, v149
    v_cvt_pk_bf16_f32 v23, v150, v151
    ds_write_b64 v116, v[22:23] offset:24
    v_cvt_pk_bf16_f32 v24, v152, v153
    v_cvt_pk_bf16_f32 v25, v154, v155
    ds_write_b64 v116, v[24:25] offset:32
    ds_read_b128 v[28:31], v117 offset:0
    ds_read_b128 v[32:35], v117 offset:64
    ds_read_b128 v[36:39], v117 offset:128
    s_waitcnt lgkmcnt(2)
    buffer_store_dwordx4 v[28:31], v119, s[4:7], 0 offen offset:0
    s_waitcnt lgkmcnt(1)
    buffer_store_dwordx4 v[32:35], v118, s[4:7], 0 offen offset:64
    s_waitcnt lgkmcnt(0)
    buffer_store_dwordx4 v[36:39], v120, s[4:7], 0 offen offset:128
L_end:
    s_endpgm
W4:
    s_branch L_wret
L11:
    s_mov_b32 s53, 200000
L50:
    s_mov_b32 s55, 0x20000
    buffer_load_dwordx4 v[44:47], v102, s[8:11], s55 offen sc1
    s_mov_b32 s55, 0x23c00
    buffer_load_dwordx4 v[48:51], v102, s[8:11], s55 offen sc1
    s_mov_b32 s55, 0x27800
    buffer_load_dwordx4 v[52:55], v102, s[8:11], s55 offen sc1
    s_mov_b32 s55, 0x2b400
    buffer_load_dwordx4 v[56:59], v102, s[8:11], s55 offen sc1
    buffer_load_dwordx4 v[60:63], v2, s[8:11], s23 offen sc1
    buffer_load_dwordx4 v[64:67], v2, s[8:11], s23 offen offset:1024 sc1
    s_waitcnt vmcnt(0)
    v_xor_b32 v44, v106, v44
    v_xor_b32 v45, v107, v45
    v_xor_b32 v46, v108, v46
    v_xor_b32 v47, v109, v47
    v_xor_b32 v48, v106, v48
    v_xor_b32 v49, v107, v49
    v_xor_b32 v50, v108, v50
    v_xor_b32 v51, v109, v51
    v_xor_b32 v52, v106, v52
    v_xor_b32 v53, v107, v53
    v_xor_b32 v54, v108, v54
    v_xor_b32 v55, v109, v55
    v_xor_b32 v56, v106, v56
    v_xor_b32 v57, v107, v57
    v_xor_b32 v58, v108, v58
    v_xor_b32 v59, v109, v59
    v_xor_b32 v62, s52, v62
    v_xor_b32 v66, s52, v66
    v_or3_b32 v94, v44, v45, v46
    v_or3_b32 v95, v47, v48, v49
    v_or3_b32 v95, v95, v50, v51
    v_or3_b32 v94, v94, v52, v53
    v_or3_b32 v95, v95, v54, v55
    v_or3_b32 v94, v94, v56, v57
    v_or3_b32 v95, v95, v58, v59
    v_or_b32 v94, v94, v95
    v_and_b32 v94, 0xff, v94
    v_or3_b32 v94, v94, v62, v66
    v_cmp_ne_u32 vcc, 0, v94
    s_nop 0
    s_cmp_eq_u64 vcc, 0
    s_cbranch_scc1 L51
    s_sleep 2
    s_sub_u32 s53, s53, 1
    s_cmp_lg_u32 s53, 0
    s_cbranch_scc1 L50
L51:
    s_branch L12
L14:
    s_nop 7
    s_mov_b32 s53, 200000
L52:
    buffer_load_dword v21, v20, s[8:11], 0 offen sc1
    s_waitcnt vmcnt(0)
    v_cmp_ne_u32 vcc, s52, v21
    s_nop 0
    s_cmp_eq_u64 vcc, 0
    s_cbranch_scc1 L53
    s_sub_u32 s53, s53, 1
    s_cmp_lg_u32 s53, 0
    s_cbranch_scc1 L52
L53:
    s_branch L15
L22:
    s_mov_b32 s53, 200000
L54:
    buffer_load_dwordx4 v[196:199], v204, s[8:11], s0 offen sc1
    s_waitcnt vmcnt(0)
    v_xor_b32 v196, v200, v196
    v_xor_b32 v197, v201, v197
    v_xor_b32 v198, v202, v198
    v_xor_b32 v199, v203, v199
    v_or3_b32 v206, v196, v197, v198
    v_or_b32 v206, v206, v199
    v_and_b32 v206, 0xff, v206
    v_cmp_ne_u32 vcc, 0, v206
    s_nop 0
    s_cmp_eq_u64 vcc, 0
    s_cbranch_scc1 L55
    s_sleep 2
    s_sub_u32 s53, s53, 1
    s_cmp_lg_u32 s53, 0
    s_cbranch_scc1 L54
L55:
    s_branch L23
L29:
    s_mov_b32 s53, 200000
L56:
    buffer_load_dwordx4 v[128:131], v145, s[8:11], s33 offen offset:0 sc1
    buffer_load_dwordx4 v[132:135], v145, s[8:11], s33 offen offset:512 sc1
    buffer_load_dwordx4 v[136:139], v234, s[8:11], s33 offen offset:0 sc1
    buffer_load_dwordx4 v[140:143], v234, s[8:11], s33 offen offset:512 sc1
    s_waitcnt vmcnt(0)
    v_xor_b32 v131, v235, v131
    v_xor_b32 v135, v235, v135
    v_xor_b32 v139, v236, v139
    v_xor_b32 v143, v236, v143
    v_or3_b32 v131, v131, v135, v139
    v_or_b32 v131, v131, v143
    v_cmp_ne_u32 vcc, 0, v131
    s_nop 0
    s_cmp_eq_u64 vcc, 0
    s_cbranch_scc1 L57
    s_sub_u32 s53, s53, 1
    s_cmp_lg_u32 s53, 0
    s_cbranch_scc1 L56
L57:
    s_branch L30
L32:
    s_mov_b32 s53, 200000
L58:
    buffer_load_dwordx4 v[228:231], v239, s[8:11], 0 offen sc1
    s_waitcnt vmcnt(0)
    v_xor_b32 v228, s52, v228
    v_xor_b32 v229, s52, v229
    v_xor_b32 v230, s52, v230
    v_xor_b32 v231, s52, v231
    v_or3_b32 v228, v228, v229, v230
    v_or_b32 v228, v228, v231
    v_cmp_ne_u32 vcc, 0, v228
    s_nop 0
    s_cmp_eq_u64 vcc, 0
    s_cbranch_scc1 L59
    s_sleep 4
    s_sub_u32 s53, s53, 1
    s_cmp_lg_u32 s53, 0
    s_cbranch_scc1 L58
L59:
    s_branch L33
L34:
    s_mov_b32 s53, 200000
L60:
    buffer_load_dwordx4 v[64:67], v146, s[8:11], 0 offen sc1
    buffer_load_dwordx4 v[68:71], v147, s[8:11], 0 offen sc1
    s_waitcnt vmcnt(0)
    v_xor_b32 v64, s59, v64
    v_xor_b32 v65, s60, v65
    v_xor_b32 v66, s62, v66
    v_xor_b32 v67, s63, v67
    v_xor_b32 v68, s59, v68
    v_xor_b32 v69, s60, v69
    v_xor_b32 v70, s62, v70
    v_xor_b32 v71, s63, v71
    v_or3_b32 v188, v64, v65, v66
    v_or3_b32 v189, v67, v68, v69
    v_or3_b32 v188, v188, v70, v71
    v_or_b32 v188, v188, v189
    v_and_b32 v188, 0xff, v188
    v_cmp_ne_u32 vcc, 0, v188
    s_nop 0
    s_cmp_eq_u64 vcc, 0
    s_cbranch_scc1 L61
    s_sleep 2
    s_sub_u32 s53, s53, 1
    s_cmp_lg_u32 s53, 0
    s_cbranch_scc1 L60
L61:
    s_branch L35
L39:
    s_mov_b32 s53, 200000
L62:
    buffer_load_dwordx4 v[220:223], v216, s[8:11], 0 offen sc1
    s_waitcnt vmcnt(0)
    v_xor_b32 v220, s52, v220
    v_xor_b32 v221, s52, v221
    v_xor_b32 v222, s52, v222
    v_xor_b32 v223, s52, v223
    v_or3_b32 v220, v220, v221, v222
    v_or_b32 v220, v220, v223
    v_cmp_ne_u32 vcc, 0, v220
    s_nop 0
    s_cmp_eq_u64 vcc, 0
    s_cbranch_scc1 L63
    s_sleep 4
    s_sub_u32 s53, s53, 1
    s_cmp_lg_u32 s53, 0
    s_cbranch_scc1 L62
L63:
    s_branch L40
L44:
    s_nop 7
    s_mov_b32 s53, 200000
L64:
    buffer_load_dword v6, v0, s[8:11], 0 offen sc1
    s_waitcnt vmcnt(0)
    v_cmp_ne_u32 vcc, s52, v6
    s_nop 0
    s_cmp_eq_u64 vcc, 0
    s_cbranch_scc1 L65
    s_sub_u32 s53, s53, 1
    s_cmp_lg_u32 s53, 0
    s_cbranch_scc1 L64
L65:
    s_branch L45
L46:
    s_nop 7
    s_mov_b32 s53, 200000
L66:
    buffer_load_dword v6, v0, s[8:11], 0 offen sc1
    s_waitcnt vmcnt(0)
    v_cmp_ne_u32 vcc, s52, v6
    s_nop 0
    s_cmp_eq_u64 vcc, 0
    s_cbranch_scc1 L67
    s_sub_u32 s53, s53, 1
    s_cmp_lg_u32 s53, 0
    s_cbranch_scc1 L66
L67:
    s_branch L47
L48:
    s_nop 7
    s_mov_b32 s53, 200000
L68:
    buffer_load_dword v6, v0, s[8:11], 0 offen sc1
    s_waitcnt vmcnt(0)
    v_cmp_ne_u32 vcc, s52, v6
    s_nop 0
    s_cmp_eq_u64 vcc, 0
    s_cbranch_scc1 L69
    s_sub_u32 s53, s53, 1
    s_cmp_lg_u32 s53, 0
    s_cbranch_scc1 L68
L69:
    s_branch L49
L_code_end:
.section .rodata,"a"
.p2align 6
.amdhsa_kernel adaLN_cond__sliding_local_dilated__mixer_channel_mlp__prompt_kernel
  .amdhsa_next_free_vgpr 512
  .amdhsa_next_free_sgpr 102
  .amdhsa_accum_offset 256
  .amdhsa_group_segment_fixed_size 0
  .amdhsa_kernarg_size 104
  .amdhsa_user_sgpr_count 2
  .amdhsa_user_sgpr_kernarg_segment_ptr 1
  .amdhsa_system_sgpr_workgroup_id_x 1
  .amdhsa_float_denorm_mode_32 3
.end_amdhsa_kernel
```
